```python
import torch

def _softmax(x, axis=-1):
    return torch.softmax(x, dim=axis)
def _gelu(x):
    return torch.nn.functional.gelu(x, approximate="tanh")
def _silu(x):
    return torch.nn.functional.silu(x)
def _sigmoid(x):
    return torch.sigmoid(x)
def _layernorm(x, axis=-1, eps=1e-5):
    m = x.mean(dim=axis, keepdim=True)
    v = x.var(dim=axis, keepdim=True, unbiased=False)
    return (x - m) / torch.sqrt(v + eps)
def _scatter_add(tgt, idx, src, axis=0):
    return tgt.clone().index_add_(axis, idx, src)
def _segment_sum(src, seg, n):
    out = torch.zeros((n,) + src.shape[1:], dtype=src.dtype)
    return out.index_add_(0, seg, src)
def _pad(x, pw):
    flat = tuple(v for pair in reversed(pw) for v in pair)
    return torch.nn.functional.pad(x, flat)

kernel_name = 'parallel_sum__sliding_block__glu_gated_geglu__prompt'

def setup_inputs():

    _w = (lambda a: (lambda t: t.to(torch.bfloat16) if t.is_floating_point() else t)(torch.as_tensor(a)))
    def _A_setup():
        B, S, D = 1, 2048, 512
        return {
            "x": _w((lambda *s: torch.randn(*s, dtype=torch.bfloat16) * 0.05)(B, S, D)),
            "wqkv": _w((lambda *s: torch.randn(*s, dtype=torch.bfloat16) * 0.05)(D, 3 * D)),
            "wo": _w((lambda *s: torch.randn(*s, dtype=torch.bfloat16) * 0.05)(D, D)),
        }
    _A_in = _A_setup()

    def _B_setup():
        B, S, Dm, Df = 1, 2048, 512, 1376
        return {
            "x": _w((lambda *s: torch.randn(*s, dtype=torch.bfloat16) * 0.05)(B, S, Dm)),
            "w_gate": _w((lambda *s: torch.randn(*s, dtype=torch.bfloat16) * 0.8)(Dm, Df) * (Dm ** -0.5)),
            "w_up": _w((lambda *s: torch.randn(*s, dtype=torch.bfloat16) * 0.8)(Dm, Df) * (Dm ** -0.5)),
            "w_down": _w((lambda *s: torch.randn(*s, dtype=torch.bfloat16) * 0.8)(Df, Dm) * (Df ** -0.5)),
        }
    _B_in = _B_setup()

    return {
        "A_x": _A_in["x"],
        "A_wqkv": _A_in["wqkv"],
        "A_wo": _A_in["wo"],
        "B_x": _B_in["x"],
        "B_w_gate": _B_in["w_gate"],
        "B_w_up": _B_in["w_up"],
        "B_w_down": _B_in["w_down"],
    }

def reference(A_x, A_wqkv, A_wo, B_x, B_w_gate, B_w_up, B_w_down):
    def _A_ref(x, wqkv, wo):
        B, S, D = x.shape
        H = 32; Dh = D // H; W = 256
        qkv = (lambda x, *d: x.permute(*d))((x @ wqkv).reshape(B, S, 3, H, Dh), 2, 0, 3, 1, 4)
        q, k, v = qkv[0], qkv[1], qkv[2]
        scores = torch.einsum("bhqd,bhkd->bhqk", q, k) * (Dh ** -0.5)
        idx = torch.arange(S)
        mask = (idx[:, None] - idx[None, :] >= 0) & (idx[:, None] - idx[None, :] < W)
        scores = torch.where(mask[None, None], scores, -1e9)
        p = _softmax(scores, axis=-1)
        o = torch.einsum("bhqk,bhkd->bhqd", p, v)
        return (lambda x, *d: x.permute(*d))(o, 0, 2, 1, 3).reshape(B, S, D) @ wo

    def _B_ref(x, w_gate, w_up, w_down):
        g = torch.einsum("bsd,df->bsf", x, w_gate)
        u = torch.einsum("bsd,df->bsf", x, w_up)
        h = _gelu(g) * u
        return torch.einsum("bsf,fd->bsd", h, w_down)

    x = A_x
    xn = _layernorm(x, axis=-1)
    return x + _A_ref(xn, A_wqkv, A_wo) + _B_ref(xn, B_w_gate, B_w_up, B_w_down)
```

```asm
; @launch grid=(256,1,1) block=(256,1,1) lds=163840
.amdgcn_target "amdgcn-amd-amdhsa--gfx950"
.text
.globl parallel_sum__sliding_block__glu_gated_geglu__prompt_kernel
.p2align 8
.type parallel_sum__sliding_block__glu_gated_geglu__prompt_kernel,@function
parallel_sum__sliding_block__glu_gated_geglu__prompt_kernel:
    s_cmp_ge_u32 s2, 256
    s_cbranch_scc1 Lend
    s_load_dwordx2 s[24:25], s[0:1], 0
    s_load_dwordx16 s[4:19], s[0:1], 0
    s_load_dwordx4 s[20:23], s[0:1], 64
    s_getpc_b64 s[68:69]
Lpc:
    s_lshr_b32 s3, s2, 3
    v_lshrrev_b32 v20, 4, v0
    v_lshl_add_u32 v20, s3, 4, v20
    v_lshlrev_b32 v20, 7, v20
    v_min_u32 v20, Lcode_end-Lpc-4, v20
    global_load_dword v15, v20, s[68:69]
    v_and_b32 v1, 63, v0
    v_lshrrev_b32 v2, 6, v0
    s_and_b32 s58, s2, 7
    v_readfirstlane_b32 s52, v2
    s_lshr_b32 s49, s2, 3
    s_and_b32 s53, s58, 1
    s_lshl_b32 s53, s53, 3
    s_and_b32 s60, s49, 7
    s_add_u32 s53, s53, s60
    s_lshr_b32 s60, s49, 3
    s_lshr_b32 s54, s58, 1
    s_lshl2_add_u32 s54, s54, s60
    s_lshl1_add_u32 s55, s60, s53
    s_and_b32 s55, s55, 7
    s_and_b32 s60, s49, 7
    s_lshr_b32 s56, s58, 1
    s_lshl3_add_u32 s56, s56, s60
    s_and_b32 s57, s58, 1
    s_lshr_b32 s60, s49, 3
    s_lshl2_add_u32 s57, s57, s60
    v_lshrrev_b32 v20, 3, v1
    v_lshrrev_b32 v21, 4, v1
    v_and_b32 v22, 7, v1
    v_xor_b32 v23, v21, v22
    v_lshlrev_b32 v23, 4, v23
    v_lshl_add_u32 v23, v20, 10, v23
    v_xor_b32 v24, 64, v23
    v_mov_b32 v2, v23
    v_add_u32 v3, 7168, v24
    v_add_u32 v4, 14336, v23
    v_add_u32 v5, 21504, v24
    s_lshl_b32 s58, s53, 17
    s_lshl_b32 s60, s52, 15
    s_add_u32 s58, s58, s60
    s_mul_i32 s59, s52, 3072
    v_lshlrev_b32 v14, 4, v1
    s_mov_b32 s26, 2097152
    s_mov_b32 s27, 0x20000
    s_add_u32 s60, s55, 0
    s_and_b32 s60, s60, 7
    s_lshl_b32 s60, s60, 7
    s_lshl_b32 m0, s52, 14
    s_add_u32 m0, m0, 0
    s_add_u32 s60, s60, s58
    s_waitcnt lgkmcnt(0)
    buffer_load_dwordx4 v2, s[24:27], s60 offen offset:0 lds
    buffer_load_dwordx4 v3, s[24:27], s60 offen offset:1024 lds
    buffer_load_dwordx4 v4, s[24:27], s60 offen offset:2048 lds
    buffer_load_dwordx4 v5, s[24:27], s60 offen offset:3072 lds
    s_add_u32 s60, s55, 1
    s_and_b32 s60, s60, 7
    s_lshl_b32 s60, s60, 7
    s_lshl_b32 m0, s52, 14
    s_add_u32 m0, m0, 4096
    s_add_u32 s60, s60, s58
    buffer_load_dwordx4 v2, s[24:27], s60 offen offset:0 lds
    buffer_load_dwordx4 v3, s[24:27], s60 offen offset:1024 lds
    buffer_load_dwordx4 v4, s[24:27], s60 offen offset:2048 lds
    buffer_load_dwordx4 v5, s[24:27], s60 offen offset:3072 lds
    s_add_u32 s60, s55, 2
    s_and_b32 s60, s60, 7
    s_lshl_b32 s60, s60, 7
    s_lshl_b32 m0, s52, 14
    s_add_u32 m0, m0, 8192
    s_add_u32 s60, s60, s58
    buffer_load_dwordx4 v2, s[24:27], s60 offen offset:0 lds
    buffer_load_dwordx4 v3, s[24:27], s60 offen offset:1024 lds
    buffer_load_dwordx4 v4, s[24:27], s60 offen offset:2048 lds
    buffer_load_dwordx4 v5, s[24:27], s60 offen offset:3072 lds
    s_and_b32 s0, s49, 28
    s_add_u32 s0, s0, s52
    s_and_b32 s1, s2, 7
    s_and_b32 s3, s49, 3
    s_lshl2_add_u32 s1, s1, s3
    s_mov_b32 s40, s22
    s_mov_b32 s41, s23
    s_mov_b32 s42, 17825792
    s_mov_b32 s43, 0x20000
    s_or_b32 s60, s2, s52
    s_cmp_lg_u32 s60, 0
    s_cbranch_scc1 Lnn_1
    s_mov_b32 s60, 16252928
    buffer_load_dword v254, off, s[40:43], s60 sc1
Lnn_1:
    s_mov_b32 s36, s6
    s_mov_b32 s37, s7
    s_mov_b32 s38, 1572864
    s_mov_b32 s39, 0x20000
    s_mul_i32 s62, s54, 192
    s_lshl_b32 s63, s52, 4
    s_movk_i32 s64, 2752
    s_movk_i32 s65, 3072
    s_cmp_eq_u32 s54, 14
    s_cselect_b32 s66, 4, 12
    v_add_u32 v20, 0, v1
    v_mul_u32_u24 v21, 683, v20
    v_lshrrev_b32 v21, 13, v21
    v_mul_u32_u24 v22, 12, v21
    v_sub_u32 v22, v20, v22
    v_bfe_u32 v23, v21, 3, 1
    v_lshlrev_b32 v23, 1, v23
    v_xor_b32 v22, v22, v23
    v_cmp_gt_u32 s[68:69], s66, v22
    v_lshl_add_u32 v22, v22, 4, s62
    v_add_u32 v21, s63, v21
    v_subrev_u32 v22, 0, v22
    v_mad_u32_u24 v11, v21, s65, v22
    v_mad_u32_u24 v23, v21, s64, v22
    v_mov_b32 v24, 0x40000000
    v_cndmask_b32 v8, v24, v23, s[68:69]
    v_add_u32 v20, 64, v1
    v_mul_u32_u24 v21, 683, v20
    v_lshrrev_b32 v21, 13, v21
    v_mul_u32_u24 v22, 12, v21
    v_sub_u32 v22, v20, v22
    v_bfe_u32 v23, v21, 3, 1
    v_lshlrev_b32 v23, 1, v23
    v_xor_b32 v22, v22, v23
    v_cmp_gt_u32 s[68:69], s66, v22
    v_lshl_add_u32 v22, v22, 4, s62
    v_add_u32 v21, s63, v21
    v_subrev_u32 v22, 1024, v22
    v_mad_u32_u24 v12, v21, s65, v22
    v_mad_u32_u24 v23, v21, s64, v22
    v_mov_b32 v24, 0x40000000
    v_cndmask_b32 v9, v24, v23, s[68:69]
    v_add_u32 v20, 128, v1
    v_mul_u32_u24 v21, 683, v20
    v_lshrrev_b32 v21, 13, v21
    v_mul_u32_u24 v22, 12, v21
    v_sub_u32 v22, v20, v22
    v_bfe_u32 v23, v21, 3, 1
    v_lshlrev_b32 v23, 1, v23
    v_xor_b32 v22, v22, v23
    v_cmp_gt_u32 s[68:69], s66, v22
    v_lshl_add_u32 v22, v22, 4, s62
    v_add_u32 v21, s63, v21
    v_subrev_u32 v22, 2048, v22
    v_mad_u32_u24 v13, v21, s65, v22
    v_mad_u32_u24 v23, v21, s64, v22
    v_mov_b32 v24, 0x40000000
    v_cndmask_b32 v10, v24, v23, s[68:69]
    s_mov_b32 s28, s12
    s_mov_b32 s29, s13
    s_mov_b32 s30, 1409024
    s_mov_b32 s31, 0x20000
    s_mov_b32 s32, s14
    s_mov_b32 s33, s15
    s_mov_b32 s34, 1409024
    s_mov_b32 s35, 0x20000
    s_mov_b32 s44, s20
    s_mov_b32 s45, s21
    s_mov_b32 s46, 256
    s_mov_b32 s47, 0x20000
    s_cmp_eq_u32 s54, 15
    s_cselect_b32 s30, 0, s30
    s_cselect_b32 s34, 0, s34
    v_and_b32 v20, 15, v1
    v_lshrrev_b32 v21, 4, v1
    v_lshrrev_b32 v22, 1, v20
    v_xor_b32 v22, v22, v21
    v_lshlrev_b32 v22, 4, v22
    v_lshl_add_u32 v22, v20, 7, v22
    s_lshl_b32 s60, s52, 14
    v_add_u32 v6, s60, v22
    v_xor_b32 v7, 64, v6
    v_bfe_u32 v20, v1, 2, 2
    v_lshl_add_u32 v20, v21, 3, v20
    v_mul_u32_u24 v20, 192, v20
    v_and_b32 v22, 3, v1
    v_lshl_add_u32 v20, v22, 3, v20
    v_and_b32 v22, 1, v21
    v_lshlrev_b32 v22, 5, v22
    v_add_u32 v23, v20, v22
    v_sub_u32 v24, v20, v22
    v_add_u32 v240, 0, v23
    v_add_u32 v241, 0, v24
    v_add_u32 v242, 65536, v23
    v_add_u32 v243, 65536, v24
    v_add_u32 v244, 126976, v23
    v_add_u32 v245, 126976, v24
    s_add_u32 s3, s55, 0
    s_and_b32 s3, s3, 7
    s_mul_i32 s4, s3, 176128
    s_add_u32 s3, s55, 1
    s_and_b32 s3, s3, 7
    s_mul_i32 s5, s3, 176128
    s_add_u32 s3, s55, 2
    s_and_b32 s3, s3, 7
    s_mul_i32 s6, s3, 176128
    s_add_u32 s3, s55, 3
    s_and_b32 s3, s3, 7
    s_mul_i32 s7, s3, 176128
    s_add_u32 s3, s55, 4
    s_and_b32 s3, s3, 7
    s_mul_i32 s12, s3, 176128
    s_add_u32 s3, s55, 5
    s_and_b32 s3, s3, 7
    s_mul_i32 s13, s3, 176128
    s_add_u32 s3, s55, 6
    s_and_b32 s3, s3, 7
    s_mul_i32 s14, s3, 176128
    s_add_u32 s3, s55, 7
    s_and_b32 s3, s3, 7
    s_mul_i32 s15, s3, 176128
    s_add_u32 s3, s55, 4
    s_and_b32 s3, s3, 7
    s_mul_i32 s62, s3, 196608
    s_add_u32 s3, s55, 5
    s_and_b32 s3, s3, 7
    s_mul_i32 s63, s3, 196608
    s_add_u32 s3, s55, 6
    s_and_b32 s3, s3, 7
    s_mul_i32 s65, s3, 196608
    s_add_u32 s3, s55, 7
    s_and_b32 s3, s3, 7
    s_mul_i32 s61, s3, 196608
    v_and_b32 v20, 31, v1
    v_lshrrev_b32 v21, 5, v1
    v_lshlrev_b32 v21, 2, v21
    v_sub_u32 v20, v20, v21
    v_cmp_le_i32 s[70:71], 0, v20
    v_cmp_le_i32 s[72:73], 1, v20
    v_cmp_le_i32 s[74:75], 2, v20
    v_cmp_le_i32 s[76:77], 3, v20
    v_cmp_le_i32 s[78:79], 8, v20
    v_cmp_le_i32 s[80:81], 9, v20
    v_cmp_le_i32 s[82:83], 10, v20
    v_cmp_le_i32 s[84:85], 11, v20
    v_cmp_le_i32 s[86:87], 16, v20
    v_cmp_le_i32 s[88:89], 17, v20
    v_cmp_le_i32 s[90:91], 18, v20
    v_cmp_le_i32 s[92:93], 19, v20
    v_cmp_le_i32 s[94:95], 24, v20
    v_cmp_le_i32 s[96:97], 25, v20
    v_cmp_le_i32 s[98:99], 26, v20
    v_cmp_le_i32 s[100:101], 27, v20
    s_add_u32 s60, s55, 3
    s_and_b32 s60, s60, 7
    s_lshl_b32 s60, s60, 7
    s_lshl_b32 m0, s52, 14
    s_add_u32 m0, m0, 12288
    s_add_u32 s60, s60, s58
    buffer_load_dwordx4 v2, s[24:27], s60 offen offset:0 lds
    buffer_load_dwordx4 v3, s[24:27], s60 offen offset:1024 lds
    buffer_load_dwordx4 v4, s[24:27], s60 offen offset:2048 lds
    buffer_load_dwordx4 v5, s[24:27], s60 offen offset:3072 lds
    v_mov_b32 v176, 0x3afe3f80
    v_mov_b32 v180, 0x3f803f80
    v_cmp_gt_u32 s[68:69], 32, v1
    v_mov_b32 v177, 0
    v_mov_b32 v181, 0
    v_mov_b32 v178, 0
    v_mov_b32 v182, 0
    v_mov_b32 v179, 0
    v_mov_b32 v183, 0
    v_cndmask_b32 v176, 0, v176, s[68:69]
    s_nop 1
    v_mfma_f32_32x32x16_bf16 a[48:63], v[176:179], v[180:183], 0
    v_mfma_f32_32x32x16_bf16 a[64:79], v[176:179], v[180:183], 0
    v_mfma_f32_32x32x16_bf16 a[80:95], v[176:179], v[180:183], 0
    v_mfma_f32_32x32x16_bf16 a[96:111], v[176:179], v[180:183], 0
    v_mfma_f32_32x32x16_bf16 a[112:127], v[176:179], v[180:183], 0
    v_mov_b32 v216, 0
    v_mov_b32 v184, 0x3f803f80
    v_mov_b32 v217, 0
    v_mov_b32 v185, 0x3f803f80
    v_mov_b32 v218, 0
    v_mov_b32 v186, 0x3f803f80
    v_mov_b32 v219, 0
    v_mov_b32 v187, 0x3f803f80
    v_lshrrev_b32 v20, 4, v1
    v_bfe_u32 v21, v1, 2, 2
    v_xor_b32 v20, v20, v21
    v_and_b32 v21, 2, v1
    v_lshl_add_u32 v20, v20, 2, v21
    v_and_b32 v21, 1, v1
    v_lshlrev_b32 v21, 4, v21
    v_mov_b32 v22, 0x3f80
    v_lshlrev_b32 v21, v21, v22
    v_cmp_eq_u32 s[68:69], 0, v20
    v_cmp_eq_u32 vcc, 2, v20
    v_mov_b32 v188, 0
    v_mov_b32 v189, 0
    v_mov_b32 v192, 0
    v_mov_b32 v193, 0
    v_cndmask_b32 v190, 0, v21, s[68:69]
    v_cndmask_b32_e64 v191, 0, v21, vcc
    s_waitcnt vmcnt(12)
    ds_read_b128 v[16:19], v6 offset:0
    ds_read_b128 v[20:23], v6 offset:2048
    ds_read_b128 v[24:27], v7 offset:0
    ds_read_b128 v[28:31], v7 offset:2048
    s_waitcnt lgkmcnt(0)
    s_add_u32 s60, s55, 4
    s_and_b32 s60, s60, 7
    s_lshl_b32 s60, s60, 7
    s_lshl_b32 m0, s52, 14
    s_add_u32 m0, m0, 0
    s_add_u32 s60, s60, s58
    buffer_load_dwordx4 v2, s[24:27], s60 offen offset:0 lds
    buffer_load_dwordx4 v3, s[24:27], s60 offen offset:1024 lds
    buffer_load_dwordx4 v4, s[24:27], s60 offen offset:2048 lds
    buffer_load_dwordx4 v5, s[24:27], s60 offen offset:3072 lds
    s_waitcnt vmcnt(12)
    ds_read_b128 v[32:35], v6 offset:4096
    ds_read_b128 v[36:39], v6 offset:6144
    ds_read_b128 v[40:43], v7 offset:4096
    ds_read_b128 v[44:47], v7 offset:6144
    v_dot2c_f32_bf16 v216, v16, v16
    v_dot2c_f32_bf16 v217, v17, v17
    v_dot2c_f32_bf16 v216, v18, v18
    v_dot2c_f32_bf16 v217, v19, v19
    v_dot2c_f32_bf16 v218, v20, v20
    v_dot2c_f32_bf16 v219, v21, v21
    v_dot2c_f32_bf16 v218, v22, v22
    v_dot2c_f32_bf16 v219, v23, v23
    v_dot2c_f32_bf16 v216, v24, v24
    v_dot2c_f32_bf16 v217, v25, v25
    v_dot2c_f32_bf16 v216, v26, v26
    v_dot2c_f32_bf16 v217, v27, v27
    v_dot2c_f32_bf16 v218, v28, v28
    v_dot2c_f32_bf16 v219, v29, v29
    v_dot2c_f32_bf16 v218, v30, v30
    v_dot2c_f32_bf16 v219, v31, v31
    v_mfma_f32_16x16x32_bf16 v[228:231], v[184:187], v[16:19], 0
    v_mfma_f32_16x16x32_bf16 v[232:235], v[184:187], v[20:23], 0
    v_mfma_f32_16x16x32_bf16 v[228:231], v[184:187], v[24:27], v[228:231]
    v_mfma_f32_16x16x32_bf16 v[232:235], v[184:187], v[28:31], v[232:235]
    s_waitcnt lgkmcnt(0)
    s_add_u32 s60, s55, 5
    s_and_b32 s60, s60, 7
    s_lshl_b32 s60, s60, 7
    s_lshl_b32 m0, s52, 14
    s_add_u32 m0, m0, 4096
    s_add_u32 s60, s60, s58
    buffer_load_dwordx4 v2, s[24:27], s60 offen offset:0 lds
    buffer_load_dwordx4 v3, s[24:27], s60 offen offset:1024 lds
    buffer_load_dwordx4 v4, s[24:27], s60 offen offset:2048 lds
    buffer_load_dwordx4 v5, s[24:27], s60 offen offset:3072 lds
    s_waitcnt vmcnt(12)
    ds_read_b128 v[48:51], v6 offset:8192
    ds_read_b128 v[52:55], v6 offset:10240
    ds_read_b128 v[56:59], v7 offset:8192
    ds_read_b128 v[60:63], v7 offset:10240
    v_dot2c_f32_bf16 v216, v32, v32
    v_dot2c_f32_bf16 v217, v33, v33
    v_dot2c_f32_bf16 v216, v34, v34
    v_dot2c_f32_bf16 v217, v35, v35
    v_dot2c_f32_bf16 v218, v36, v36
    v_dot2c_f32_bf16 v219, v37, v37
    v_dot2c_f32_bf16 v218, v38, v38
    v_dot2c_f32_bf16 v219, v39, v39
    v_dot2c_f32_bf16 v216, v40, v40
    v_dot2c_f32_bf16 v217, v41, v41
    v_dot2c_f32_bf16 v216, v42, v42
    v_dot2c_f32_bf16 v217, v43, v43
    v_dot2c_f32_bf16 v218, v44, v44
    v_dot2c_f32_bf16 v219, v45, v45
    v_dot2c_f32_bf16 v218, v46, v46
    v_dot2c_f32_bf16 v219, v47, v47
    v_mfma_f32_16x16x32_bf16 v[228:231], v[184:187], v[32:35], v[228:231]
    v_mfma_f32_16x16x32_bf16 v[232:235], v[184:187], v[36:39], v[232:235]
    v_mfma_f32_16x16x32_bf16 v[228:231], v[184:187], v[40:43], v[228:231]
    v_mfma_f32_16x16x32_bf16 v[232:235], v[184:187], v[44:47], v[232:235]
    s_waitcnt lgkmcnt(0)
    s_add_u32 s60, s55, 6
    s_and_b32 s60, s60, 7
    s_lshl_b32 s60, s60, 7
    s_lshl_b32 m0, s52, 14
    s_add_u32 m0, m0, 8192
    s_add_u32 s60, s60, s58
    buffer_load_dwordx4 v2, s[24:27], s60 offen offset:0 lds
    buffer_load_dwordx4 v3, s[24:27], s60 offen offset:1024 lds
    buffer_load_dwordx4 v4, s[24:27], s60 offen offset:2048 lds
    buffer_load_dwordx4 v5, s[24:27], s60 offen offset:3072 lds
    s_waitcnt vmcnt(12)
    ds_read_b128 v[64:67], v6 offset:12288
    ds_read_b128 v[68:71], v6 offset:14336
    ds_read_b128 v[72:75], v7 offset:12288
    ds_read_b128 v[76:79], v7 offset:14336
    s_or_b32 s60, s2, s52
    s_cmp_lg_u32 s60, 0
    s_cbranch_scc1 Lnn_2
    v_add_u32 v252, 1, v254
    v_mov_b32 v253, 1
    s_mov_b32 s60, 16252928
    s_mov_b64 exec, 1
    buffer_store_dwordx2 v[252:253], off, s[44:47], 0 sc1
    buffer_store_dword v252, off, s[40:43], s60 sc1
    s_mov_b64 exec, -1
Lnn_2:
    v_dot2c_f32_bf16 v216, v48, v48
    v_dot2c_f32_bf16 v217, v49, v49
    v_dot2c_f32_bf16 v216, v50, v50
    v_dot2c_f32_bf16 v217, v51, v51
    v_dot2c_f32_bf16 v218, v52, v52
    v_dot2c_f32_bf16 v219, v53, v53
    v_dot2c_f32_bf16 v218, v54, v54
    v_dot2c_f32_bf16 v219, v55, v55
    v_dot2c_f32_bf16 v216, v56, v56
    v_dot2c_f32_bf16 v217, v57, v57
    v_dot2c_f32_bf16 v216, v58, v58
    v_dot2c_f32_bf16 v217, v59, v59
    v_dot2c_f32_bf16 v218, v60, v60
    v_dot2c_f32_bf16 v219, v61, v61
    v_dot2c_f32_bf16 v218, v62, v62
    v_dot2c_f32_bf16 v219, v63, v63
    v_mfma_f32_16x16x32_bf16 v[228:231], v[184:187], v[48:51], v[228:231]
    v_mfma_f32_16x16x32_bf16 v[232:235], v[184:187], v[52:55], v[232:235]
    v_mfma_f32_16x16x32_bf16 v[228:231], v[184:187], v[56:59], v[228:231]
    v_mfma_f32_16x16x32_bf16 v[232:235], v[184:187], v[60:63], v[232:235]
    s_waitcnt lgkmcnt(0)
    s_add_u32 s60, s55, 7
    s_and_b32 s60, s60, 7
    s_lshl_b32 s60, s60, 7
    s_lshl_b32 m0, s52, 14
    s_add_u32 m0, m0, 12288
    s_add_u32 s60, s60, s58
    buffer_load_dwordx4 v2, s[24:27], s60 offen offset:0 lds
    buffer_load_dwordx4 v3, s[24:27], s60 offen offset:1024 lds
    buffer_load_dwordx4 v4, s[24:27], s60 offen offset:2048 lds
    buffer_load_dwordx4 v5, s[24:27], s60 offen offset:3072 lds
    s_waitcnt vmcnt(12)
    ds_read_b128 v[80:83], v6 offset:0
    ds_read_b128 v[84:87], v6 offset:2048
    ds_read_b128 v[88:91], v7 offset:0
    ds_read_b128 v[92:95], v7 offset:2048
    v_dot2c_f32_bf16 v216, v64, v64
    v_dot2c_f32_bf16 v217, v65, v65
    v_dot2c_f32_bf16 v216, v66, v66
    v_dot2c_f32_bf16 v217, v67, v67
    v_dot2c_f32_bf16 v218, v68, v68
    v_dot2c_f32_bf16 v219, v69, v69
    v_dot2c_f32_bf16 v218, v70, v70
    v_dot2c_f32_bf16 v219, v71, v71
    v_dot2c_f32_bf16 v216, v72, v72
    v_dot2c_f32_bf16 v217, v73, v73
    v_dot2c_f32_bf16 v216, v74, v74
    v_dot2c_f32_bf16 v217, v75, v75
    v_dot2c_f32_bf16 v218, v76, v76
    v_dot2c_f32_bf16 v219, v77, v77
    v_dot2c_f32_bf16 v218, v78, v78
    v_dot2c_f32_bf16 v219, v79, v79
    v_mfma_f32_16x16x32_bf16 v[228:231], v[184:187], v[64:67], v[228:231]
    v_mfma_f32_16x16x32_bf16 v[232:235], v[184:187], v[68:71], v[232:235]
    v_mfma_f32_16x16x32_bf16 v[228:231], v[184:187], v[72:75], v[228:231]
    v_mfma_f32_16x16x32_bf16 v[232:235], v[184:187], v[76:79], v[232:235]
    s_waitcnt vmcnt(8)
    ds_read_b128 v[96:99], v6 offset:4096
    ds_read_b128 v[100:103], v6 offset:6144
    ds_read_b128 v[104:107], v7 offset:4096
    ds_read_b128 v[108:111], v7 offset:6144
    s_waitcnt lgkmcnt(7)
    v_dot2c_f32_bf16 v216, v80, v80
    v_dot2c_f32_bf16 v217, v81, v81
    v_dot2c_f32_bf16 v216, v82, v82
    v_dot2c_f32_bf16 v217, v83, v83
    s_waitcnt lgkmcnt(6)
    v_dot2c_f32_bf16 v218, v84, v84
    v_dot2c_f32_bf16 v219, v85, v85
    v_dot2c_f32_bf16 v218, v86, v86
    v_dot2c_f32_bf16 v219, v87, v87
    s_waitcnt lgkmcnt(5)
    v_dot2c_f32_bf16 v216, v88, v88
    v_dot2c_f32_bf16 v217, v89, v89
    v_dot2c_f32_bf16 v216, v90, v90
    v_dot2c_f32_bf16 v217, v91, v91
    s_waitcnt lgkmcnt(4)
    v_dot2c_f32_bf16 v218, v92, v92
    v_dot2c_f32_bf16 v219, v93, v93
    v_dot2c_f32_bf16 v218, v94, v94
    v_dot2c_f32_bf16 v219, v95, v95
    v_mfma_f32_16x16x32_bf16 v[228:231], v[184:187], v[80:83], v[228:231]
    v_mfma_f32_16x16x32_bf16 v[232:235], v[184:187], v[84:87], v[232:235]
    v_mfma_f32_16x16x32_bf16 v[228:231], v[184:187], v[88:91], v[228:231]
    v_mfma_f32_16x16x32_bf16 v[232:235], v[184:187], v[92:95], v[232:235]
    s_waitcnt vmcnt(4)
    ds_read_b128 v[112:115], v6 offset:8192
    ds_read_b128 v[116:119], v6 offset:10240
    ds_read_b128 v[120:123], v7 offset:8192
    ds_read_b128 v[124:127], v7 offset:10240
    s_waitcnt lgkmcnt(7)
    v_dot2c_f32_bf16 v216, v96, v96
    v_dot2c_f32_bf16 v217, v97, v97
    v_dot2c_f32_bf16 v216, v98, v98
    v_dot2c_f32_bf16 v217, v99, v99
    s_waitcnt lgkmcnt(6)
    v_dot2c_f32_bf16 v218, v100, v100
    v_dot2c_f32_bf16 v219, v101, v101
    v_dot2c_f32_bf16 v218, v102, v102
    v_dot2c_f32_bf16 v219, v103, v103
    s_waitcnt lgkmcnt(5)
    v_dot2c_f32_bf16 v216, v104, v104
    v_dot2c_f32_bf16 v217, v105, v105
    v_dot2c_f32_bf16 v216, v106, v106
    v_dot2c_f32_bf16 v217, v107, v107
    s_waitcnt lgkmcnt(4)
    v_dot2c_f32_bf16 v218, v108, v108
    v_dot2c_f32_bf16 v219, v109, v109
    v_dot2c_f32_bf16 v218, v110, v110
    v_dot2c_f32_bf16 v219, v111, v111
    v_mfma_f32_16x16x32_bf16 v[228:231], v[184:187], v[96:99], v[228:231]
    v_mfma_f32_16x16x32_bf16 v[232:235], v[184:187], v[100:103], v[232:235]
    v_mfma_f32_16x16x32_bf16 v[228:231], v[184:187], v[104:107], v[228:231]
    v_mfma_f32_16x16x32_bf16 v[232:235], v[184:187], v[108:111], v[232:235]
    s_add_u32 s60, s55, 0
    s_and_b32 s60, s60, 7
    s_add_u32 m0, s59, 65536
    s_mul_i32 s60, s60, 196608
    buffer_load_dwordx4 v11, s[36:39], s60 offen offset:0 nt lds
    buffer_load_dwordx4 v12, s[36:39], s60 offen offset:1024 nt lds
    buffer_load_dwordx4 v13, s[36:39], s60 offen offset:2048 nt lds
    s_waitcnt vmcnt(3)
    ds_read_b128 v[128:131], v6 offset:12288
    ds_read_b128 v[132:135], v6 offset:14336
    ds_read_b128 v[136:139], v7 offset:12288
    ds_read_b128 v[140:143], v7 offset:14336
    s_waitcnt lgkmcnt(7)
    v_dot2c_f32_bf16 v216, v112, v112
    v_dot2c_f32_bf16 v217, v113, v113
    v_dot2c_f32_bf16 v216, v114, v114
    v_dot2c_f32_bf16 v217, v115, v115
    s_waitcnt lgkmcnt(6)
    v_dot2c_f32_bf16 v218, v116, v116
    v_dot2c_f32_bf16 v219, v117, v117
    v_dot2c_f32_bf16 v218, v118, v118
    v_dot2c_f32_bf16 v219, v119, v119
    s_waitcnt lgkmcnt(5)
    v_dot2c_f32_bf16 v216, v120, v120
    v_dot2c_f32_bf16 v217, v121, v121
    v_dot2c_f32_bf16 v216, v122, v122
    v_dot2c_f32_bf16 v217, v123, v123
    s_waitcnt lgkmcnt(4)
    v_dot2c_f32_bf16 v218, v124, v124
    v_dot2c_f32_bf16 v219, v125, v125
    v_dot2c_f32_bf16 v218, v126, v126
    v_dot2c_f32_bf16 v219, v127, v127
    v_mfma_f32_16x16x32_bf16 v[228:231], v[184:187], v[112:115], v[228:231]
    v_mfma_f32_16x16x32_bf16 v[232:235], v[184:187], v[116:119], v[232:235]
    v_mfma_f32_16x16x32_bf16 v[228:231], v[184:187], v[120:123], v[228:231]
    v_mfma_f32_16x16x32_bf16 v[232:235], v[184:187], v[124:127], v[232:235]
    s_add_u32 s60, s55, 1
    s_and_b32 s60, s60, 7
    s_add_u32 m0, s59, 77824
    s_mul_i32 s60, s60, 196608
    buffer_load_dwordx4 v11, s[36:39], s60 offen offset:0 lds
    buffer_load_dwordx4 v12, s[36:39], s60 offen offset:1024 lds
    buffer_load_dwordx4 v13, s[36:39], s60 offen offset:2048 lds
    s_waitcnt lgkmcnt(3)
    v_mfma_f32_16x16x32_bf16 v[228:231], v[184:187], v[128:131], v[228:231]
    s_waitcnt lgkmcnt(2)
    v_mfma_f32_16x16x32_bf16 v[232:235], v[184:187], v[132:135], v[232:235]
    s_waitcnt lgkmcnt(1)
    v_mfma_f32_16x16x32_bf16 v[228:231], v[184:187], v[136:139], v[228:231]
    s_waitcnt lgkmcnt(0)
    v_mfma_f32_16x16x32_bf16 v[232:235], v[184:187], v[140:143], v[232:235]
    v_dot2c_f32_bf16 v216, v128, v128
    v_dot2c_f32_bf16 v217, v129, v129
    v_dot2c_f32_bf16 v216, v130, v130
    v_dot2c_f32_bf16 v217, v131, v131
    v_dot2c_f32_bf16 v218, v132, v132
    v_dot2c_f32_bf16 v219, v133, v133
    v_dot2c_f32_bf16 v218, v134, v134
    v_dot2c_f32_bf16 v219, v135, v135
    v_dot2c_f32_bf16 v216, v136, v136
    v_dot2c_f32_bf16 v217, v137, v137
    v_dot2c_f32_bf16 v216, v138, v138
    v_dot2c_f32_bf16 v217, v139, v139
    v_dot2c_f32_bf16 v218, v140, v140
    v_dot2c_f32_bf16 v219, v141, v141
    v_dot2c_f32_bf16 v218, v142, v142
    v_dot2c_f32_bf16 v219, v143, v143
    v_mul_f32 v220, 0xbb000000, v228
    v_mul_f32 v221, 0xbb000000, v229
    v_mul_f32 v222, 0xbb000000, v230
    v_mul_f32 v223, 0xbb000000, v231
    v_mul_f32 v224, 0xbb000000, v232
    v_mul_f32 v225, 0xbb000000, v233
    v_mul_f32 v226, 0xbb000000, v234
    v_mul_f32 v227, 0xbb000000, v235
.p2align 3
    v_mfma_f32_16x16x32_bf16 v[144:147], v[190:193], v[16:19], v[220:223]
    v_mfma_f32_16x16x32_bf16 v[148:151], v[188:191], v[16:19], v[220:223]
    v_mfma_f32_16x16x32_bf16 v[152:155], v[190:193], v[20:23], v[224:227]
    v_mfma_f32_16x16x32_bf16 v[156:159], v[188:191], v[20:23], v[224:227]
    v_mfma_f32_16x16x32_bf16 v[160:163], v[190:193], v[24:27], v[220:223]
    s_nop 3
    v_cvt_pk_bf16_f32 v16, v144, v145
    v_cvt_pk_bf16_f32 v17, v146, v147
    v_mfma_f32_16x16x32_bf16 v[164:167], v[188:191], v[24:27], v[220:223]
    v_cvt_pk_bf16_f32 v18, v148, v149
    v_cvt_pk_bf16_f32 v19, v150, v151
    v_mfma_f32_16x16x32_bf16 v[168:171], v[190:193], v[28:31], v[224:227]
    v_cvt_pk_bf16_f32 v20, v152, v153
    v_cvt_pk_bf16_f32 v21, v154, v155
    v_mfma_f32_16x16x32_bf16 v[172:175], v[188:191], v[28:31], v[224:227]
    v_cvt_pk_bf16_f32 v22, v156, v157
    v_cvt_pk_bf16_f32 v23, v158, v159
    v_mfma_f32_16x16x32_bf16 v[144:147], v[190:193], v[32:35], v[220:223]
    v_cvt_pk_bf16_f32 v24, v160, v161
    v_cvt_pk_bf16_f32 v25, v162, v163
    v_mfma_f32_16x16x32_bf16 v[148:151], v[188:191], v[32:35], v[220:223]
    v_cvt_pk_bf16_f32 v26, v164, v165
    s_add_u32 s60, s55, 2
    s_and_b32 s60, s60, 7
    s_add_u32 m0, s59, 90112
    s_mul_i32 s60, s60, 196608
.p2align 3
    v_cvt_pk_bf16_f32 v27, v166, v167
    v_mfma_f32_16x16x32_bf16 v[152:155], v[190:193], v[36:39], v[224:227]
    v_cvt_pk_bf16_f32 v28, v168, v169
    v_cvt_pk_bf16_f32 v29, v170, v171
    v_mfma_f32_16x16x32_bf16 v[156:159], v[188:191], v[36:39], v[224:227]
    v_cvt_pk_bf16_f32 v30, v172, v173
    v_cvt_pk_bf16_f32 v31, v174, v175
    v_mfma_f32_16x16x32_bf16 v[160:163], v[190:193], v[40:43], v[220:223]
    v_cvt_pk_bf16_f32 v32, v144, v145
    v_cvt_pk_bf16_f32 v33, v146, v147
    v_mfma_f32_16x16x32_bf16 v[164:167], v[188:191], v[40:43], v[220:223]
    v_cvt_pk_bf16_f32 v34, v148, v149
    v_cvt_pk_bf16_f32 v35, v150, v151
    v_mfma_f32_16x16x32_bf16 v[168:171], v[190:193], v[44:47], v[224:227]
    v_cvt_pk_bf16_f32 v36, v152, v153
    v_cvt_pk_bf16_f32 v37, v154, v155
    v_mfma_f32_16x16x32_bf16 v[172:175], v[188:191], v[44:47], v[224:227]
    v_cvt_pk_bf16_f32 v38, v156, v157
    v_cvt_pk_bf16_f32 v39, v158, v159
    v_mfma_f32_16x16x32_bf16 v[144:147], v[190:193], v[48:51], v[220:223]
    v_cvt_pk_bf16_f32 v40, v160, v161
    buffer_load_dwordx4 v11, s[36:39], s60 offen offset:0 lds
.p2align 3
    v_cvt_pk_bf16_f32 v41, v162, v163
    v_mfma_f32_16x16x32_bf16 v[148:151], v[188:191], v[48:51], v[220:223]
    v_cvt_pk_bf16_f32 v42, v164, v165
    v_cvt_pk_bf16_f32 v43, v166, v167
    v_mfma_f32_16x16x32_bf16 v[152:155], v[190:193], v[52:55], v[224:227]
    v_cvt_pk_bf16_f32 v44, v168, v169
    v_cvt_pk_bf16_f32 v45, v170, v171
    v_mfma_f32_16x16x32_bf16 v[156:159], v[188:191], v[52:55], v[224:227]
    v_cvt_pk_bf16_f32 v46, v172, v173
    v_cvt_pk_bf16_f32 v47, v174, v175
    v_mfma_f32_16x16x32_bf16 v[160:163], v[190:193], v[56:59], v[220:223]
    v_cvt_pk_bf16_f32 v48, v144, v145
    v_cvt_pk_bf16_f32 v49, v146, v147
    v_mfma_f32_16x16x32_bf16 v[164:167], v[188:191], v[56:59], v[220:223]
    v_cvt_pk_bf16_f32 v50, v148, v149
    v_cvt_pk_bf16_f32 v51, v150, v151
    v_mfma_f32_16x16x32_bf16 v[168:171], v[190:193], v[60:63], v[224:227]
    v_cvt_pk_bf16_f32 v52, v152, v153
    v_cvt_pk_bf16_f32 v53, v154, v155
    v_mfma_f32_16x16x32_bf16 v[172:175], v[188:191], v[60:63], v[224:227]
    v_cvt_pk_bf16_f32 v54, v156, v157
    buffer_load_dwordx4 v12, s[36:39], s60 offen offset:1024 lds
.p2align 3
    v_cvt_pk_bf16_f32 v55, v158, v159
    v_mfma_f32_16x16x32_bf16 v[144:147], v[190:193], v[64:67], v[220:223]
    v_cvt_pk_bf16_f32 v56, v160, v161
    v_cvt_pk_bf16_f32 v57, v162, v163
    v_mfma_f32_16x16x32_bf16 v[148:151], v[188:191], v[64:67], v[220:223]
    v_cvt_pk_bf16_f32 v58, v164, v165
    v_cvt_pk_bf16_f32 v59, v166, v167
    v_mfma_f32_16x16x32_bf16 v[152:155], v[190:193], v[68:71], v[224:227]
    v_cvt_pk_bf16_f32 v60, v168, v169
    v_cvt_pk_bf16_f32 v61, v170, v171
    v_mfma_f32_16x16x32_bf16 v[156:159], v[188:191], v[68:71], v[224:227]
    v_cvt_pk_bf16_f32 v62, v172, v173
    v_cvt_pk_bf16_f32 v63, v174, v175
    v_mfma_f32_16x16x32_bf16 v[160:163], v[190:193], v[72:75], v[220:223]
    v_cvt_pk_bf16_f32 v64, v144, v145
    v_cvt_pk_bf16_f32 v65, v146, v147
    v_mfma_f32_16x16x32_bf16 v[164:167], v[188:191], v[72:75], v[220:223]
    v_cvt_pk_bf16_f32 v66, v148, v149
    v_cvt_pk_bf16_f32 v67, v150, v151
    v_mfma_f32_16x16x32_bf16 v[168:171], v[190:193], v[76:79], v[224:227]
    v_cvt_pk_bf16_f32 v68, v152, v153
    buffer_load_dwordx4 v13, s[36:39], s60 offen offset:2048 lds
.p2align 3
    v_cvt_pk_bf16_f32 v69, v154, v155
    v_mfma_f32_16x16x32_bf16 v[172:175], v[188:191], v[76:79], v[224:227]
    v_cvt_pk_bf16_f32 v70, v156, v157
    v_cvt_pk_bf16_f32 v71, v158, v159
    v_mfma_f32_16x16x32_bf16 v[144:147], v[190:193], v[80:83], v[220:223]
    v_cvt_pk_bf16_f32 v72, v160, v161
    v_cvt_pk_bf16_f32 v73, v162, v163
    v_mfma_f32_16x16x32_bf16 v[148:151], v[188:191], v[80:83], v[220:223]
    v_cvt_pk_bf16_f32 v74, v164, v165
    v_cvt_pk_bf16_f32 v75, v166, v167
    v_mfma_f32_16x16x32_bf16 v[152:155], v[190:193], v[84:87], v[224:227]
    v_cvt_pk_bf16_f32 v76, v168, v169
    v_cvt_pk_bf16_f32 v77, v170, v171
    v_mfma_f32_16x16x32_bf16 v[156:159], v[188:191], v[84:87], v[224:227]
    v_cvt_pk_bf16_f32 v78, v172, v173
    v_cvt_pk_bf16_f32 v79, v174, v175
    v_mfma_f32_16x16x32_bf16 v[160:163], v[190:193], v[88:91], v[220:223]
    v_cvt_pk_bf16_f32 v80, v144, v145
    v_cvt_pk_bf16_f32 v81, v146, v147
    v_mfma_f32_16x16x32_bf16 v[164:167], v[188:191], v[88:91], v[220:223]
    v_cvt_pk_bf16_f32 v82, v148, v149
    s_add_u32 s60, s55, 3
    s_and_b32 s60, s60, 7
    s_add_u32 m0, s59, 102400
    s_mul_i32 s60, s60, 196608
.p2align 3
    v_cvt_pk_bf16_f32 v83, v150, v151
    v_mfma_f32_16x16x32_bf16 v[168:171], v[190:193], v[92:95], v[224:227]
    v_cvt_pk_bf16_f32 v84, v152, v153
    v_cvt_pk_bf16_f32 v85, v154, v155
    v_mfma_f32_16x16x32_bf16 v[172:175], v[188:191], v[92:95], v[224:227]
    v_cvt_pk_bf16_f32 v86, v156, v157
    v_cvt_pk_bf16_f32 v87, v158, v159
    v_mfma_f32_16x16x32_bf16 v[144:147], v[190:193], v[96:99], v[220:223]
    v_cvt_pk_bf16_f32 v88, v160, v161
    v_cvt_pk_bf16_f32 v89, v162, v163
    v_mfma_f32_16x16x32_bf16 v[148:151], v[188:191], v[96:99], v[220:223]
    v_cvt_pk_bf16_f32 v90, v164, v165
    v_cvt_pk_bf16_f32 v91, v166, v167
    v_mfma_f32_16x16x32_bf16 v[152:155], v[190:193], v[100:103], v[224:227]
    v_cvt_pk_bf16_f32 v92, v168, v169
    v_cvt_pk_bf16_f32 v93, v170, v171
    v_mfma_f32_16x16x32_bf16 v[156:159], v[188:191], v[100:103], v[224:227]
    v_cvt_pk_bf16_f32 v94, v172, v173
    v_cvt_pk_bf16_f32 v95, v174, v175
    v_mfma_f32_16x16x32_bf16 v[160:163], v[190:193], v[104:107], v[220:223]
    v_cvt_pk_bf16_f32 v96, v144, v145
    buffer_load_dwordx4 v11, s[36:39], s60 offen offset:0 lds
.p2align 3
    v_cvt_pk_bf16_f32 v97, v146, v147
    v_mfma_f32_16x16x32_bf16 v[164:167], v[188:191], v[104:107], v[220:223]
    v_cvt_pk_bf16_f32 v98, v148, v149
    v_cvt_pk_bf16_f32 v99, v150, v151
    v_mfma_f32_16x16x32_bf16 v[168:171], v[190:193], v[108:111], v[224:227]
    v_cvt_pk_bf16_f32 v100, v152, v153
    v_cvt_pk_bf16_f32 v101, v154, v155
    v_mfma_f32_16x16x32_bf16 v[172:175], v[188:191], v[108:111], v[224:227]
    v_cvt_pk_bf16_f32 v102, v156, v157
    v_cvt_pk_bf16_f32 v103, v158, v159
    v_mfma_f32_16x16x32_bf16 v[144:147], v[190:193], v[112:115], v[220:223]
    v_cvt_pk_bf16_f32 v104, v160, v161
    v_cvt_pk_bf16_f32 v105, v162, v163
    v_mfma_f32_16x16x32_bf16 v[148:151], v[188:191], v[112:115], v[220:223]
    v_cvt_pk_bf16_f32 v106, v164, v165
    v_cvt_pk_bf16_f32 v107, v166, v167
    v_mfma_f32_16x16x32_bf16 v[152:155], v[190:193], v[116:119], v[224:227]
    v_cvt_pk_bf16_f32 v108, v168, v169
    v_cvt_pk_bf16_f32 v109, v170, v171
    v_mfma_f32_16x16x32_bf16 v[156:159], v[188:191], v[116:119], v[224:227]
    v_cvt_pk_bf16_f32 v110, v172, v173
    buffer_load_dwordx4 v12, s[36:39], s60 offen offset:1024 lds
.p2align 3
    v_cvt_pk_bf16_f32 v111, v174, v175
    v_mfma_f32_16x16x32_bf16 v[160:163], v[190:193], v[120:123], v[220:223]
    v_cvt_pk_bf16_f32 v112, v144, v145
    v_cvt_pk_bf16_f32 v113, v146, v147
    v_mfma_f32_16x16x32_bf16 v[164:167], v[188:191], v[120:123], v[220:223]
    v_cvt_pk_bf16_f32 v114, v148, v149
    v_cvt_pk_bf16_f32 v115, v150, v151
    v_mfma_f32_16x16x32_bf16 v[168:171], v[190:193], v[124:127], v[224:227]
    v_cvt_pk_bf16_f32 v116, v152, v153
    v_cvt_pk_bf16_f32 v117, v154, v155
    v_mfma_f32_16x16x32_bf16 v[172:175], v[188:191], v[124:127], v[224:227]
    v_cvt_pk_bf16_f32 v118, v156, v157
    v_cvt_pk_bf16_f32 v119, v158, v159
    v_mfma_f32_16x16x32_bf16 v[144:147], v[190:193], v[128:131], v[220:223]
    v_cvt_pk_bf16_f32 v120, v160, v161
    v_cvt_pk_bf16_f32 v121, v162, v163
    v_mfma_f32_16x16x32_bf16 v[148:151], v[188:191], v[128:131], v[220:223]
    v_cvt_pk_bf16_f32 v122, v164, v165
    v_cvt_pk_bf16_f32 v123, v166, v167
    v_mfma_f32_16x16x32_bf16 v[152:155], v[190:193], v[132:135], v[224:227]
    v_cvt_pk_bf16_f32 v124, v168, v169
    buffer_load_dwordx4 v13, s[36:39], s60 offen offset:2048 lds
.p2align 3
    v_cvt_pk_bf16_f32 v125, v170, v171
    v_mfma_f32_16x16x32_bf16 v[156:159], v[188:191], v[132:135], v[224:227]
    v_cvt_pk_bf16_f32 v126, v172, v173
    v_cvt_pk_bf16_f32 v127, v174, v175
    v_mfma_f32_16x16x32_bf16 v[160:163], v[190:193], v[136:139], v[220:223]
    v_cvt_pk_bf16_f32 v128, v144, v145
    v_cvt_pk_bf16_f32 v129, v146, v147
    v_mfma_f32_16x16x32_bf16 v[164:167], v[188:191], v[136:139], v[220:223]
    v_cvt_pk_bf16_f32 v130, v148, v149
    v_cvt_pk_bf16_f32 v131, v150, v151
    v_mfma_f32_16x16x32_bf16 v[168:171], v[190:193], v[140:143], v[224:227]
    v_cvt_pk_bf16_f32 v132, v152, v153
    v_cvt_pk_bf16_f32 v133, v154, v155
    v_mfma_f32_16x16x32_bf16 v[172:175], v[188:191], v[140:143], v[224:227]
    v_cvt_pk_bf16_f32 v134, v156, v157
    v_cvt_pk_bf16_f32 v135, v158, v159
    v_cvt_pk_bf16_f32 v136, v160, v161
    v_cvt_pk_bf16_f32 v137, v162, v163
    v_cvt_pk_bf16_f32 v138, v164, v165
    v_cvt_pk_bf16_f32 v139, v166, v167
    v_cvt_pk_bf16_f32 v140, v168, v169
.p2align 3
    v_cvt_pk_bf16_f32 v141, v170, v171
    v_cvt_pk_bf16_f32 v142, v172, v173
    v_cvt_pk_bf16_f32 v143, v174, v175
    s_waitcnt vmcnt(6)
    s_barrier
    ds_read_b64_tr_b16 a[128:129], v242 offset:0
    ds_read_b64_tr_b16 a[130:131], v242 offset:768
    ds_read_b64_tr_b16 a[132:133], v243 offset:32
    ds_read_b64_tr_b16 a[134:135], v243 offset:800
    ds_read_b64_tr_b16 a[136:137], v242 offset:64
    ds_read_b64_tr_b16 a[138:139], v242 offset:832
    ds_read_b64_tr_b16 a[140:141], v243 offset:96
    ds_read_b64_tr_b16 a[142:143], v243 offset:864
    ds_read_b64_tr_b16 a[144:145], v242 offset:128
    ds_read_b64_tr_b16 a[146:147], v242 offset:896
    s_cmp_ge_u32 s54, 10
    s_cbranch_scc1 Lvsel
    s_waitcnt lgkmcnt(6)
    v_mfma_f32_16x16x32_bf16 v[144:147], a[128:131], v[16:19], 0
    ds_read_b64_tr_b16 a[148:149], v243 offset:160
    v_mfma_f32_16x16x32_bf16 v[148:151], a[128:131], v[20:23], 0
    ds_read_b64_tr_b16 a[150:151], v243 offset:928
    s_add_u32 m0, s59, 114688
    v_mfma_f32_16x16x32_bf16 v[152:155], a[132:135], v[16:19], 0
    ds_read_b64_tr_b16 a[128:129], v242 offset:6144
    v_mfma_f32_16x16x32_bf16 v[156:159], a[132:135], v[20:23], 0
    ds_read_b64_tr_b16 a[130:131], v242 offset:6912
    buffer_load_dwordx4 v11, s[36:39], s62 offen offset:0 lds
    s_waitcnt lgkmcnt(6)
    v_mfma_f32_16x16x32_bf16 v[160:163], a[136:139], v[16:19], 0
    ds_read_b64_tr_b16 a[132:133], v243 offset:6176
    v_mfma_f32_16x16x32_bf16 v[164:167], a[136:139], v[20:23], 0
    ds_read_b64_tr_b16 a[134:135], v243 offset:6944
    buffer_load_dwordx4 v12, s[36:39], s62 offen offset:1024 lds
    v_mfma_f32_16x16x32_bf16 v[168:171], a[140:143], v[16:19], 0
    ds_read_b64_tr_b16 a[136:137], v242 offset:6208
    v_mfma_f32_16x16x32_bf16 v[172:175], a[140:143], v[20:23], 0
    ds_read_b64_tr_b16 a[138:139], v242 offset:6976
    buffer_load_dwordx4 v13, s[36:39], s62 offen offset:2048 lds
    s_waitcnt lgkmcnt(6)
    v_mfma_f32_16x16x32_bf16 v[176:179], a[144:147], v[16:19], 0
    ds_read_b64_tr_b16 a[140:141], v243 offset:6240
    v_mfma_f32_16x16x32_bf16 v[180:183], a[144:147], v[20:23], 0
    ds_read_b64_tr_b16 a[142:143], v243 offset:7008
    s_add_u32 m0, s59, 126976
    v_mfma_f32_16x16x32_bf16 v[184:187], a[148:151], v[16:19], 0
    ds_read_b64_tr_b16 a[144:145], v242 offset:6272
    v_mfma_f32_16x16x32_bf16 v[188:191], a[148:151], v[20:23], 0
    ds_read_b64_tr_b16 a[146:147], v242 offset:7040
    buffer_load_dwordx4 v11, s[36:39], s63 offen offset:0 lds
    s_waitcnt lgkmcnt(6)
    v_mfma_f32_16x16x32_bf16 v[144:147], a[128:131], v[24:27], v[144:147]
    ds_read_b64_tr_b16 a[148:149], v243 offset:6304
    v_mfma_f32_16x16x32_bf16 v[148:151], a[128:131], v[28:31], v[148:151]
    ds_read_b64_tr_b16 a[150:151], v243 offset:7072
    buffer_load_dwordx4 v12, s[36:39], s63 offen offset:1024 lds
    v_mfma_f32_16x16x32_bf16 v[152:155], a[132:135], v[24:27], v[152:155]
    ds_read_b64_tr_b16 a[128:129], v242 offset:12288
    v_mfma_f32_16x16x32_bf16 v[156:159], a[132:135], v[28:31], v[156:159]
    ds_read_b64_tr_b16 a[130:131], v242 offset:13056
    buffer_load_dwordx4 v13, s[36:39], s63 offen offset:2048 lds
    s_waitcnt lgkmcnt(6)
    v_mfma_f32_16x16x32_bf16 v[160:163], a[136:139], v[24:27], v[160:163]
    ds_read_b64_tr_b16 a[132:133], v243 offset:12320
    v_mfma_f32_16x16x32_bf16 v[164:167], a[136:139], v[28:31], v[164:167]
    ds_read_b64_tr_b16 a[134:135], v243 offset:13088
    s_add_u32 m0, s59, 139264
    v_mfma_f32_16x16x32_bf16 v[168:171], a[140:143], v[24:27], v[168:171]
    ds_read_b64_tr_b16 a[136:137], v242 offset:12352
    v_mfma_f32_16x16x32_bf16 v[172:175], a[140:143], v[28:31], v[172:175]
    ds_read_b64_tr_b16 a[138:139], v242 offset:13120
    buffer_load_dwordx4 v11, s[36:39], s65 offen offset:0 lds
    s_waitcnt lgkmcnt(6)
    v_mfma_f32_16x16x32_bf16 v[176:179], a[144:147], v[24:27], v[176:179]
    ds_read_b64_tr_b16 a[140:141], v243 offset:12384
    v_mfma_f32_16x16x32_bf16 v[180:183], a[144:147], v[28:31], v[180:183]
    ds_read_b64_tr_b16 a[142:143], v243 offset:13152
    buffer_load_dwordx4 v12, s[36:39], s65 offen offset:1024 lds
    v_mfma_f32_16x16x32_bf16 v[184:187], a[148:151], v[24:27], v[184:187]
    ds_read_b64_tr_b16 a[144:145], v242 offset:12416
    v_mfma_f32_16x16x32_bf16 v[188:191], a[148:151], v[28:31], v[188:191]
    ds_read_b64_tr_b16 a[146:147], v242 offset:13184
    buffer_load_dwordx4 v13, s[36:39], s65 offen offset:2048 lds
    s_waitcnt lgkmcnt(6)
    v_mfma_f32_16x16x32_bf16 v[144:147], a[128:131], v[32:35], v[144:147]
    ds_read_b64_tr_b16 a[148:149], v243 offset:12448
    v_mfma_f32_16x16x32_bf16 v[148:151], a[128:131], v[36:39], v[148:151]
    ds_read_b64_tr_b16 a[150:151], v243 offset:13216
    s_add_u32 m0, s59, 151552
    v_mfma_f32_16x16x32_bf16 v[152:155], a[132:135], v[32:35], v[152:155]
    ds_read_b64_tr_b16 a[128:129], v242 offset:18432
    v_mfma_f32_16x16x32_bf16 v[156:159], a[132:135], v[36:39], v[156:159]
    ds_read_b64_tr_b16 a[130:131], v242 offset:19200
    buffer_load_dwordx4 v11, s[36:39], s61 offen offset:0 lds
    s_waitcnt lgkmcnt(6)
    v_mfma_f32_16x16x32_bf16 v[160:163], a[136:139], v[32:35], v[160:163]
    ds_read_b64_tr_b16 a[132:133], v243 offset:18464
    v_mfma_f32_16x16x32_bf16 v[164:167], a[136:139], v[36:39], v[164:167]
    ds_read_b64_tr_b16 a[134:135], v243 offset:19232
    buffer_load_dwordx4 v12, s[36:39], s61 offen offset:1024 lds
    v_mfma_f32_16x16x32_bf16 v[168:171], a[140:143], v[32:35], v[168:171]
    ds_read_b64_tr_b16 a[136:137], v242 offset:18496
    v_mfma_f32_16x16x32_bf16 v[172:175], a[140:143], v[36:39], v[172:175]
    ds_read_b64_tr_b16 a[138:139], v242 offset:19264
    buffer_load_dwordx4 v13, s[36:39], s61 offen offset:2048 lds
    s_waitcnt lgkmcnt(6)
    v_mfma_f32_16x16x32_bf16 v[176:179], a[144:147], v[32:35], v[176:179]
    ds_read_b64_tr_b16 a[140:141], v243 offset:18528
    v_mfma_f32_16x16x32_bf16 v[180:183], a[144:147], v[36:39], v[180:183]
    ds_read_b64_tr_b16 a[142:143], v243 offset:19296
    s_add_u32 m0, s59, 0
    v_mfma_f32_16x16x32_bf16 v[184:187], a[148:151], v[32:35], v[184:187]
    ds_read_b64_tr_b16 a[144:145], v242 offset:18560
    v_mfma_f32_16x16x32_bf16 v[188:191], a[148:151], v[36:39], v[188:191]
    ds_read_b64_tr_b16 a[146:147], v242 offset:19328
    buffer_load_dwordx4 v8, s[28:31], s4 offen offset:0 lds
    s_waitcnt lgkmcnt(6)
    v_mfma_f32_16x16x32_bf16 v[144:147], a[128:131], v[40:43], v[144:147]
    ds_read_b64_tr_b16 a[148:149], v243 offset:18592
    v_mfma_f32_16x16x32_bf16 v[148:151], a[128:131], v[44:47], v[148:151]
    ds_read_b64_tr_b16 a[150:151], v243 offset:19360
    v_mfma_f32_16x16x32_bf16 v[152:155], a[132:135], v[40:43], v[152:155]
    s_waitcnt vmcnt(13)
    s_barrier
    ds_read_b64_tr_b16 a[128:129], v242 offset:24576
    v_mfma_f32_16x16x32_bf16 v[156:159], a[132:135], v[44:47], v[156:159]
    ds_read_b64_tr_b16 a[130:131], v242 offset:25344
    buffer_load_dwordx4 v9, s[28:31], s4 offen offset:1024 lds
    s_waitcnt lgkmcnt(6)
    v_mfma_f32_16x16x32_bf16 v[160:163], a[136:139], v[40:43], v[160:163]
    ds_read_b64_tr_b16 a[132:133], v243 offset:24608
    v_mfma_f32_16x16x32_bf16 v[164:167], a[136:139], v[44:47], v[164:167]
    ds_read_b64_tr_b16 a[134:135], v243 offset:25376
    v_mfma_f32_16x16x32_bf16 v[168:171], a[140:143], v[40:43], v[168:171]
    ds_read_b64_tr_b16 a[136:137], v242 offset:24640
    v_mfma_f32_16x16x32_bf16 v[172:175], a[140:143], v[44:47], v[172:175]
    ds_read_b64_tr_b16 a[138:139], v242 offset:25408
    buffer_load_dwordx4 v10, s[28:31], s4 offen offset:2048 lds
    s_waitcnt lgkmcnt(6)
    v_mfma_f32_16x16x32_bf16 v[176:179], a[144:147], v[40:43], v[176:179]
    ds_read_b64_tr_b16 a[140:141], v243 offset:24672
    v_mfma_f32_16x16x32_bf16 v[180:183], a[144:147], v[44:47], v[180:183]
    ds_read_b64_tr_b16 a[142:143], v243 offset:25440
    v_mfma_f32_16x16x32_bf16 v[184:187], a[148:151], v[40:43], v[184:187]
    ds_read_b64_tr_b16 a[144:145], v242 offset:24704
    v_mfma_f32_16x16x32_bf16 v[188:191], a[148:151], v[44:47], v[188:191]
    ds_read_b64_tr_b16 a[146:147], v242 offset:25472
    s_add_u32 m0, s59, 12288
    s_waitcnt lgkmcnt(6)
    v_mfma_f32_16x16x32_bf16 v[144:147], a[128:131], v[48:51], v[144:147]
    ds_read_b64_tr_b16 a[148:149], v243 offset:24736
    v_mfma_f32_16x16x32_bf16 v[148:151], a[128:131], v[52:55], v[148:151]
    ds_read_b64_tr_b16 a[150:151], v243 offset:25504
    buffer_load_dwordx4 v8, s[32:35], s4 offen offset:0 lds
    v_mfma_f32_16x16x32_bf16 v[152:155], a[132:135], v[48:51], v[152:155]
    ds_read_b64_tr_b16 a[128:129], v242 offset:30720
    v_mfma_f32_16x16x32_bf16 v[156:159], a[132:135], v[52:55], v[156:159]
    ds_read_b64_tr_b16 a[130:131], v242 offset:31488
    s_waitcnt lgkmcnt(6)
    v_mfma_f32_16x16x32_bf16 v[160:163], a[136:139], v[48:51], v[160:163]
    ds_read_b64_tr_b16 a[132:133], v243 offset:30752
    v_mfma_f32_16x16x32_bf16 v[164:167], a[136:139], v[52:55], v[164:167]
    ds_read_b64_tr_b16 a[134:135], v243 offset:31520
    buffer_load_dwordx4 v9, s[32:35], s4 offen offset:1024 lds
    v_mfma_f32_16x16x32_bf16 v[168:171], a[140:143], v[48:51], v[168:171]
    ds_read_b64_tr_b16 a[136:137], v242 offset:30784
    v_mfma_f32_16x16x32_bf16 v[172:175], a[140:143], v[52:55], v[172:175]
    ds_read_b64_tr_b16 a[138:139], v242 offset:31552
    s_waitcnt lgkmcnt(6)
    v_mfma_f32_16x16x32_bf16 v[176:179], a[144:147], v[48:51], v[176:179]
    ds_read_b64_tr_b16 a[140:141], v243 offset:30816
    v_mfma_f32_16x16x32_bf16 v[180:183], a[144:147], v[52:55], v[180:183]
    ds_read_b64_tr_b16 a[142:143], v243 offset:31584
    buffer_load_dwordx4 v10, s[32:35], s4 offen offset:2048 lds
    v_mfma_f32_16x16x32_bf16 v[184:187], a[148:151], v[48:51], v[184:187]
    ds_read_b64_tr_b16 a[144:145], v242 offset:30848
    v_mfma_f32_16x16x32_bf16 v[188:191], a[148:151], v[52:55], v[188:191]
    ds_read_b64_tr_b16 a[146:147], v242 offset:31616
    s_waitcnt lgkmcnt(6)
    v_mfma_f32_16x16x32_bf16 v[144:147], a[128:131], v[56:59], v[144:147]
    ds_read_b64_tr_b16 a[148:149], v243 offset:30880
    v_mfma_f32_16x16x32_bf16 v[148:151], a[128:131], v[60:63], v[148:151]
    ds_read_b64_tr_b16 a[150:151], v243 offset:31648
    buffer_load_dwordx2 v[252:253], off, s[44:47], 0 sc1
    v_mfma_f32_16x16x32_bf16 v[152:155], a[132:135], v[56:59], v[152:155]
    ds_read_b64_tr_b16 a[128:129], v242 offset:36864
    v_mfma_f32_16x16x32_bf16 v[156:159], a[132:135], v[60:63], v[156:159]
    ds_read_b64_tr_b16 a[130:131], v242 offset:37632
    s_waitcnt lgkmcnt(6)
    v_mfma_f32_16x16x32_bf16 v[160:163], a[136:139], v[56:59], v[160:163]
    ds_read_b64_tr_b16 a[132:133], v243 offset:36896
    v_mfma_f32_16x16x32_bf16 v[164:167], a[136:139], v[60:63], v[164:167]
    ds_read_b64_tr_b16 a[134:135], v243 offset:37664
    v_mfma_f32_16x16x32_bf16 v[168:171], a[140:143], v[56:59], v[168:171]
    ds_read_b64_tr_b16 a[136:137], v242 offset:36928
    v_mfma_f32_16x16x32_bf16 v[172:175], a[140:143], v[60:63], v[172:175]
    ds_read_b64_tr_b16 a[138:139], v242 offset:37696
    s_waitcnt lgkmcnt(6)
    v_mfma_f32_16x16x32_bf16 v[176:179], a[144:147], v[56:59], v[176:179]
    ds_read_b64_tr_b16 a[140:141], v243 offset:36960
    v_mfma_f32_16x16x32_bf16 v[180:183], a[144:147], v[60:63], v[180:183]
    ds_read_b64_tr_b16 a[142:143], v243 offset:37728
    v_mfma_f32_16x16x32_bf16 v[184:187], a[148:151], v[56:59], v[184:187]
    ds_read_b64_tr_b16 a[144:145], v242 offset:36992
    v_mfma_f32_16x16x32_bf16 v[188:191], a[148:151], v[60:63], v[188:191]
    ds_read_b64_tr_b16 a[146:147], v242 offset:37760
    s_waitcnt lgkmcnt(6)
    v_mfma_f32_16x16x32_bf16 v[144:147], a[128:131], v[64:67], v[144:147]
    ds_read_b64_tr_b16 a[148:149], v243 offset:37024
    v_mfma_f32_16x16x32_bf16 v[148:151], a[128:131], v[68:71], v[148:151]
    ds_read_b64_tr_b16 a[150:151], v243 offset:37792
    v_mfma_f32_16x16x32_bf16 v[152:155], a[132:135], v[64:67], v[152:155]
    ds_read_b64_tr_b16 a[128:129], v242 offset:43008
    v_mfma_f32_16x16x32_bf16 v[156:159], a[132:135], v[68:71], v[156:159]
    ds_read_b64_tr_b16 a[130:131], v242 offset:43776
    s_waitcnt lgkmcnt(6)
    v_mfma_f32_16x16x32_bf16 v[160:163], a[136:139], v[64:67], v[160:163]
    ds_read_b64_tr_b16 a[132:133], v243 offset:43040
    v_mfma_f32_16x16x32_bf16 v[164:167], a[136:139], v[68:71], v[164:167]
    ds_read_b64_tr_b16 a[134:135], v243 offset:43808
    v_mfma_f32_16x16x32_bf16 v[168:171], a[140:143], v[64:67], v[168:171]
    ds_read_b64_tr_b16 a[136:137], v242 offset:43072
    v_mfma_f32_16x16x32_bf16 v[172:175], a[140:143], v[68:71], v[172:175]
    ds_read_b64_tr_b16 a[138:139], v242 offset:43840
    s_waitcnt lgkmcnt(6)
    v_mfma_f32_16x16x32_bf16 v[176:179], a[144:147], v[64:67], v[176:179]
    ds_read_b64_tr_b16 a[140:141], v243 offset:43104
    v_mfma_f32_16x16x32_bf16 v[180:183], a[144:147], v[68:71], v[180:183]
    ds_read_b64_tr_b16 a[142:143], v243 offset:43872
    v_mfma_f32_16x16x32_bf16 v[184:187], a[148:151], v[64:67], v[184:187]
    ds_read_b64_tr_b16 a[144:145], v242 offset:43136
    v_mfma_f32_16x16x32_bf16 v[188:191], a[148:151], v[68:71], v[188:191]
    ds_read_b64_tr_b16 a[146:147], v242 offset:43904
    s_waitcnt lgkmcnt(6)
    v_mfma_f32_16x16x32_bf16 v[144:147], a[128:131], v[72:75], v[144:147]
    ds_read_b64_tr_b16 a[148:149], v243 offset:43168
    v_mfma_f32_16x16x32_bf16 v[148:151], a[128:131], v[76:79], v[148:151]
    ds_read_b64_tr_b16 a[150:151], v243 offset:43936
    v_mfma_f32_16x16x32_bf16 v[152:155], a[132:135], v[72:75], v[152:155]
    s_waitcnt vmcnt(13)
    s_barrier
    ds_read_b64_tr_b16 a[128:129], v242 offset:49152
    v_mfma_f32_16x16x32_bf16 v[156:159], a[132:135], v[76:79], v[156:159]
    ds_read_b64_tr_b16 a[130:131], v242 offset:49920
    s_waitcnt lgkmcnt(6)
    v_mfma_f32_16x16x32_bf16 v[160:163], a[136:139], v[72:75], v[160:163]
    ds_read_b64_tr_b16 a[132:133], v243 offset:49184
    v_mfma_f32_16x16x32_bf16 v[164:167], a[136:139], v[76:79], v[164:167]
    ds_read_b64_tr_b16 a[134:135], v243 offset:49952
    s_mov_b32 s36, s16
    v_mfma_f32_16x16x32_bf16 v[168:171], a[140:143], v[72:75], v[168:171]
    ds_read_b64_tr_b16 a[136:137], v242 offset:49216
    v_mfma_f32_16x16x32_bf16 v[172:175], a[140:143], v[76:79], v[172:175]
    ds_read_b64_tr_b16 a[138:139], v242 offset:49984
    s_mov_b32 s37, s17
    s_waitcnt lgkmcnt(6)
    v_mfma_f32_16x16x32_bf16 v[176:179], a[144:147], v[72:75], v[176:179]
    ds_read_b64_tr_b16 a[140:141], v243 offset:49248
    v_mfma_f32_16x16x32_bf16 v[180:183], a[144:147], v[76:79], v[180:183]
    ds_read_b64_tr_b16 a[142:143], v243 offset:50016
    s_mov_b32 s38, 1409024
    v_mfma_f32_16x16x32_bf16 v[184:187], a[148:151], v[72:75], v[184:187]
    ds_read_b64_tr_b16 a[144:145], v242 offset:49280
    v_mfma_f32_16x16x32_bf16 v[188:191], a[148:151], v[76:79], v[188:191]
    ds_read_b64_tr_b16 a[146:147], v242 offset:50048
    s_mov_b32 s39, 0x20000
    s_waitcnt lgkmcnt(6)
    v_mfma_f32_16x16x32_bf16 v[144:147], a[128:131], v[80:83], v[144:147]
    ds_read_b64_tr_b16 a[148:149], v243 offset:49312
    v_mfma_f32_16x16x32_bf16 v[148:151], a[128:131], v[84:87], v[148:151]
    ds_read_b64_tr_b16 a[150:151], v243 offset:50080
    s_lshl2_add_u32 s67, s49, s52
    v_mfma_f32_16x16x32_bf16 v[152:155], a[132:135], v[80:83], v[152:155]
    ds_read_b64_tr_b16 a[128:129], v242 offset:55296
    v_mfma_f32_16x16x32_bf16 v[156:159], a[132:135], v[84:87], v[156:159]
    ds_read_b64_tr_b16 a[130:131], v242 offset:56064
    v_min_u32 v254, 42, v1
    s_waitcnt lgkmcnt(6)
    v_mfma_f32_16x16x32_bf16 v[160:163], a[136:139], v[80:83], v[160:163]
    ds_read_b64_tr_b16 a[132:133], v243 offset:55328
    v_mfma_f32_16x16x32_bf16 v[164:167], a[136:139], v[84:87], v[164:167]
    ds_read_b64_tr_b16 a[134:135], v243 offset:56096
    v_mov_b32 v15, 43
    v_mfma_f32_16x16x32_bf16 v[168:171], a[140:143], v[80:83], v[168:171]
    ds_read_b64_tr_b16 a[136:137], v242 offset:55360
    v_mfma_f32_16x16x32_bf16 v[172:175], a[140:143], v[84:87], v[172:175]
    ds_read_b64_tr_b16 a[138:139], v242 offset:56128
    v_mad_u32_u24 v254, v15, s67, v254
    s_waitcnt lgkmcnt(6)
    v_mfma_f32_16x16x32_bf16 v[176:179], a[144:147], v[80:83], v[176:179]
    ds_read_b64_tr_b16 a[140:141], v243 offset:55392
    v_mfma_f32_16x16x32_bf16 v[180:183], a[144:147], v[84:87], v[180:183]
    ds_read_b64_tr_b16 a[142:143], v243 offset:56160
    v_and_b32 v15, 3, v254
    v_mfma_f32_16x16x32_bf16 v[184:187], a[148:151], v[80:83], v[184:187]
    ds_read_b64_tr_b16 a[144:145], v242 offset:55424
    v_mfma_f32_16x16x32_bf16 v[188:191], a[148:151], v[84:87], v[188:191]
    ds_read_b64_tr_b16 a[146:147], v242 offset:56192
    v_lshrrev_b32 v254, 2, v254
    s_waitcnt lgkmcnt(6)
    v_mfma_f32_16x16x32_bf16 v[144:147], a[128:131], v[88:91], v[144:147]
    ds_read_b64_tr_b16 a[148:149], v243 offset:55456
    v_mfma_f32_16x16x32_bf16 v[148:151], a[128:131], v[92:95], v[148:151]
    ds_read_b64_tr_b16 a[150:151], v243 offset:56224
    v_lshlrev_b32 v15, 7, v15
    v_mfma_f32_16x16x32_bf16 v[152:155], a[132:135], v[88:91], v[152:155]
    ds_read_b64_tr_b16 a[128:129], v244 offset:0
    v_mfma_f32_16x16x32_bf16 v[156:159], a[132:135], v[92:95], v[156:159]
    ds_read_b64_tr_b16 a[130:131], v244 offset:768
    v_lshl_add_u32 v15, v254, 10, v15
    s_waitcnt lgkmcnt(6)
    v_mfma_f32_16x16x32_bf16 v[160:163], a[136:139], v[88:91], v[160:163]
    ds_read_b64_tr_b16 a[132:133], v245 offset:32
    v_mfma_f32_16x16x32_bf16 v[164:167], a[136:139], v[92:95], v[164:167]
    ds_read_b64_tr_b16 a[134:135], v245 offset:800
    s_add_u32 m0, s59, 24576
    s_and_b32 s64, s2, 1
    v_mfma_f32_16x16x32_bf16 v[168:171], a[140:143], v[88:91], v[168:171]
    ds_read_b64_tr_b16 a[136:137], v244 offset:64
    v_mfma_f32_16x16x32_bf16 v[172:175], a[140:143], v[92:95], v[172:175]
    ds_read_b64_tr_b16 a[138:139], v244 offset:832
    buffer_load_dwordx4 v8, s[28:31], s5 offen offset:0 lds
    s_lshl_b32 s64, s64, 9
    s_waitcnt lgkmcnt(6)
    v_mfma_f32_16x16x32_bf16 v[176:179], a[144:147], v[88:91], v[176:179]
    ds_read_b64_tr_b16 a[140:141], v245 offset:96
    v_mfma_f32_16x16x32_bf16 v[180:183], a[144:147], v[92:95], v[180:183]
    ds_read_b64_tr_b16 a[142:143], v245 offset:864
    v_add_f32 v216, v216, v217
    v_mfma_f32_16x16x32_bf16 v[184:187], a[148:151], v[88:91], v[184:187]
    ds_read_b64_tr_b16 a[144:145], v244 offset:128
    v_mfma_f32_16x16x32_bf16 v[188:191], a[148:151], v[92:95], v[188:191]
    ds_read_b64_tr_b16 a[146:147], v244 offset:896
    buffer_load_dwordx4 v9, s[28:31], s5 offen offset:1024 lds
    v_add_f32 v218, v218, v219
    s_waitcnt lgkmcnt(6)
    v_mfma_f32_16x16x32_bf16 v[144:147], a[128:131], v[96:99], v[144:147]
    ds_read_b64_tr_b16 a[148:149], v245 offset:160
    v_mfma_f32_16x16x32_bf16 v[148:151], a[128:131], v[100:103], v[148:151]
    ds_read_b64_tr_b16 a[150:151], v245 offset:928
    v_mov_b32 v217, v216
    v_mfma_f32_16x16x32_bf16 v[152:155], a[132:135], v[96:99], v[152:155]
    ds_read_b64_tr_b16 a[128:129], v244 offset:6144
    v_mfma_f32_16x16x32_bf16 v[156:159], a[132:135], v[100:103], v[156:159]
    ds_read_b64_tr_b16 a[130:131], v244 offset:6912
    buffer_load_dwordx4 v10, s[28:31], s5 offen offset:2048 lds
    s_waitcnt lgkmcnt(6)
    v_mfma_f32_16x16x32_bf16 v[160:163], a[136:139], v[96:99], v[160:163]
    ds_read_b64_tr_b16 a[132:133], v245 offset:6176
    v_mfma_f32_16x16x32_bf16 v[164:167], a[136:139], v[100:103], v[164:167]
    ds_read_b64_tr_b16 a[134:135], v245 offset:6944
    v_mov_b32 v219, v218
    v_mfma_f32_16x16x32_bf16 v[168:171], a[140:143], v[96:99], v[168:171]
    ds_read_b64_tr_b16 a[136:137], v244 offset:6208
    v_mfma_f32_16x16x32_bf16 v[172:175], a[140:143], v[100:103], v[172:175]
    ds_read_b64_tr_b16 a[138:139], v244 offset:6976
    s_add_u32 m0, s59, 36864
    v_permlane16_swap_b32 v216, v217
    s_waitcnt lgkmcnt(6)
    v_mfma_f32_16x16x32_bf16 v[176:179], a[144:147], v[96:99], v[176:179]
    ds_read_b64_tr_b16 a[140:141], v245 offset:6240
    v_mfma_f32_16x16x32_bf16 v[180:183], a[144:147], v[100:103], v[180:183]
    ds_read_b64_tr_b16 a[142:143], v245 offset:7008
    buffer_load_dwordx4 v8, s[32:35], s5 offen offset:0 lds
    v_mfma_f32_16x16x32_bf16 v[184:187], a[148:151], v[96:99], v[184:187]
    ds_read_b64_tr_b16 a[144:145], v244 offset:6272
    v_mfma_f32_16x16x32_bf16 v[188:191], a[148:151], v[100:103], v[188:191]
    ds_read_b64_tr_b16 a[146:147], v244 offset:7040
    v_permlane16_swap_b32 v218, v219
    s_waitcnt lgkmcnt(6)
    v_mfma_f32_16x16x32_bf16 v[144:147], a[128:131], v[104:107], v[144:147]
    ds_read_b64_tr_b16 a[148:149], v245 offset:6304
    v_mfma_f32_16x16x32_bf16 v[148:151], a[128:131], v[108:111], v[148:151]
    ds_read_b64_tr_b16 a[150:151], v245 offset:7072
    buffer_load_dwordx4 v9, s[32:35], s5 offen offset:1024 lds
    v_add_f32 v216, v216, v217
    v_mfma_f32_16x16x32_bf16 v[152:155], a[132:135], v[104:107], v[152:155]
    s_waitcnt vmcnt(12)
    s_barrier
    ds_read_b64_tr_b16 a[128:129], v244 offset:12288
    v_mfma_f32_16x16x32_bf16 v[156:159], a[132:135], v[108:111], v[156:159]
    ds_read_b64_tr_b16 a[130:131], v244 offset:13056
    v_add_f32 v218, v218, v219
    s_waitcnt lgkmcnt(6)
    v_mfma_f32_16x16x32_bf16 v[160:163], a[136:139], v[104:107], v[160:163]
    ds_read_b64_tr_b16 a[132:133], v245 offset:12320
    v_mfma_f32_16x16x32_bf16 v[164:167], a[136:139], v[108:111], v[164:167]
    ds_read_b64_tr_b16 a[134:135], v245 offset:13088
    buffer_load_dwordx4 v10, s[32:35], s5 offen offset:2048 lds
    v_mfma_f32_16x16x32_bf16 v[168:171], a[140:143], v[104:107], v[168:171]
    ds_read_b64_tr_b16 a[136:137], v244 offset:12352
    v_mfma_f32_16x16x32_bf16 v[172:175], a[140:143], v[108:111], v[172:175]
    ds_read_b64_tr_b16 a[138:139], v244 offset:13120
    v_mov_b32 v217, v216
    s_waitcnt lgkmcnt(6)
    v_mfma_f32_16x16x32_bf16 v[176:179], a[144:147], v[104:107], v[176:179]
    ds_read_b64_tr_b16 a[140:141], v245 offset:12384
    v_mfma_f32_16x16x32_bf16 v[180:183], a[144:147], v[108:111], v[180:183]
    ds_read_b64_tr_b16 a[142:143], v245 offset:13152
    v_mov_b32 v219, v218
    v_mfma_f32_16x16x32_bf16 v[184:187], a[148:151], v[104:107], v[184:187]
    ds_read_b64_tr_b16 a[144:145], v244 offset:12416
    v_mfma_f32_16x16x32_bf16 v[188:191], a[148:151], v[108:111], v[188:191]
    ds_read_b64_tr_b16 a[146:147], v244 offset:13184
    s_waitcnt lgkmcnt(6)
    v_mfma_f32_16x16x32_bf16 v[144:147], a[128:131], v[112:115], v[144:147]
    ds_read_b64_tr_b16 a[148:149], v245 offset:12448
    v_mfma_f32_16x16x32_bf16 v[148:151], a[128:131], v[116:119], v[148:151]
    ds_read_b64_tr_b16 a[150:151], v245 offset:13216
    v_permlane32_swap_b32 v216, v217
    v_mfma_f32_16x16x32_bf16 v[152:155], a[132:135], v[112:115], v[152:155]
    ds_read_b64_tr_b16 a[128:129], v244 offset:18432
    v_mfma_f32_16x16x32_bf16 v[156:159], a[132:135], v[116:119], v[156:159]
    ds_read_b64_tr_b16 a[130:131], v244 offset:19200
    v_permlane32_swap_b32 v218, v219
    s_waitcnt lgkmcnt(6)
    v_mfma_f32_16x16x32_bf16 v[160:163], a[136:139], v[112:115], v[160:163]
    ds_read_b64_tr_b16 a[132:133], v245 offset:18464
    v_mfma_f32_16x16x32_bf16 v[164:167], a[136:139], v[116:119], v[164:167]
    ds_read_b64_tr_b16 a[134:135], v245 offset:19232
    s_add_u32 m0, s59, 49152
    v_mfma_f32_16x16x32_bf16 v[168:171], a[140:143], v[112:115], v[168:171]
    ds_read_b64_tr_b16 a[136:137], v244 offset:18496
    v_mfma_f32_16x16x32_bf16 v[172:175], a[140:143], v[116:119], v[172:175]
    ds_read_b64_tr_b16 a[138:139], v244 offset:19264
    buffer_load_dwordx4 v8, s[28:31], s6 offen offset:0 lds
    v_add_f32 v216, v216, v217
    s_waitcnt lgkmcnt(6)
    v_mfma_f32_16x16x32_bf16 v[176:179], a[144:147], v[112:115], v[176:179]
    ds_read_b64_tr_b16 a[140:141], v245 offset:18528
    v_mfma_f32_16x16x32_bf16 v[180:183], a[144:147], v[116:119], v[180:183]
    ds_read_b64_tr_b16 a[142:143], v245 offset:19296
    v_add_f32 v218, v218, v219
    v_mfma_f32_16x16x32_bf16 v[184:187], a[148:151], v[112:115], v[184:187]
    ds_read_b64_tr_b16 a[144:145], v244 offset:18560
    v_mfma_f32_16x16x32_bf16 v[188:191], a[148:151], v[116:119], v[188:191]
    ds_read_b64_tr_b16 a[146:147], v244 offset:19328
    buffer_load_dwordx4 v9, s[28:31], s6 offen offset:1024 lds
    v_mul_f32 v216, 0x3b000000, v216
    s_waitcnt lgkmcnt(6)
    v_mfma_f32_16x16x32_bf16 v[144:147], a[128:131], v[120:123], v[144:147]
    ds_read_b64_tr_b16 a[148:149], v245 offset:18592
    v_mfma_f32_16x16x32_bf16 v[148:151], a[128:131], v[124:127], v[148:151]
    ds_read_b64_tr_b16 a[150:151], v245 offset:19360
    v_mfma_f32_16x16x32_bf16 v[152:155], a[132:135], v[120:123], v[152:155]
    ds_read_b64_tr_b16 a[128:129], v244 offset:24576
    v_mfma_f32_16x16x32_bf16 v[156:159], a[132:135], v[124:127], v[156:159]
    ds_read_b64_tr_b16 a[130:131], v244 offset:25344
    buffer_load_dwordx4 v10, s[28:31], s6 offen offset:2048 lds
    v_fma_f32 v216, -v220, v220, v216
    s_waitcnt lgkmcnt(6)
    v_mfma_f32_16x16x32_bf16 v[160:163], a[136:139], v[120:123], v[160:163]
    ds_read_b64_tr_b16 a[132:133], v245 offset:24608
    v_mfma_f32_16x16x32_bf16 v[164:167], a[136:139], v[124:127], v[164:167]
    ds_read_b64_tr_b16 a[134:135], v245 offset:25376
    v_max_f32 v216, 0, v216
    v_mfma_f32_16x16x32_bf16 v[168:171], a[140:143], v[120:123], v[168:171]
    ds_read_b64_tr_b16 a[136:137], v244 offset:24640
    v_mfma_f32_16x16x32_bf16 v[172:175], a[140:143], v[124:127], v[172:175]
    ds_read_b64_tr_b16 a[138:139], v244 offset:25408
    s_add_u32 m0, s59, 65536
    s_waitcnt lgkmcnt(6)
    v_mfma_f32_16x16x32_bf16 v[176:179], a[144:147], v[120:123], v[176:179]
    ds_read_b64_tr_b16 a[140:141], v245 offset:24672
    v_mfma_f32_16x16x32_bf16 v[180:183], a[144:147], v[124:127], v[180:183]
    ds_read_b64_tr_b16 a[142:143], v245 offset:25440
    buffer_load_dwordx4 v8, s[32:35], s6 offen offset:0 lds
    v_add_f32 v216, 0x3727c5ac, v216
    v_mfma_f32_16x16x32_bf16 v[184:187], a[148:151], v[120:123], v[184:187]
    ds_read_b64_tr_b16 a[144:145], v244 offset:24704
    v_mfma_f32_16x16x32_bf16 v[188:191], a[148:151], v[124:127], v[188:191]
    ds_read_b64_tr_b16 a[146:147], v244 offset:25472
    v_rsq_f32 v248, v216
    s_waitcnt lgkmcnt(6)
    v_mfma_f32_16x16x32_bf16 v[144:147], a[128:131], v[128:131], v[144:147]
    ds_read_b64_tr_b16 a[148:149], v245 offset:24736
    v_mfma_f32_16x16x32_bf16 v[148:151], a[128:131], v[132:135], v[148:151]
    ds_read_b64_tr_b16 a[150:151], v245 offset:25504
    buffer_load_dwordx4 v9, s[32:35], s6 offen offset:1024 lds
    v_mul_f32 v218, 0x3b000000, v218
    v_mfma_f32_16x16x32_bf16 v[152:155], a[132:135], v[128:131], v[152:155]
    ds_read_b64_tr_b16 a[128:129], v244 offset:30720
    v_mfma_f32_16x16x32_bf16 v[156:159], a[132:135], v[132:135], v[156:159]
    ds_read_b64_tr_b16 a[130:131], v244 offset:31488
    s_waitcnt lgkmcnt(6)
    v_mfma_f32_16x16x32_bf16 v[160:163], a[136:139], v[128:131], v[160:163]
    ds_read_b64_tr_b16 a[132:133], v245 offset:30752
    v_mfma_f32_16x16x32_bf16 v[164:167], a[136:139], v[132:135], v[164:167]
    ds_read_b64_tr_b16 a[134:135], v245 offset:31520
    buffer_load_dwordx4 v10, s[32:35], s6 offen offset:2048 lds
    v_fma_f32 v218, -v224, v224, v218
    v_mfma_f32_16x16x32_bf16 v[168:171], a[140:143], v[128:131], v[168:171]
    ds_read_b64_tr_b16 a[136:137], v244 offset:30784
    v_mfma_f32_16x16x32_bf16 v[172:175], a[140:143], v[132:135], v[172:175]
    ds_read_b64_tr_b16 a[138:139], v244 offset:31552
    v_max_f32 v218, 0, v218
    s_waitcnt lgkmcnt(6)
    v_mfma_f32_16x16x32_bf16 v[176:179], a[144:147], v[128:131], v[176:179]
    ds_read_b64_tr_b16 a[140:141], v245 offset:30816
    v_mfma_f32_16x16x32_bf16 v[180:183], a[144:147], v[132:135], v[180:183]
    ds_read_b64_tr_b16 a[142:143], v245 offset:31584
    v_mfma_f32_16x16x32_bf16 v[184:187], a[148:151], v[128:131], v[184:187]
    ds_read_b64_tr_b16 a[144:145], v244 offset:30848
    v_mfma_f32_16x16x32_bf16 v[188:191], a[148:151], v[132:135], v[188:191]
    ds_read_b64_tr_b16 a[146:147], v244 offset:31616
    v_add_f32 v218, 0x3727c5ac, v218
    s_waitcnt lgkmcnt(6)
    v_mfma_f32_16x16x32_bf16 v[144:147], a[128:131], v[136:139], v[144:147]
    ds_read_b64_tr_b16 a[148:149], v245 offset:30880
    v_mfma_f32_16x16x32_bf16 v[148:151], a[128:131], v[140:143], v[148:151]
    ds_read_b64_tr_b16 a[150:151], v245 offset:31648
    v_rsq_f32 v249, v218
    v_mfma_f32_16x16x32_bf16 v[152:155], a[132:135], v[136:139], v[152:155]
    s_waitcnt vmcnt(13)
    s_barrier
    ds_read_b64_tr_b16 a[128:129], v240 offset:0
    v_mfma_f32_16x16x32_bf16 v[156:159], a[132:135], v[140:143], v[156:159]
    ds_read_b64_tr_b16 a[130:131], v240 offset:768
    s_waitcnt lgkmcnt(6)
    v_mfma_f32_16x16x32_bf16 v[160:163], a[136:139], v[136:139], v[160:163]
    ds_read_b64_tr_b16 a[132:133], v240 offset:12288
    v_mfma_f32_16x16x32_bf16 v[164:167], a[136:139], v[140:143], v[164:167]
    ds_read_b64_tr_b16 a[134:135], v240 offset:13056
    v_mfma_f32_16x16x32_bf16 v[168:171], a[140:143], v[136:139], v[168:171]
    ds_read_b64_tr_b16 a[136:137], v241 offset:32
    v_mfma_f32_16x16x32_bf16 v[172:175], a[140:143], v[140:143], v[172:175]
    ds_read_b64_tr_b16 a[138:139], v241 offset:800
    s_waitcnt lgkmcnt(6)
    v_mfma_f32_16x16x32_bf16 v[176:179], a[144:147], v[136:139], v[176:179]
    ds_read_b64_tr_b16 a[140:141], v241 offset:12320
    v_mfma_f32_16x16x32_bf16 v[180:183], a[144:147], v[140:143], v[180:183]
    ds_read_b64_tr_b16 a[142:143], v241 offset:13088
    v_mfma_f32_16x16x32_bf16 v[184:187], a[148:151], v[136:139], v[184:187]
    ds_read_b64_tr_b16 a[144:145], v240 offset:64
    v_mfma_f32_16x16x32_bf16 v[188:191], a[148:151], v[140:143], v[188:191]
    ds_read_b64_tr_b16 a[146:147], v240 offset:832
    v_mul_f32 v208, 0x3f19be61, v248
    v_mul_f32 v210, 0x3f19be61, v249
    s_lshl2_add_u32 s62, s53, s52
    s_lshl4_add_u32 s62, s62, s54
    s_mul_i32 s62, s62, 6144
    s_add_u32 s62, s62, 0
    s_add_u32 s63, s62, 4096
    s_cmp_lt_u32 s54, 6
    s_cselect_b32 s3, 1, 0
    v_bitop3_b32 v212, s3, v1, v1 bitop3:0x3f
    v_pk_mul_f32 v[144:145], v[144:145], v[208:209] op_sel_hi:[1,0]
    v_pk_mul_f32 v[146:147], v[146:147], v[208:209] op_sel_hi:[1,0]
    v_pk_mul_f32 v[148:149], v[148:149], v[210:211] op_sel_hi:[1,0]
    v_pk_mul_f32 v[150:151], v[150:151], v[210:211] op_sel_hi:[1,0]
    v_pk_mul_f32 v[152:153], v[152:153], v[208:209] op_sel_hi:[1,0]
    v_pk_mul_f32 v[154:155], v[154:155], v[208:209] op_sel_hi:[1,0]
    v_pk_mul_f32 v[156:157], v[156:157], v[210:211] op_sel_hi:[1,0]
    v_pk_mul_f32 v[158:159], v[158:159], v[210:211] op_sel_hi:[1,0]
    v_cvt_pk_bf16_f32 v144, v144, v145
    v_cvt_pk_bf16_f32 v145, v146, v147
    v_cvt_pk_bf16_f32 v146, v148, v149
    v_cvt_pk_bf16_f32 v147, v150, v151
    v_cvt_pk_bf16_f32 v152, v152, v153
    v_cvt_pk_bf16_f32 v153, v154, v155
    v_cvt_pk_bf16_f32 v154, v156, v157
    v_cvt_pk_bf16_f32 v155, v158, v159
    v_permlane16_swap_b32 v144, v146
    v_permlane16_swap_b32 v145, v147
    v_and_b32 v144, v212, v144
    buffer_store_dwordx4 v[144:147], v14, s[40:43], s62 offen offset:0 sc1
    v_permlane16_swap_b32 v152, v154
    v_permlane16_swap_b32 v153, v155
    v_and_b32 v152, v212, v152
    buffer_store_dwordx4 v[152:155], v14, s[40:43], s62 offen offset:1024 sc1
    s_cmp_lt_u32 s54, 5
    s_cselect_b32 s3, 1, 0
    v_bitop3_b32 v212, s3, v1, v1 bitop3:0x3f
    v_pk_mul_f32 v[160:161], v[160:161], v[208:209] op_sel_hi:[1,0]
    v_pk_mul_f32 v[162:163], v[162:163], v[208:209] op_sel_hi:[1,0]
    v_pk_mul_f32 v[164:165], v[164:165], v[210:211] op_sel_hi:[1,0]
    v_pk_mul_f32 v[166:167], v[166:167], v[210:211] op_sel_hi:[1,0]
    v_pk_mul_f32 v[168:169], v[168:169], v[208:209] op_sel_hi:[1,0]
    v_pk_mul_f32 v[170:171], v[170:171], v[208:209] op_sel_hi:[1,0]
    v_pk_mul_f32 v[172:173], v[172:173], v[210:211] op_sel_hi:[1,0]
    v_pk_mul_f32 v[174:175], v[174:175], v[210:211] op_sel_hi:[1,0]
    v_cvt_pk_bf16_f32 v160, v160, v161
    v_cvt_pk_bf16_f32 v161, v162, v163
    v_cvt_pk_bf16_f32 v162, v164, v165
    v_cvt_pk_bf16_f32 v163, v166, v167
    v_cvt_pk_bf16_f32 v168, v168, v169
    v_cvt_pk_bf16_f32 v169, v170, v171
    v_cvt_pk_bf16_f32 v170, v172, v173
    v_cvt_pk_bf16_f32 v171, v174, v175
    v_permlane16_swap_b32 v160, v162
    v_permlane16_swap_b32 v161, v163
    v_and_b32 v160, v212, v160
    buffer_store_dwordx4 v[160:163], v14, s[40:43], s62 offen offset:2048 sc1
    v_permlane16_swap_b32 v168, v170
    v_permlane16_swap_b32 v169, v171
    v_and_b32 v168, v212, v168
    buffer_store_dwordx4 v[168:171], v14, s[40:43], s62 offen offset:3072 sc1
    s_cmp_lt_u32 s54, 5
    s_cselect_b32 s3, 1, 0
    v_bitop3_b32 v212, s3, v1, v1 bitop3:0x3f
    v_pk_mul_f32 v[176:177], v[176:177], v[208:209] op_sel_hi:[1,0]
    v_pk_mul_f32 v[178:179], v[178:179], v[208:209] op_sel_hi:[1,0]
    v_pk_mul_f32 v[180:181], v[180:181], v[210:211] op_sel_hi:[1,0]
    v_pk_mul_f32 v[182:183], v[182:183], v[210:211] op_sel_hi:[1,0]
    v_pk_mul_f32 v[184:185], v[184:185], v[208:209] op_sel_hi:[1,0]
    v_pk_mul_f32 v[186:187], v[186:187], v[208:209] op_sel_hi:[1,0]
    v_pk_mul_f32 v[188:189], v[188:189], v[210:211] op_sel_hi:[1,0]
    v_pk_mul_f32 v[190:191], v[190:191], v[210:211] op_sel_hi:[1,0]
    v_cvt_pk_bf16_f32 v176, v176, v177
    v_cvt_pk_bf16_f32 v177, v178, v179
    v_cvt_pk_bf16_f32 v178, v180, v181
    v_cvt_pk_bf16_f32 v179, v182, v183
    v_cvt_pk_bf16_f32 v184, v184, v185
    v_cvt_pk_bf16_f32 v185, v186, v187
    v_cvt_pk_bf16_f32 v186, v188, v189
    v_cvt_pk_bf16_f32 v187, v190, v191
    v_permlane16_swap_b32 v176, v178
    v_permlane16_swap_b32 v177, v179
    v_and_b32 v176, v212, v176
    buffer_store_dwordx4 v[176:179], v14, s[40:43], s63 offen offset:0 sc1
    v_permlane16_swap_b32 v184, v186
    v_permlane16_swap_b32 v185, v187
    v_and_b32 v184, v212, v184
    buffer_store_dwordx4 v[184:187], v14, s[40:43], s63 offen offset:1024 sc1
Lgu_5:
    s_waitcnt vmcnt(18)
    v_cmp_ne_u32 vcc, 1, v253
    s_nop 0
    s_cbranch_vccnz Lsp_6
Lok_7:
    v_readfirstlane_b32 s48, v252
    s_waitcnt lgkmcnt(6)
    v_mfma_f32_16x16x32_bf16 v[144:147], a[128:131], v[16:19], 0
    ds_read_b64_tr_b16 a[148:149], v240 offset:12352
    v_mfma_f32_16x16x32_bf16 v[152:155], a[128:131], v[20:23], 0
    ds_read_b64_tr_b16 a[150:151], v240 offset:13120
    v_mfma_f32_16x16x32_bf16 v[148:151], a[132:135], v[16:19], 0
    ds_read_b64_tr_b16 a[128:129], v241 offset:96
    v_mfma_f32_16x16x32_bf16 v[156:159], a[132:135], v[20:23], 0
    ds_read_b64_tr_b16 a[130:131], v241 offset:864
    s_lshl_b32 s20, s52, 14
    s_waitcnt lgkmcnt(6)
    v_mfma_f32_16x16x32_bf16 v[160:163], a[136:139], v[16:19], 0
    ds_read_b64_tr_b16 a[132:133], v241 offset:12384
    v_mfma_f32_16x16x32_bf16 v[168:171], a[136:139], v[20:23], 0
    ds_read_b64_tr_b16 a[134:135], v241 offset:13152
    v_mfma_f32_16x16x32_bf16 v[164:167], a[140:143], v[16:19], 0
    ds_read_b64_tr_b16 a[136:137], v240 offset:128
    v_mfma_f32_16x16x32_bf16 v[172:175], a[140:143], v[20:23], 0
    ds_read_b64_tr_b16 a[138:139], v240 offset:896
    s_add_u32 s20, s20, 36864
    s_waitcnt lgkmcnt(6)
    v_mfma_f32_16x16x32_bf16 v[176:179], a[144:147], v[16:19], 0
    ds_read_b64_tr_b16 a[140:141], v240 offset:12416
    v_mfma_f32_16x16x32_bf16 v[184:187], a[144:147], v[20:23], 0
    ds_read_b64_tr_b16 a[142:143], v240 offset:13184
    s_add_u32 m0, s59, 77824
    v_mfma_f32_16x16x32_bf16 v[180:183], a[148:151], v[16:19], 0
    ds_read_b64_tr_b16 a[144:145], v241 offset:160
    v_mfma_f32_16x16x32_bf16 v[188:191], a[148:151], v[20:23], 0
    ds_read_b64_tr_b16 a[146:147], v241 offset:928
    buffer_load_dwordx4 v8, s[28:31], s7 offen offset:0 lds
    s_mul_i32 s22, s52, 12288
    s_waitcnt lgkmcnt(6)
    v_mfma_f32_16x16x32_bf16 v[192:195], a[128:131], v[16:19], 0
    ds_read_b64_tr_b16 a[148:149], v241 offset:12448
    v_mfma_f32_16x16x32_bf16 v[200:203], a[128:131], v[20:23], 0
    ds_read_b64_tr_b16 a[150:151], v241 offset:13216
    v_mfma_f32_16x16x32_bf16 v[196:199], a[132:135], v[16:19], 0
    ds_read_b64_tr_b16 a[128:129], v240 offset:6144
    v_mfma_f32_16x16x32_bf16 v[204:207], a[132:135], v[20:23], 0
    ds_read_b64_tr_b16 a[130:131], v240 offset:6912
    buffer_load_dwordx4 v9, s[28:31], s7 offen offset:1024 lds
    s_waitcnt lgkmcnt(6)
    v_mfma_f32_16x16x32_bf16 v[208:211], a[136:139], v[16:19], 0
    ds_read_b64_tr_b16 a[132:133], v240 offset:18432
    v_mfma_f32_16x16x32_bf16 v[216:219], a[136:139], v[20:23], 0
    ds_read_b64_tr_b16 a[134:135], v240 offset:19200
    s_add_u32 s21, s22, 102400
    v_mfma_f32_16x16x32_bf16 v[212:215], a[140:143], v[16:19], 0
    ds_read_b64_tr_b16 a[136:137], v241 offset:6176
    v_mfma_f32_16x16x32_bf16 v[220:223], a[140:143], v[20:23], 0
    ds_read_b64_tr_b16 a[138:139], v241 offset:6944
    buffer_load_dwordx4 v10, s[28:31], s7 offen offset:2048 lds
    s_waitcnt lgkmcnt(6)
    v_mfma_f32_16x16x32_bf16 v[224:227], a[144:147], v[16:19], 0
    ds_read_b64_tr_b16 a[140:141], v241 offset:18464
    v_mfma_f32_16x16x32_bf16 v[232:235], a[144:147], v[20:23], 0
    ds_read_b64_tr_b16 a[142:143], v241 offset:19232
    s_cmp_eq_u32 s52, 3
    s_cselect_b32 s22, 151552, s22
    v_mfma_f32_16x16x32_bf16 v[228:231], a[148:151], v[16:19], 0
    ds_read_b64_tr_b16 a[144:145], v240 offset:6208
    v_mfma_f32_16x16x32_bf16 v[236:239], a[148:151], v[20:23], 0
    ds_read_b64_tr_b16 a[146:147], v240 offset:6976
    s_add_u32 m0, s59, 90112
    s_waitcnt lgkmcnt(6)
    v_mfma_f32_16x16x32_bf16 v[144:147], a[128:131], v[24:27], v[144:147]
    ds_read_b64_tr_b16 a[148:149], v240 offset:18496
    v_mfma_f32_16x16x32_bf16 v[152:155], a[128:131], v[28:31], v[152:155]
    ds_read_b64_tr_b16 a[150:151], v240 offset:19264
    buffer_load_dwordx4 v8, s[32:35], s7 offen offset:0 lds
    s_mul_i32 s66, s52, 360448
    v_mfma_f32_16x16x32_bf16 v[148:151], a[132:135], v[24:27], v[148:151]
    ds_read_b64_tr_b16 a[128:129], v241 offset:6240
    v_mfma_f32_16x16x32_bf16 v[156:159], a[132:135], v[28:31], v[156:159]
    ds_read_b64_tr_b16 a[130:131], v241 offset:7008
    s_waitcnt lgkmcnt(6)
    v_mfma_f32_16x16x32_bf16 v[160:163], a[136:139], v[24:27], v[160:163]
    ds_read_b64_tr_b16 a[132:133], v241 offset:18528
    v_mfma_f32_16x16x32_bf16 v[168:171], a[136:139], v[28:31], v[168:171]
    ds_read_b64_tr_b16 a[134:135], v241 offset:19296
    buffer_load_dwordx4 v9, s[32:35], s7 offen offset:1024 lds
    v_mfma_f32_16x16x32_bf16 v[164:167], a[140:143], v[24:27], v[164:167]
    ds_read_b64_tr_b16 a[136:137], v240 offset:6272
    v_mfma_f32_16x16x32_bf16 v[172:175], a[140:143], v[28:31], v[172:175]
    ds_read_b64_tr_b16 a[138:139], v240 offset:7040
    v_lshrrev_b32 v250, 3, v1
    s_waitcnt lgkmcnt(6)
    v_mfma_f32_16x16x32_bf16 v[176:179], a[144:147], v[24:27], v[176:179]
    ds_read_b64_tr_b16 a[140:141], v240 offset:18560
    v_mfma_f32_16x16x32_bf16 v[184:187], a[144:147], v[28:31], v[184:187]
    ds_read_b64_tr_b16 a[142:143], v240 offset:19328
    buffer_load_dwordx4 v10, s[32:35], s7 offen offset:2048 lds
    v_mfma_f32_16x16x32_bf16 v[180:183], a[148:151], v[24:27], v[180:183]
    ds_read_b64_tr_b16 a[144:145], v241 offset:6304
    v_mfma_f32_16x16x32_bf16 v[188:191], a[148:151], v[28:31], v[188:191]
    ds_read_b64_tr_b16 a[146:147], v241 offset:7072
    v_lshrrev_b32 v251, 4, v1
    s_waitcnt lgkmcnt(6)
    v_mfma_f32_16x16x32_bf16 v[192:195], a[128:131], v[24:27], v[192:195]
    ds_read_b64_tr_b16 a[148:149], v241 offset:18592
    v_mfma_f32_16x16x32_bf16 v[200:203], a[128:131], v[28:31], v[200:203]
    ds_read_b64_tr_b16 a[150:151], v241 offset:19360
    v_mfma_f32_16x16x32_bf16 v[196:199], a[132:135], v[24:27], v[196:199]
    s_waitcnt vmcnt(18)
    s_barrier
    ds_read_b64_tr_b16 a[128:129], v240 offset:24576
    v_mfma_f32_16x16x32_bf16 v[204:207], a[132:135], v[28:31], v[204:207]
    ds_read_b64_tr_b16 a[130:131], v240 offset:25344
    s_waitcnt lgkmcnt(6)
    v_mfma_f32_16x16x32_bf16 v[208:211], a[136:139], v[24:27], v[208:211]
    ds_read_b64_tr_b16 a[132:133], v240 offset:36864
    v_mfma_f32_16x16x32_bf16 v[216:219], a[136:139], v[28:31], v[216:219]
    ds_read_b64_tr_b16 a[134:135], v240 offset:37632
    v_lshlrev_b32 v251, 1, v251
    v_mfma_f32_16x16x32_bf16 v[212:215], a[140:143], v[24:27], v[212:215]
    ds_read_b64_tr_b16 a[136:137], v241 offset:24608
    v_mfma_f32_16x16x32_bf16 v[220:223], a[140:143], v[28:31], v[220:223]
    ds_read_b64_tr_b16 a[138:139], v241 offset:25376
    s_waitcnt lgkmcnt(6)
    v_mfma_f32_16x16x32_bf16 v[224:227], a[144:147], v[24:27], v[224:227]
    ds_read_b64_tr_b16 a[140:141], v241 offset:36896
    v_mfma_f32_16x16x32_bf16 v[232:235], a[144:147], v[28:31], v[232:235]
    ds_read_b64_tr_b16 a[142:143], v241 offset:37664
    v_and_b32 v252, 7, v1
    v_mfma_f32_16x16x32_bf16 v[228:231], a[148:151], v[24:27], v[228:231]
    ds_read_b64_tr_b16 a[144:145], v240 offset:24640
    v_mfma_f32_16x16x32_bf16 v[236:239], a[148:151], v[28:31], v[236:239]
    ds_read_b64_tr_b16 a[146:147], v240 offset:25408
    s_waitcnt lgkmcnt(6)
    v_mfma_f32_16x16x32_bf16 v[144:147], a[128:131], v[32:35], v[144:147]
    ds_read_b64_tr_b16 a[148:149], v240 offset:36928
    v_mfma_f32_16x16x32_bf16 v[152:155], a[128:131], v[36:39], v[152:155]
    ds_read_b64_tr_b16 a[150:151], v240 offset:37696
    v_xor_b32 v251, v251, v252
    v_mfma_f32_16x16x32_bf16 v[148:151], a[132:135], v[32:35], v[148:151]
    ds_read_b64_tr_b16 a[128:129], v241 offset:24672
    v_mfma_f32_16x16x32_bf16 v[156:159], a[132:135], v[36:39], v[156:159]
    ds_read_b64_tr_b16 a[130:131], v241 offset:25440
    s_waitcnt lgkmcnt(6)
    v_mfma_f32_16x16x32_bf16 v[160:163], a[136:139], v[32:35], v[160:163]
    ds_read_b64_tr_b16 a[132:133], v241 offset:36960
    v_mfma_f32_16x16x32_bf16 v[168:171], a[136:139], v[36:39], v[168:171]
    ds_read_b64_tr_b16 a[134:135], v241 offset:37728
    s_add_u32 m0, s59, 102400
    v_mfma_f32_16x16x32_bf16 v[164:167], a[140:143], v[32:35], v[164:167]
    ds_read_b64_tr_b16 a[136:137], v240 offset:24704
    v_mfma_f32_16x16x32_bf16 v[172:175], a[140:143], v[36:39], v[172:175]
    ds_read_b64_tr_b16 a[138:139], v240 offset:25472
    buffer_load_dwordx4 v8, s[28:31], s12 offen offset:0 lds
    v_lshlrev_b32 v251, 4, v251
    s_waitcnt lgkmcnt(6)
    v_mfma_f32_16x16x32_bf16 v[176:179], a[144:147], v[32:35], v[176:179]
    ds_read_b64_tr_b16 a[140:141], v240 offset:36992
    v_mfma_f32_16x16x32_bf16 v[184:187], a[144:147], v[36:39], v[184:187]
    ds_read_b64_tr_b16 a[142:143], v240 offset:37760
    v_mfma_f32_16x16x32_bf16 v[180:183], a[148:151], v[32:35], v[180:183]
    ds_read_b64_tr_b16 a[144:145], v241 offset:24736
    v_mfma_f32_16x16x32_bf16 v[188:191], a[148:151], v[36:39], v[188:191]
    ds_read_b64_tr_b16 a[146:147], v241 offset:25504
    buffer_load_dwordx4 v9, s[28:31], s12 offen offset:1024 lds
    v_lshl_add_u32 v251, v250, 10, v251
    s_waitcnt lgkmcnt(6)
    v_mfma_f32_16x16x32_bf16 v[192:195], a[128:131], v[32:35], v[192:195]
    ds_read_b64_tr_b16 a[148:149], v241 offset:37024
    v_mfma_f32_16x16x32_bf16 v[200:203], a[128:131], v[36:39], v[200:203]
    ds_read_b64_tr_b16 a[150:151], v241 offset:37792
    v_mfma_f32_16x16x32_bf16 v[196:199], a[132:135], v[32:35], v[196:199]
    ds_read_b64_tr_b16 a[128:129], v240 offset:30720
    v_mfma_f32_16x16x32_bf16 v[204:207], a[132:135], v[36:39], v[204:207]
    ds_read_b64_tr_b16 a[130:131], v240 offset:31488
    buffer_load_dwordx4 v10, s[28:31], s12 offen offset:2048 lds
    s_waitcnt lgkmcnt(6)
    v_mfma_f32_16x16x32_bf16 v[208:211], a[136:139], v[32:35], v[208:211]
    ds_read_b64_tr_b16 a[132:133], v240 offset:43008
    v_mfma_f32_16x16x32_bf16 v[216:219], a[136:139], v[36:39], v[216:219]
    ds_read_b64_tr_b16 a[134:135], v240 offset:43776
    s_lshl_b32 s3, s57, 7
    v_mfma_f32_16x16x32_bf16 v[212:215], a[140:143], v[32:35], v[212:215]
    ds_read_b64_tr_b16 a[136:137], v241 offset:30752
    v_mfma_f32_16x16x32_bf16 v[220:223], a[140:143], v[36:39], v[220:223]
    ds_read_b64_tr_b16 a[138:139], v241 offset:31520
    s_add_u32 m0, s59, 114688
    s_waitcnt lgkmcnt(6)
    v_mfma_f32_16x16x32_bf16 v[224:227], a[144:147], v[32:35], v[224:227]
    ds_read_b64_tr_b16 a[140:141], v241 offset:43040
    v_mfma_f32_16x16x32_bf16 v[232:235], a[144:147], v[36:39], v[232:235]
    ds_read_b64_tr_b16 a[142:143], v241 offset:43808
    buffer_load_dwordx4 v8, s[32:35], s12 offen offset:0 lds
    v_add_u32 v2, s3, v251
    v_mfma_f32_16x16x32_bf16 v[228:231], a[148:151], v[32:35], v[228:231]
    ds_read_b64_tr_b16 a[144:145], v240 offset:30784
    v_mfma_f32_16x16x32_bf16 v[236:239], a[148:151], v[36:39], v[236:239]
    ds_read_b64_tr_b16 a[146:147], v240 offset:31552
    s_waitcnt lgkmcnt(6)
    v_mfma_f32_16x16x32_bf16 v[144:147], a[128:131], v[40:43], v[144:147]
    ds_read_b64_tr_b16 a[148:149], v240 offset:43072
    v_mfma_f32_16x16x32_bf16 v[152:155], a[128:131], v[44:47], v[152:155]
    ds_read_b64_tr_b16 a[150:151], v240 offset:43840
    buffer_load_dwordx4 v9, s[32:35], s12 offen offset:1024 lds
    v_add_u32 v3, 7168, v2
    v_mfma_f32_16x16x32_bf16 v[148:151], a[132:135], v[40:43], v[148:151]
    ds_read_b64_tr_b16 a[128:129], v241 offset:30816
    v_mfma_f32_16x16x32_bf16 v[156:159], a[132:135], v[44:47], v[156:159]
    ds_read_b64_tr_b16 a[130:131], v241 offset:31584
    s_waitcnt lgkmcnt(6)
    v_mfma_f32_16x16x32_bf16 v[160:163], a[136:139], v[40:43], v[160:163]
    ds_read_b64_tr_b16 a[132:133], v241 offset:43104
    v_mfma_f32_16x16x32_bf16 v[168:171], a[136:139], v[44:47], v[168:171]
    ds_read_b64_tr_b16 a[134:135], v241 offset:43872
    buffer_load_dwordx4 v10, s[32:35], s12 offen offset:2048 lds
    v_mfma_f32_16x16x32_bf16 v[164:167], a[140:143], v[40:43], v[164:167]
    ds_read_b64_tr_b16 a[136:137], v240 offset:30848
    v_mfma_f32_16x16x32_bf16 v[172:175], a[140:143], v[44:47], v[172:175]
    ds_read_b64_tr_b16 a[138:139], v240 offset:31616
    v_add_u32 v4, 14336, v2
    s_waitcnt lgkmcnt(6)
    v_mfma_f32_16x16x32_bf16 v[176:179], a[144:147], v[40:43], v[176:179]
    ds_read_b64_tr_b16 a[140:141], v240 offset:43136
    v_mfma_f32_16x16x32_bf16 v[184:187], a[144:147], v[44:47], v[184:187]
    ds_read_b64_tr_b16 a[142:143], v240 offset:43904
    v_mfma_f32_16x16x32_bf16 v[180:183], a[148:151], v[40:43], v[180:183]
    ds_read_b64_tr_b16 a[144:145], v241 offset:30880
    v_mfma_f32_16x16x32_bf16 v[188:191], a[148:151], v[44:47], v[188:191]
    ds_read_b64_tr_b16 a[146:147], v241 offset:31648
    v_add_u32 v5, 21504, v2
    s_waitcnt lgkmcnt(6)
    v_mfma_f32_16x16x32_bf16 v[192:195], a[128:131], v[40:43], v[192:195]
    ds_read_b64_tr_b16 a[148:149], v241 offset:43168
    v_mfma_f32_16x16x32_bf16 v[200:203], a[128:131], v[44:47], v[200:203]
    ds_read_b64_tr_b16 a[150:151], v241 offset:43936
    v_mfma_f32_16x16x32_bf16 v[196:199], a[132:135], v[40:43], v[196:199]
    s_waitcnt vmcnt(6)
    s_barrier
    ds_read_b64_tr_b16 a[128:129], v240 offset:49152
    v_mfma_f32_16x16x32_bf16 v[204:207], a[132:135], v[44:47], v[204:207]
    ds_read_b64_tr_b16 a[130:131], v240 offset:49920
    s_lshl4_add_u32 s62, s53, s54
    s_lshl_b32 s62, s62, 7
    s_add_u32 s62, s62, 15728640
    s_cmp_lg_u32 s52, 0
    s_cbranch_scc1 Lpb_8
    v_mov_b32 v7, s48
    s_mov_b64 exec, 1
    buffer_store_dword v7, off, s[40:43], s62 sc1
    s_mov_b64 exec, -1
Lpb_8:
    s_waitcnt lgkmcnt(6)
    v_mfma_f32_16x16x32_bf16 v[208:211], a[136:139], v[40:43], v[208:211]
    ds_read_b64_tr_b16 a[132:133], v242 offset:0
    v_mfma_f32_16x16x32_bf16 v[216:219], a[136:139], v[44:47], v[216:219]
    ds_read_b64_tr_b16 a[134:135], v242 offset:768
    v_mfma_f32_16x16x32_bf16 v[212:215], a[140:143], v[40:43], v[212:215]
    ds_read_b64_tr_b16 a[136:137], v241 offset:49184
    v_mfma_f32_16x16x32_bf16 v[220:223], a[140:143], v[44:47], v[220:223]
    ds_read_b64_tr_b16 a[138:139], v241 offset:49952
    s_waitcnt lgkmcnt(6)
    v_mfma_f32_16x16x32_bf16 v[224:227], a[144:147], v[40:43], v[224:227]
    ds_read_b64_tr_b16 a[140:141], v243 offset:32
    v_mfma_f32_16x16x32_bf16 v[232:235], a[144:147], v[44:47], v[232:235]
    ds_read_b64_tr_b16 a[142:143], v243 offset:800
    v_mfma_f32_16x16x32_bf16 v[228:231], a[148:151], v[40:43], v[228:231]
    ds_read_b64_tr_b16 a[144:145], v240 offset:49216
    v_mfma_f32_16x16x32_bf16 v[236:239], a[148:151], v[44:47], v[236:239]
    ds_read_b64_tr_b16 a[146:147], v240 offset:49984
    s_waitcnt lgkmcnt(6)
    v_mfma_f32_16x16x32_bf16 v[144:147], a[128:131], v[48:51], v[144:147]
    ds_read_b64_tr_b16 a[148:149], v242 offset:64
    v_mfma_f32_16x16x32_bf16 v[152:155], a[128:131], v[52:55], v[152:155]
    ds_read_b64_tr_b16 a[150:151], v242 offset:832
    s_add_u32 m0, s59, 126976
    v_mfma_f32_16x16x32_bf16 v[148:151], a[132:135], v[48:51], v[148:151]
    ds_read_b64_tr_b16 a[128:129], v241 offset:49248
    v_mfma_f32_16x16x32_bf16 v[156:159], a[132:135], v[52:55], v[156:159]
    ds_read_b64_tr_b16 a[130:131], v241 offset:50016
    buffer_load_dwordx4 v8, s[28:31], s13 offen offset:0 lds
    s_waitcnt lgkmcnt(6)
    v_mfma_f32_16x16x32_bf16 v[160:163], a[136:139], v[48:51], v[160:163]
    ds_read_b64_tr_b16 a[132:133], v243 offset:96
    v_mfma_f32_16x16x32_bf16 v[168:171], a[136:139], v[52:55], v[168:171]
    ds_read_b64_tr_b16 a[134:135], v243 offset:864
    s_lshr_b32 s61, s0, 1
    v_mfma_f32_16x16x32_bf16 v[164:167], a[140:143], v[48:51], v[164:167]
    ds_read_b64_tr_b16 a[136:137], v240 offset:49280
    v_mfma_f32_16x16x32_bf16 v[172:175], a[140:143], v[52:55], v[172:175]
    ds_read_b64_tr_b16 a[138:139], v240 offset:50048
    buffer_load_dwordx4 v9, s[28:31], s13 offen offset:1024 lds
    s_waitcnt lgkmcnt(6)
    v_mfma_f32_16x16x32_bf16 v[176:179], a[144:147], v[48:51], v[176:179]
    ds_read_b64_tr_b16 a[140:141], v242 offset:128
    v_mfma_f32_16x16x32_bf16 v[184:187], a[144:147], v[52:55], v[184:187]
    ds_read_b64_tr_b16 a[142:143], v242 offset:896
    v_mfma_f32_16x16x32_bf16 v[180:183], a[148:151], v[48:51], v[180:183]
    ds_read_b64_tr_b16 a[144:145], v241 offset:49312
    v_mfma_f32_16x16x32_bf16 v[188:191], a[148:151], v[52:55], v[188:191]
    ds_read_b64_tr_b16 a[146:147], v241 offset:50080
    buffer_load_dwordx4 v10, s[28:31], s13 offen offset:2048 lds
    v_lshrrev_b32 v250, 2, v1
    s_waitcnt lgkmcnt(6)
    v_mfma_f32_16x16x32_bf16 v[192:195], a[128:131], v[48:51], v[192:195]
    ds_read_b64_tr_b16 a[148:149], v243 offset:160
    v_mfma_f32_16x16x32_bf16 v[200:203], a[128:131], v[52:55], v[200:203]
    ds_read_b64_tr_b16 a[150:151], v243 offset:928
    v_mfma_f32_16x16x32_bf16 v[196:199], a[132:135], v[48:51], v[196:199]
    ds_read_b64_tr_b16 a[128:129], v240 offset:55296
    v_mfma_f32_16x16x32_bf16 v[204:207], a[132:135], v[52:55], v[204:207]
    ds_read_b64_tr_b16 a[130:131], v240 offset:56064
    s_add_u32 m0, s59, 139264
    s_waitcnt lgkmcnt(6)
    v_mfma_f32_16x16x32_bf16 v[208:211], a[136:139], v[48:51], v[208:211]
    ds_read_b64_tr_b16 a[132:133], v242 offset:6144
    v_mfma_f32_16x16x32_bf16 v[216:219], a[136:139], v[52:55], v[216:219]
    ds_read_b64_tr_b16 a[134:135], v242 offset:6912
    buffer_load_dwordx4 v8, s[32:35], s13 offen offset:0 lds
    v_min_u32 v250, 2, v250
    v_mfma_f32_16x16x32_bf16 v[212:215], a[140:143], v[48:51], v[212:215]
    ds_read_b64_tr_b16 a[136:137], v241 offset:55328
    v_mfma_f32_16x16x32_bf16 v[220:223], a[140:143], v[52:55], v[220:223]
    ds_read_b64_tr_b16 a[138:139], v241 offset:56096
    s_waitcnt lgkmcnt(6)
    v_mfma_f32_16x16x32_bf16 v[224:227], a[144:147], v[48:51], v[224:227]
    ds_read_b64_tr_b16 a[140:141], v243 offset:6176
    v_mfma_f32_16x16x32_bf16 v[232:235], a[144:147], v[52:55], v[232:235]
    ds_read_b64_tr_b16 a[142:143], v243 offset:6944
    buffer_load_dwordx4 v9, s[32:35], s13 offen offset:1024 lds
    v_mfma_f32_16x16x32_bf16 v[228:231], a[148:151], v[48:51], v[228:231]
    ds_read_b64_tr_b16 a[144:145], v240 offset:55360
    v_mfma_f32_16x16x32_bf16 v[236:239], a[148:151], v[52:55], v[236:239]
    ds_read_b64_tr_b16 a[146:147], v240 offset:56128
    v_lshl_add_u32 v250, v250, 5, s1
    s_waitcnt lgkmcnt(6)
    v_mfma_f32_16x16x32_bf16 v[144:147], a[128:131], v[56:59], v[144:147]
    ds_read_b64_tr_b16 a[148:149], v242 offset:6208
    v_mfma_f32_16x16x32_bf16 v[152:155], a[128:131], v[60:63], v[152:155]
    ds_read_b64_tr_b16 a[150:151], v242 offset:6976
    buffer_load_dwordx4 v10, s[32:35], s13 offen offset:2048 lds
    v_mfma_f32_16x16x32_bf16 v[148:151], a[132:135], v[56:59], v[148:151]
    ds_read_b64_tr_b16 a[128:129], v241 offset:55392
    v_mfma_f32_16x16x32_bf16 v[156:159], a[132:135], v[60:63], v[156:159]
    ds_read_b64_tr_b16 a[130:131], v241 offset:56160
    s_waitcnt lgkmcnt(6)
    v_mfma_f32_16x16x32_bf16 v[160:163], a[136:139], v[56:59], v[160:163]
    ds_read_b64_tr_b16 a[132:133], v243 offset:6240
    v_mfma_f32_16x16x32_bf16 v[168:171], a[136:139], v[60:63], v[168:171]
    ds_read_b64_tr_b16 a[134:135], v243 offset:7008
    s_add_u32 m0, s59, 151552
    v_mul_u32_u24 v250, 43, v250
    v_mfma_f32_16x16x32_bf16 v[164:167], a[140:143], v[56:59], v[164:167]
    ds_read_b64_tr_b16 a[136:137], v240 offset:55424
    v_mfma_f32_16x16x32_bf16 v[172:175], a[140:143], v[60:63], v[172:175]
    ds_read_b64_tr_b16 a[138:139], v240 offset:56192
    buffer_load_dwordx4 v8, s[28:31], s14 offen offset:0 lds
    s_waitcnt lgkmcnt(6)
    v_mfma_f32_16x16x32_bf16 v[176:179], a[144:147], v[56:59], v[176:179]
    ds_read_b64_tr_b16 a[140:141], v242 offset:6272
    v_mfma_f32_16x16x32_bf16 v[184:187], a[144:147], v[60:63], v[184:187]
    ds_read_b64_tr_b16 a[142:143], v242 offset:7040
    v_mfma_f32_16x16x32_bf16 v[180:183], a[148:151], v[56:59], v[180:183]
    ds_read_b64_tr_b16 a[144:145], v241 offset:55456
    v_mfma_f32_16x16x32_bf16 v[188:191], a[148:151], v[60:63], v[188:191]
    ds_read_b64_tr_b16 a[146:147], v241 offset:56224
    buffer_load_dwordx4 v9, s[28:31], s14 offen offset:1024 lds
    v_lshrrev_b32 v250, 8, v250
    s_waitcnt lgkmcnt(6)
    v_mfma_f32_16x16x32_bf16 v[192:195], a[128:131], v[56:59], v[192:195]
    ds_read_b64_tr_b16 a[148:149], v243 offset:6304
    v_mfma_f32_16x16x32_bf16 v[200:203], a[128:131], v[60:63], v[200:203]
    ds_read_b64_tr_b16 a[150:151], v243 offset:7072
    v_mfma_f32_16x16x32_bf16 v[196:199], a[132:135], v[56:59], v[196:199]
    ds_read_b64_tr_b16 a[128:129], v242 offset:12288
    v_mfma_f32_16x16x32_bf16 v[204:207], a[132:135], v[60:63], v[204:207]
    ds_read_b64_tr_b16 a[130:131], v242 offset:13056
    buffer_load_dwordx4 v10, s[28:31], s14 offen offset:2048 lds
    s_waitcnt lgkmcnt(6)
    v_mfma_f32_16x16x32_bf16 v[208:211], a[136:139], v[56:59], v[208:211]
    ds_read_b64_tr_b16 a[132:133], v242 offset:24576
    v_mfma_f32_16x16x32_bf16 v[216:219], a[136:139], v[60:63], v[216:219]
    ds_read_b64_tr_b16 a[134:135], v242 offset:25344
    v_and_b32 v251, 3, v1
    v_mfma_f32_16x16x32_bf16 v[212:215], a[140:143], v[56:59], v[212:215]
    ds_read_b64_tr_b16 a[136:137], v243 offset:12320
    v_mfma_f32_16x16x32_bf16 v[220:223], a[140:143], v[60:63], v[220:223]
    ds_read_b64_tr_b16 a[138:139], v243 offset:13088
    s_add_u32 m0, s59, 0
    s_waitcnt lgkmcnt(6)
    v_mfma_f32_16x16x32_bf16 v[224:227], a[144:147], v[56:59], v[224:227]
    ds_read_b64_tr_b16 a[140:141], v243 offset:24608
    v_mfma_f32_16x16x32_bf16 v[232:235], a[144:147], v[60:63], v[232:235]
    ds_read_b64_tr_b16 a[142:143], v243 offset:25376
    buffer_load_dwordx4 v8, s[32:35], s14 offen offset:0 lds
    v_mfma_f32_16x16x32_bf16 v[228:231], a[148:151], v[56:59], v[228:231]
    ds_read_b64_tr_b16 a[144:145], v242 offset:12352
    v_mfma_f32_16x16x32_bf16 v[236:239], a[148:151], v[60:63], v[236:239]
    ds_read_b64_tr_b16 a[146:147], v242 offset:13120
    v_min_u32 v251, 2, v251
    s_waitcnt lgkmcnt(6)
    v_mfma_f32_16x16x32_bf16 v[144:147], a[128:131], v[64:67], v[144:147]
    ds_read_b64_tr_b16 a[148:149], v242 offset:24640
    v_mfma_f32_16x16x32_bf16 v[152:155], a[128:131], v[68:71], v[152:155]
    ds_read_b64_tr_b16 a[150:151], v242 offset:25408
    buffer_load_dwordx4 v9, s[32:35], s14 offen offset:1024 lds
    v_mfma_f32_16x16x32_bf16 v[148:151], a[132:135], v[64:67], v[148:151]
    ds_read_b64_tr_b16 a[128:129], v243 offset:12384
    v_mfma_f32_16x16x32_bf16 v[156:159], a[132:135], v[68:71], v[156:159]
    ds_read_b64_tr_b16 a[130:131], v243 offset:13152
    s_waitcnt lgkmcnt(6)
    v_mfma_f32_16x16x32_bf16 v[160:163], a[136:139], v[64:67], v[160:163]
    ds_read_b64_tr_b16 a[132:133], v243 offset:24672
    v_mfma_f32_16x16x32_bf16 v[168:171], a[136:139], v[68:71], v[168:171]
    ds_read_b64_tr_b16 a[134:135], v243 offset:25440
    buffer_load_dwordx4 v10, s[32:35], s14 offen offset:2048 lds
    v_sub_u32 v251, s61, v251
    v_mfma_f32_16x16x32_bf16 v[164:167], a[140:143], v[64:67], v[164:167]
    ds_read_b64_tr_b16 a[136:137], v242 offset:12416
    v_mfma_f32_16x16x32_bf16 v[172:175], a[140:143], v[68:71], v[172:175]
    ds_read_b64_tr_b16 a[138:139], v242 offset:13184
    s_waitcnt lgkmcnt(6)
    v_mfma_f32_16x16x32_bf16 v[176:179], a[144:147], v[64:67], v[176:179]
    ds_read_b64_tr_b16 a[140:141], v242 offset:24704
    v_mfma_f32_16x16x32_bf16 v[184:187], a[144:147], v[68:71], v[184:187]
    ds_read_b64_tr_b16 a[142:143], v242 offset:25472
    s_add_u32 m0, s59, 12288
    v_mfma_f32_16x16x32_bf16 v[180:183], a[148:151], v[64:67], v[180:183]
    ds_read_b64_tr_b16 a[144:145], v243 offset:12448
    v_mfma_f32_16x16x32_bf16 v[188:191], a[148:151], v[68:71], v[188:191]
    ds_read_b64_tr_b16 a[146:147], v243 offset:13216
    buffer_load_dwordx4 v8, s[28:31], s15 offen offset:0 lds
    v_max_i32 v251, 0, v251
    s_waitcnt lgkmcnt(6)
    v_mfma_f32_16x16x32_bf16 v[192:195], a[128:131], v[64:67], v[192:195]
    ds_read_b64_tr_b16 a[148:149], v243 offset:24736
    v_mfma_f32_16x16x32_bf16 v[200:203], a[128:131], v[68:71], v[200:203]
    ds_read_b64_tr_b16 a[150:151], v243 offset:25504
    v_mfma_f32_16x16x32_bf16 v[196:199], a[132:135], v[64:67], v[196:199]
    ds_read_b64_tr_b16 a[128:129], v242 offset:18432
    v_mfma_f32_16x16x32_bf16 v[204:207], a[132:135], v[68:71], v[204:207]
    ds_read_b64_tr_b16 a[130:131], v242 offset:19200
    buffer_load_dwordx4 v9, s[28:31], s15 offen offset:1024 lds
    s_waitcnt lgkmcnt(6)
    v_mfma_f32_16x16x32_bf16 v[208:211], a[136:139], v[64:67], v[208:211]
    ds_read_b64_tr_b16 a[132:133], v242 offset:30720
    v_mfma_f32_16x16x32_bf16 v[216:219], a[136:139], v[68:71], v[216:219]
    ds_read_b64_tr_b16 a[134:135], v242 offset:31488
    v_lshl_add_u32 v250, v251, 4, v250
    v_mfma_f32_16x16x32_bf16 v[212:215], a[140:143], v[64:67], v[212:215]
    ds_read_b64_tr_b16 a[136:137], v243 offset:18464
    v_mfma_f32_16x16x32_bf16 v[220:223], a[140:143], v[68:71], v[220:223]
    ds_read_b64_tr_b16 a[138:139], v243 offset:19232
    buffer_load_dwordx4 v10, s[28:31], s15 offen offset:2048 lds
    s_waitcnt lgkmcnt(6)
    v_mfma_f32_16x16x32_bf16 v[224:227], a[144:147], v[64:67], v[224:227]
    ds_read_b64_tr_b16 a[140:141], v243 offset:30752
    v_mfma_f32_16x16x32_bf16 v[232:235], a[144:147], v[68:71], v[232:235]
    ds_read_b64_tr_b16 a[142:143], v243 offset:31520
    v_mfma_f32_16x16x32_bf16 v[228:231], a[148:151], v[64:67], v[228:231]
    ds_read_b64_tr_b16 a[144:145], v242 offset:18496
    v_mfma_f32_16x16x32_bf16 v[236:239], a[148:151], v[68:71], v[236:239]
    ds_read_b64_tr_b16 a[146:147], v242 offset:19264
    s_add_u32 m0, s59, 24576
    v_lshlrev_b32 v250, 7, v250
    s_waitcnt lgkmcnt(6)
    v_mfma_f32_16x16x32_bf16 v[144:147], a[128:131], v[72:75], v[144:147]
    ds_read_b64_tr_b16 a[148:149], v242 offset:30784
    v_mfma_f32_16x16x32_bf16 v[152:155], a[128:131], v[76:79], v[152:155]
    ds_read_b64_tr_b16 a[150:151], v242 offset:31552
    buffer_load_dwordx4 v8, s[32:35], s15 offen offset:0 lds
    buffer_load_dword v254, v15, s[36:39], s64 offen
    v_mfma_f32_16x16x32_bf16 v[148:151], a[132:135], v[72:75], v[148:151]
    ds_read_b64_tr_b16 a[128:129], v243 offset:18528
    v_mfma_f32_16x16x32_bf16 v[156:159], a[132:135], v[76:79], v[156:159]
    ds_read_b64_tr_b16 a[130:131], v243 offset:19296
    s_waitcnt lgkmcnt(6)
    v_mfma_f32_16x16x32_bf16 v[160:163], a[136:139], v[72:75], v[160:163]
    ds_read_b64_tr_b16 a[132:133], v243 offset:30816
    v_mfma_f32_16x16x32_bf16 v[168:171], a[136:139], v[76:79], v[168:171]
    ds_read_b64_tr_b16 a[134:135], v243 offset:31584
    buffer_load_dwordx4 v9, s[32:35], s15 offen offset:1024 lds
    v_add_u32 v6, 15728640, v250
    v_mfma_f32_16x16x32_bf16 v[164:167], a[140:143], v[72:75], v[164:167]
    ds_read_b64_tr_b16 a[136:137], v242 offset:18560
    v_mfma_f32_16x16x32_bf16 v[172:175], a[140:143], v[76:79], v[172:175]
    ds_read_b64_tr_b16 a[138:139], v242 offset:19328
    s_waitcnt lgkmcnt(6)
    v_mfma_f32_16x16x32_bf16 v[176:179], a[144:147], v[72:75], v[176:179]
    ds_read_b64_tr_b16 a[140:141], v242 offset:30848
    v_mfma_f32_16x16x32_bf16 v[184:187], a[144:147], v[76:79], v[184:187]
    ds_read_b64_tr_b16 a[142:143], v242 offset:31616
    buffer_load_dwordx4 v10, s[32:35], s15 offen offset:2048 lds
    v_mfma_f32_16x16x32_bf16 v[180:183], a[148:151], v[72:75], v[180:183]
    ds_read_b64_tr_b16 a[144:145], v243 offset:18592
    v_mfma_f32_16x16x32_bf16 v[188:191], a[148:151], v[76:79], v[188:191]
    ds_read_b64_tr_b16 a[146:147], v243 offset:19360
    s_waitcnt lgkmcnt(6)
    v_mfma_f32_16x16x32_bf16 v[192:195], a[128:131], v[72:75], v[192:195]
    ds_read_b64_tr_b16 a[148:149], v243 offset:30880
    v_mfma_f32_16x16x32_bf16 v[200:203], a[128:131], v[76:79], v[200:203]
    ds_read_b64_tr_b16 a[150:151], v243 offset:31648
    v_mfma_f32_16x16x32_bf16 v[196:199], a[132:135], v[72:75], v[196:199]
    s_waitcnt vmcnt(13)
    s_barrier
    ds_read_b64_tr_b16 a[128:129], v242 offset:36864
    v_mfma_f32_16x16x32_bf16 v[204:207], a[132:135], v[76:79], v[204:207]
    ds_read_b64_tr_b16 a[130:131], v242 offset:37632
    s_waitcnt lgkmcnt(6)
    v_mfma_f32_16x16x32_bf16 v[208:211], a[136:139], v[72:75], v[208:211]
    ds_read_b64_tr_b16 a[132:133], v242 offset:49152
    v_mfma_f32_16x16x32_bf16 v[216:219], a[136:139], v[76:79], v[216:219]
    ds_read_b64_tr_b16 a[134:135], v242 offset:49920
    v_mfma_f32_16x16x32_bf16 v[212:215], a[140:143], v[72:75], v[212:215]
    ds_read_b64_tr_b16 a[136:137], v243 offset:36896
    v_mfma_f32_16x16x32_bf16 v[220:223], a[140:143], v[76:79], v[220:223]
    ds_read_b64_tr_b16 a[138:139], v243 offset:37664
    s_waitcnt lgkmcnt(6)
    v_mfma_f32_16x16x32_bf16 v[224:227], a[144:147], v[72:75], v[224:227]
    ds_read_b64_tr_b16 a[140:141], v243 offset:49184
    v_mfma_f32_16x16x32_bf16 v[232:235], a[144:147], v[76:79], v[232:235]
    ds_read_b64_tr_b16 a[142:143], v243 offset:49952
    s_mov_b32 s44, s8
    v_mfma_f32_16x16x32_bf16 v[228:231], a[148:151], v[72:75], v[228:231]
    ds_read_b64_tr_b16 a[144:145], v242 offset:36928
    v_mfma_f32_16x16x32_bf16 v[236:239], a[148:151], v[76:79], v[236:239]
    ds_read_b64_tr_b16 a[146:147], v242 offset:37696
    s_mov_b32 s45, s9
    s_waitcnt lgkmcnt(6)
    v_mfma_f32_16x16x32_bf16 v[144:147], a[128:131], v[80:83], v[144:147]
    ds_read_b64_tr_b16 a[148:149], v242 offset:49216
    v_mfma_f32_16x16x32_bf16 v[152:155], a[128:131], v[84:87], v[152:155]
    ds_read_b64_tr_b16 a[150:151], v242 offset:49984
    s_mov_b32 s46, 524288
    v_mfma_f32_16x16x32_bf16 v[148:151], a[132:135], v[80:83], v[148:151]
    ds_read_b64_tr_b16 a[128:129], v243 offset:36960
    v_mfma_f32_16x16x32_bf16 v[156:159], a[132:135], v[84:87], v[156:159]
    ds_read_b64_tr_b16 a[130:131], v243 offset:37728
    s_mov_b32 s47, 0x20000
    s_waitcnt lgkmcnt(6)
    v_mfma_f32_16x16x32_bf16 v[160:163], a[136:139], v[80:83], v[160:163]
    ds_read_b64_tr_b16 a[132:133], v243 offset:49248
    v_mfma_f32_16x16x32_bf16 v[168:171], a[136:139], v[84:87], v[168:171]
    ds_read_b64_tr_b16 a[134:135], v243 offset:50016
    v_and_b32 v15, 3, v1
    v_mfma_f32_16x16x32_bf16 v[164:167], a[140:143], v[80:83], v[164:167]
    ds_read_b64_tr_b16 a[136:137], v242 offset:36992
    v_mfma_f32_16x16x32_bf16 v[172:175], a[140:143], v[84:87], v[172:175]
    ds_read_b64_tr_b16 a[138:139], v242 offset:37760
    v_bfe_u32 v253, v1, 2, 2
    s_waitcnt lgkmcnt(6)
    v_mfma_f32_16x16x32_bf16 v[176:179], a[144:147], v[80:83], v[176:179]
    ds_read_b64_tr_b16 a[140:141], v242 offset:49280
    v_mfma_f32_16x16x32_bf16 v[184:187], a[144:147], v[84:87], v[184:187]
    ds_read_b64_tr_b16 a[142:143], v242 offset:50048
    v_lshlrev_b32 v15, 7, v15
    v_mfma_f32_16x16x32_bf16 v[180:183], a[148:151], v[80:83], v[180:183]
    ds_read_b64_tr_b16 a[144:145], v243 offset:37024
    v_mfma_f32_16x16x32_bf16 v[188:191], a[148:151], v[84:87], v[188:191]
    ds_read_b64_tr_b16 a[146:147], v243 offset:37792
    v_lshl_add_u32 v15, v253, 10, v15
    s_waitcnt lgkmcnt(6)
    v_mfma_f32_16x16x32_bf16 v[192:195], a[128:131], v[80:83], v[192:195]
    ds_read_b64_tr_b16 a[148:149], v243 offset:49312
    v_mfma_f32_16x16x32_bf16 v[200:203], a[128:131], v[84:87], v[200:203]
    ds_read_b64_tr_b16 a[150:151], v243 offset:50080
    s_lshl_b32 s67, s67, 12
    v_mfma_f32_16x16x32_bf16 v[196:199], a[132:135], v[80:83], v[196:199]
    ds_read_b64_tr_b16 a[128:129], v242 offset:43008
    v_mfma_f32_16x16x32_bf16 v[204:207], a[132:135], v[84:87], v[204:207]
    ds_read_b64_tr_b16 a[130:131], v242 offset:43776
    s_add_u32 s67, s67, s64
    s_waitcnt lgkmcnt(6)
    v_mfma_f32_16x16x32_bf16 v[208:211], a[136:139], v[80:83], v[208:211]
    ds_read_b64_tr_b16 a[132:133], v242 offset:55296
    v_mfma_f32_16x16x32_bf16 v[216:219], a[136:139], v[84:87], v[216:219]
    ds_read_b64_tr_b16 a[134:135], v242 offset:56064
    buffer_load_dword v254, v15, s[44:47], s67 offen
    v_mfma_f32_16x16x32_bf16 v[212:215], a[140:143], v[80:83], v[212:215]
    ds_read_b64_tr_b16 a[136:137], v243 offset:43040
    v_mfma_f32_16x16x32_bf16 v[220:223], a[140:143], v[84:87], v[220:223]
    ds_read_b64_tr_b16 a[138:139], v243 offset:43808
    s_waitcnt lgkmcnt(6)
    v_mfma_f32_16x16x32_bf16 v[224:227], a[144:147], v[80:83], v[224:227]
    ds_read_b64_tr_b16 a[140:141], v243 offset:55328
    v_mfma_f32_16x16x32_bf16 v[232:235], a[144:147], v[84:87], v[232:235]
    ds_read_b64_tr_b16 a[142:143], v243 offset:56096
    v_mfma_f32_16x16x32_bf16 v[228:231], a[148:151], v[80:83], v[228:231]
    ds_read_b64_tr_b16 a[144:145], v242 offset:43072
    v_mfma_f32_16x16x32_bf16 v[236:239], a[148:151], v[84:87], v[236:239]
    ds_read_b64_tr_b16 a[146:147], v242 offset:43840
    s_waitcnt lgkmcnt(6)
    v_mfma_f32_16x16x32_bf16 v[144:147], a[128:131], v[88:91], v[144:147]
    ds_read_b64_tr_b16 a[148:149], v242 offset:55360
    v_mfma_f32_16x16x32_bf16 v[152:155], a[128:131], v[92:95], v[152:155]
    ds_read_b64_tr_b16 a[150:151], v242 offset:56128
    v_mfma_f32_16x16x32_bf16 v[148:151], a[132:135], v[88:91], v[148:151]
    ds_read_b64_tr_b16 a[128:129], v243 offset:43104
    v_mfma_f32_16x16x32_bf16 v[156:159], a[132:135], v[92:95], v[156:159]
    ds_read_b64_tr_b16 a[130:131], v243 offset:43872
    s_waitcnt lgkmcnt(6)
    v_mfma_f32_16x16x32_bf16 v[160:163], a[136:139], v[88:91], v[160:163]
    ds_read_b64_tr_b16 a[132:133], v243 offset:55392
    v_mfma_f32_16x16x32_bf16 v[168:171], a[136:139], v[92:95], v[168:171]
    ds_read_b64_tr_b16 a[134:135], v243 offset:56160
    v_mfma_f32_16x16x32_bf16 v[164:167], a[140:143], v[88:91], v[164:167]
    ds_read_b64_tr_b16 a[136:137], v242 offset:43136
    v_mfma_f32_16x16x32_bf16 v[172:175], a[140:143], v[92:95], v[172:175]
    ds_read_b64_tr_b16 a[138:139], v242 offset:43904
    s_waitcnt lgkmcnt(6)
    v_mfma_f32_16x16x32_bf16 v[176:179], a[144:147], v[88:91], v[176:179]
    ds_read_b64_tr_b16 a[140:141], v242 offset:55424
    v_mfma_f32_16x16x32_bf16 v[184:187], a[144:147], v[92:95], v[184:187]
    ds_read_b64_tr_b16 a[142:143], v242 offset:56192
    v_mfma_f32_16x16x32_bf16 v[180:183], a[148:151], v[88:91], v[180:183]
    ds_read_b64_tr_b16 a[144:145], v243 offset:43168
    v_mfma_f32_16x16x32_bf16 v[188:191], a[148:151], v[92:95], v[188:191]
    ds_read_b64_tr_b16 a[146:147], v243 offset:43936
    s_waitcnt lgkmcnt(6)
    v_mfma_f32_16x16x32_bf16 v[192:195], a[128:131], v[88:91], v[192:195]
    ds_read_b64_tr_b16 a[148:149], v243 offset:55456
    v_mfma_f32_16x16x32_bf16 v[200:203], a[128:131], v[92:95], v[200:203]
    ds_read_b64_tr_b16 a[150:151], v243 offset:56224
    v_mfma_f32_16x16x32_bf16 v[196:199], a[132:135], v[88:91], v[196:199]
    ds_read_b64_tr_b16 a[128:129], v244 offset:0
    v_mfma_f32_16x16x32_bf16 v[204:207], a[132:135], v[92:95], v[204:207]
    ds_read_b64_tr_b16 a[130:131], v244 offset:768
    s_waitcnt lgkmcnt(6)
    v_mfma_f32_16x16x32_bf16 v[208:211], a[136:139], v[88:91], v[208:211]
    ds_read_b64_tr_b16 a[132:133], v244 offset:12288
    v_mfma_f32_16x16x32_bf16 v[216:219], a[136:139], v[92:95], v[216:219]
    ds_read_b64_tr_b16 a[134:135], v244 offset:13056
    v_mfma_f32_16x16x32_bf16 v[212:215], a[140:143], v[88:91], v[212:215]
    ds_read_b64_tr_b16 a[136:137], v245 offset:32
    v_mfma_f32_16x16x32_bf16 v[220:223], a[140:143], v[92:95], v[220:223]
    ds_read_b64_tr_b16 a[138:139], v245 offset:800
    s_waitcnt lgkmcnt(6)
    v_mfma_f32_16x16x32_bf16 v[224:227], a[144:147], v[88:91], v[224:227]
    ds_read_b64_tr_b16 a[140:141], v245 offset:12320
    v_mfma_f32_16x16x32_bf16 v[232:235], a[144:147], v[92:95], v[232:235]
    ds_read_b64_tr_b16 a[142:143], v245 offset:13088
    v_mfma_f32_16x16x32_bf16 v[228:231], a[148:151], v[88:91], v[228:231]
    ds_read_b64_tr_b16 a[144:145], v244 offset:64
    v_mfma_f32_16x16x32_bf16 v[236:239], a[148:151], v[92:95], v[236:239]
    ds_read_b64_tr_b16 a[146:147], v244 offset:832
    s_waitcnt lgkmcnt(6)
    v_mfma_f32_16x16x32_bf16 v[144:147], a[128:131], v[96:99], v[144:147]
    ds_read_b64_tr_b16 a[148:149], v244 offset:12352
    v_mfma_f32_16x16x32_bf16 v[152:155], a[128:131], v[100:103], v[152:155]
    ds_read_b64_tr_b16 a[150:151], v244 offset:13120
    v_mfma_f32_16x16x32_bf16 v[148:151], a[132:135], v[96:99], v[148:151]
    ds_read_b64_tr_b16 a[128:129], v245 offset:96
    v_mfma_f32_16x16x32_bf16 v[156:159], a[132:135], v[100:103], v[156:159]
    ds_read_b64_tr_b16 a[130:131], v245 offset:864
    s_waitcnt lgkmcnt(6)
    v_mfma_f32_16x16x32_bf16 v[160:163], a[136:139], v[96:99], v[160:163]
    ds_read_b64_tr_b16 a[132:133], v245 offset:12384
    v_mfma_f32_16x16x32_bf16 v[168:171], a[136:139], v[100:103], v[168:171]
    ds_read_b64_tr_b16 a[134:135], v245 offset:13152
    v_mov_b32 v252, 0xffff
    v_mov_b32 v253, 0xffff0000
    v_mfma_f32_16x16x32_bf16 v[164:167], a[140:143], v[96:99], v[164:167]
    ds_read_b64_tr_b16 a[136:137], v244 offset:128
    v_mfma_f32_16x16x32_bf16 v[172:175], a[140:143], v[100:103], v[172:175]
    ds_read_b64_tr_b16 a[138:139], v244 offset:896
    v_mov_b32 v8, 0xff800000
    s_waitcnt lgkmcnt(6)
    v_mfma_f32_16x16x32_bf16 v[176:179], a[144:147], v[96:99], v[176:179]
    ds_read_b64_tr_b16 a[140:141], v244 offset:12416
    v_mfma_f32_16x16x32_bf16 v[184:187], a[144:147], v[100:103], v[184:187]
    ds_read_b64_tr_b16 a[142:143], v244 offset:13184
    v_cndmask_b32 v250, 0, v252, s[70:71]
    v_cndmask_b32 v251, 0, v253, s[72:73]
    v_mfma_f32_16x16x32_bf16 v[180:183], a[148:151], v[96:99], v[180:183]
    ds_read_b64_tr_b16 a[144:145], v245 offset:160
    v_mfma_f32_16x16x32_bf16 v[188:191], a[148:151], v[100:103], v[188:191]
    ds_read_b64_tr_b16 a[146:147], v245 offset:928
    v_or_b32 v80, v250, v251
    s_waitcnt lgkmcnt(6)
    v_mfma_f32_16x16x32_bf16 v[192:195], a[128:131], v[96:99], v[192:195]
    ds_read_b64_tr_b16 a[148:149], v245 offset:12448
    v_mfma_f32_16x16x32_bf16 v[200:203], a[128:131], v[100:103], v[200:203]
    ds_read_b64_tr_b16 a[150:151], v245 offset:13216
    v_cndmask_b32 v250, 0, v252, s[74:75]
    v_mfma_f32_16x16x32_bf16 v[196:199], a[132:135], v[96:99], v[196:199]
    ds_read_b64_tr_b16 a[128:129], v244 offset:6144
    v_mfma_f32_16x16x32_bf16 v[204:207], a[132:135], v[100:103], v[204:207]
    ds_read_b64_tr_b16 a[130:131], v244 offset:6912
    v_cndmask_b32 v251, 0, v253, s[76:77]
    v_or_b32 v81, v250, v251
    s_waitcnt lgkmcnt(6)
    v_mfma_f32_16x16x32_bf16 v[208:211], a[136:139], v[96:99], v[208:211]
    ds_read_b64_tr_b16 a[132:133], v244 offset:18432
    v_mfma_f32_16x16x32_bf16 v[216:219], a[136:139], v[100:103], v[216:219]
    ds_read_b64_tr_b16 a[134:135], v244 offset:19200
    v_cndmask_b32 v250, 0, v252, s[78:79]
    v_mfma_f32_16x16x32_bf16 v[212:215], a[140:143], v[96:99], v[212:215]
    ds_read_b64_tr_b16 a[136:137], v245 offset:6176
    v_mfma_f32_16x16x32_bf16 v[220:223], a[140:143], v[100:103], v[220:223]
    ds_read_b64_tr_b16 a[138:139], v245 offset:6944
    v_cndmask_b32 v251, 0, v253, s[80:81]
    v_or_b32 v82, v250, v251
    s_waitcnt lgkmcnt(6)
    v_mfma_f32_16x16x32_bf16 v[224:227], a[144:147], v[96:99], v[224:227]
    ds_read_b64_tr_b16 a[140:141], v245 offset:18464
    v_mfma_f32_16x16x32_bf16 v[232:235], a[144:147], v[100:103], v[232:235]
    ds_read_b64_tr_b16 a[142:143], v245 offset:19232
    s_add_u32 m0, s20, 0
    s_nop 0
    v_cndmask_b32 v250, 0, v252, s[82:83]
    v_mfma_f32_16x16x32_bf16 v[228:231], a[148:151], v[96:99], v[228:231]
    ds_read_b64_tr_b16 a[144:145], v244 offset:6208
    v_mfma_f32_16x16x32_bf16 v[236:239], a[148:151], v[100:103], v[236:239]
    ds_read_b64_tr_b16 a[146:147], v244 offset:6976
    buffer_load_dwordx4 v2, s[36:39], s66 offen offset:0 lds
    v_cndmask_b32 v251, 0, v253, s[84:85]
    s_waitcnt lgkmcnt(6)
    v_mfma_f32_16x16x32_bf16 v[144:147], a[128:131], v[104:107], v[144:147]
    ds_read_b64_tr_b16 a[148:149], v244 offset:18496
    v_mfma_f32_16x16x32_bf16 v[152:155], a[128:131], v[108:111], v[152:155]
    ds_read_b64_tr_b16 a[150:151], v244 offset:19264
    buffer_load_dwordx4 v3, s[36:39], s66 offen offset:1024 lds
    v_or_b32 v83, v250, v251
    v_cndmask_b32 v250, 0, v252, s[86:87]
    v_mfma_f32_16x16x32_bf16 v[148:151], a[132:135], v[104:107], v[148:151]
    ds_read_b64_tr_b16 a[128:129], v245 offset:6240
    v_mfma_f32_16x16x32_bf16 v[156:159], a[132:135], v[108:111], v[156:159]
    ds_read_b64_tr_b16 a[130:131], v245 offset:7008
    buffer_load_dwordx4 v4, s[36:39], s66 offen offset:2048 lds
    v_cndmask_b32 v251, 0, v253, s[88:89]
    s_waitcnt lgkmcnt(6)
    v_mfma_f32_16x16x32_bf16 v[160:163], a[136:139], v[104:107], v[160:163]
    ds_read_b64_tr_b16 a[132:133], v245 offset:18528
    v_mfma_f32_16x16x32_bf16 v[168:171], a[136:139], v[108:111], v[168:171]
    ds_read_b64_tr_b16 a[134:135], v245 offset:19296
    buffer_load_dword v7, v6, s[40:43], 0 offen sc1
    buffer_load_dwordx4 v5, s[36:39], s66 offen offset:3072 lds
    v_or_b32 v84, v250, v251
    v_cndmask_b32 v250, 0, v252, s[90:91]
    v_mfma_f32_16x16x32_bf16 v[164:167], a[140:143], v[104:107], v[164:167]
    ds_read_b64_tr_b16 a[136:137], v244 offset:6272
    v_mfma_f32_16x16x32_bf16 v[172:175], a[140:143], v[108:111], v[172:175]
    ds_read_b64_tr_b16 a[138:139], v244 offset:7040
    s_add_u32 m0, s20, 4096
    v_cndmask_b32 v251, 0, v253, s[92:93]
    s_waitcnt lgkmcnt(6)
    v_mfma_f32_16x16x32_bf16 v[176:179], a[144:147], v[104:107], v[176:179]
    ds_read_b64_tr_b16 a[140:141], v244 offset:18560
    v_mfma_f32_16x16x32_bf16 v[184:187], a[144:147], v[108:111], v[184:187]
    ds_read_b64_tr_b16 a[142:143], v244 offset:19328
    s_add_u32 s66, s66, 32768
    v_or_b32 v85, v250, v251
    v_mfma_f32_16x16x32_bf16 v[180:183], a[148:151], v[104:107], v[180:183]
    ds_read_b64_tr_b16 a[144:145], v245 offset:6304
    v_mfma_f32_16x16x32_bf16 v[188:191], a[148:151], v[108:111], v[188:191]
    ds_read_b64_tr_b16 a[146:147], v245 offset:7072
    buffer_load_dwordx4 v2, s[36:39], s66 offen offset:0 lds
    v_cndmask_b32 v250, 0, v252, s[94:95]
    v_cndmask_b32 v251, 0, v253, s[96:97]
    s_waitcnt lgkmcnt(6)
    v_mfma_f32_16x16x32_bf16 v[192:195], a[128:131], v[104:107], v[192:195]
    ds_read_b64_tr_b16 a[148:149], v245 offset:18592
    v_mfma_f32_16x16x32_bf16 v[200:203], a[128:131], v[108:111], v[200:203]
    ds_read_b64_tr_b16 a[150:151], v245 offset:19360
    buffer_load_dwordx4 v3, s[36:39], s66 offen offset:1024 lds
    v_or_b32 v86, v250, v251
    v_mfma_f32_16x16x32_bf16 v[196:199], a[132:135], v[104:107], v[196:199]
    s_waitcnt vmcnt(8)
    s_barrier
    ds_read_b64_tr_b16 a[128:129], v244 offset:24576
    v_mfma_f32_16x16x32_bf16 v[204:207], a[132:135], v[108:111], v[204:207]
    ds_read_b64_tr_b16 a[130:131], v244 offset:25344
    buffer_load_dwordx4 v4, s[36:39], s66 offen offset:2048 lds
    v_cndmask_b32 v250, 0, v252, s[98:99]
    v_cndmask_b32 v251, 0, v253, s[100:101]
    s_waitcnt lgkmcnt(6)
    v_mfma_f32_16x16x32_bf16 v[208:211], a[136:139], v[104:107], v[208:211]
    ds_read_b64_tr_b16 a[132:133], v240 offset:0
    v_mfma_f32_16x16x32_bf16 v[216:219], a[136:139], v[108:111], v[216:219]
    ds_read_b64_tr_b16 a[134:135], v240 offset:768
    buffer_load_dwordx4 v5, s[36:39], s66 offen offset:3072 lds
    v_or_b32 v87, v250, v251
    v_mfma_f32_16x16x32_bf16 v[212:215], a[140:143], v[104:107], v[212:215]
    ds_read_b64_tr_b16 a[136:137], v245 offset:24608
    v_mfma_f32_16x16x32_bf16 v[220:223], a[140:143], v[108:111], v[220:223]
    ds_read_b64_tr_b16 a[138:139], v245 offset:25376
    s_add_u32 m0, s20, 8192
    s_add_u32 s66, s66, 32768
    s_mov_b32 s28, s16
    s_waitcnt lgkmcnt(6)
    v_mfma_f32_16x16x32_bf16 v[224:227], a[144:147], v[104:107], v[224:227]
    ds_read_b64_tr_b16 a[140:141], v241 offset:32
    v_mfma_f32_16x16x32_bf16 v[232:235], a[144:147], v[108:111], v[232:235]
    ds_read_b64_tr_b16 a[142:143], v241 offset:800
    buffer_load_dwordx4 v2, s[36:39], s66 offen offset:0 lds
    s_mov_b32 s29, s17
    s_mov_b32 s30, 1409024
    v_mfma_f32_16x16x32_bf16 v[228:231], a[148:151], v[104:107], v[228:231]
    ds_read_b64_tr_b16 a[144:145], v244 offset:24640
    v_mfma_f32_16x16x32_bf16 v[236:239], a[148:151], v[108:111], v[236:239]
    ds_read_b64_tr_b16 a[146:147], v244 offset:25408
    buffer_load_dwordx4 v3, s[36:39], s66 offen offset:1024 lds
    s_mov_b32 s31, 0x20000
    s_waitcnt lgkmcnt(6)
    v_mfma_f32_16x16x32_bf16 v[144:147], a[128:131], v[112:115], v[144:147]
    ds_read_b64_tr_b16 a[148:149], v240 offset:64
    v_mfma_f32_16x16x32_bf16 v[152:155], a[128:131], v[116:119], v[152:155]
    ds_read_b64_tr_b16 a[150:151], v240 offset:832
    buffer_load_dwordx4 v4, s[36:39], s66 offen offset:2048 lds
    s_mov_b32 s32, s8
    s_mov_b32 s33, s9
    v_mfma_f32_16x16x32_bf16 v[148:151], a[132:135], v[112:115], v[148:151]
    ds_read_b64_tr_b16 a[128:129], v245 offset:24672
    v_mfma_f32_16x16x32_bf16 v[156:159], a[132:135], v[116:119], v[156:159]
    ds_read_b64_tr_b16 a[130:131], v245 offset:25440
    buffer_load_dwordx4 v5, s[36:39], s66 offen offset:3072 lds
    s_mov_b32 s34, 524288
    s_waitcnt lgkmcnt(6)
    v_mfma_f32_16x16x32_bf16 v[160:163], a[136:139], v[112:115], v[160:163]
    ds_read_b64_tr_b16 a[132:133], v241 offset:96
    v_mfma_f32_16x16x32_bf16 v[168:171], a[136:139], v[116:119], v[168:171]
    ds_read_b64_tr_b16 a[134:135], v241 offset:864
    s_add_u32 m0, s20, 12288
    s_mov_b32 s35, 0x20000
    v_mfma_f32_16x16x32_bf16 v[164:167], a[140:143], v[112:115], v[164:167]
    ds_read_b64_tr_b16 a[136:137], v244 offset:24704
    v_mfma_f32_16x16x32_bf16 v[172:175], a[140:143], v[116:119], v[172:175]
    ds_read_b64_tr_b16 a[138:139], v244 offset:25472
    s_add_u32 s66, s66, 32768
    s_mul_i32 s65, s56, 240
    s_mul_i32 s23, s52, 11
    s_waitcnt lgkmcnt(6)
    v_mfma_f32_16x16x32_bf16 v[176:179], a[144:147], v[112:115], v[176:179]
    ds_read_b64_tr_b16 a[140:141], v240 offset:128
    v_mfma_f32_16x16x32_bf16 v[184:187], a[144:147], v[116:119], v[184:187]
    ds_read_b64_tr_b16 a[142:143], v240 offset:896
    buffer_load_dwordx4 v2, s[36:39], s66 offen offset:0 lds
    s_add_u32 s65, s65, s23
    v_mfma_f32_16x16x32_bf16 v[180:183], a[148:151], v[112:115], v[180:183]
    ds_read_b64_tr_b16 a[144:145], v245 offset:24736
    v_mfma_f32_16x16x32_bf16 v[188:191], a[148:151], v[116:119], v[188:191]
    ds_read_b64_tr_b16 a[146:147], v245 offset:25504
    buffer_load_dwordx4 v3, s[36:39], s66 offen offset:1024 lds
    s_lshl_b32 s65, s65, 10
    s_add_u32 s65, s65, 7356416
    s_waitcnt lgkmcnt(6)
    v_mfma_f32_16x16x32_bf16 v[192:195], a[128:131], v[112:115], v[192:195]
    ds_read_b64_tr_b16 a[148:149], v241 offset:160
    v_mfma_f32_16x16x32_bf16 v[200:203], a[128:131], v[116:119], v[200:203]
    ds_read_b64_tr_b16 a[150:151], v241 offset:928
    buffer_load_dwordx4 v4, s[36:39], s66 offen offset:2048 lds
    v_mov_b32 v88, v14
    v_mfma_f32_16x16x32_bf16 v[196:199], a[132:135], v[112:115], v[196:199]
    ds_read_b64_tr_b16 a[128:129], v244 offset:30720
    v_mfma_f32_16x16x32_bf16 v[204:207], a[132:135], v[116:119], v[204:207]
    ds_read_b64_tr_b16 a[130:131], v244 offset:31488
    buffer_load_dwordx4 v5, s[36:39], s66 offen offset:3072 lds
    v_add_u32 v89, 61440, v14
    s_waitcnt lgkmcnt(6)
    v_mfma_f32_16x16x32_bf16 v[208:211], a[136:139], v[112:115], v[208:211]
    ds_read_b64_tr_b16 a[132:133], v240 offset:6144
    v_mfma_f32_16x16x32_bf16 v[216:219], a[136:139], v[116:119], v[216:219]
    ds_read_b64_tr_b16 a[134:135], v240 offset:6912
    s_waitcnt vmcnt(13)
    v_cmp_ne_u32 vcc, s48, v7
    s_nop 0
    s_cbranch_vccnz Lsp_9
Lok_10:
    v_add_u32 v90, 122880, v14
    v_add_u32 v91, 184320, v14
    v_mfma_f32_16x16x32_bf16 v[212:215], a[140:143], v[112:115], v[212:215]
    ds_read_b64_tr_b16 a[136:137], v245 offset:30752
    v_mfma_f32_16x16x32_bf16 v[220:223], a[140:143], v[116:119], v[220:223]
    ds_read_b64_tr_b16 a[138:139], v245 offset:31520
    s_mul_i32 s60, s0, 192
    s_add_u32 s60, s60, s1
    v_bfe_u32 v250, v1, 2, 4
    s_waitcnt lgkmcnt(6)
    v_mfma_f32_16x16x32_bf16 v[224:227], a[144:147], v[112:115], v[224:227]
    ds_read_b64_tr_b16 a[140:141], v241 offset:6176
    v_mfma_f32_16x16x32_bf16 v[232:235], a[144:147], v[116:119], v[232:235]
    ds_read_b64_tr_b16 a[142:143], v241 offset:6944
    s_lshl_b32 s60, s60, 10
    v_lshlrev_b32 v250, 7, v250
    v_bfe_u32 v251, v1, 3, 2
    v_mfma_f32_16x16x32_bf16 v[228:231], a[148:151], v[112:115], v[228:231]
    ds_read_b64_tr_b16 a[144:145], v244 offset:30784
    v_mfma_f32_16x16x32_bf16 v[236:239], a[148:151], v[116:119], v[236:239]
    ds_read_b64_tr_b16 a[146:147], v244 offset:31552
    s_lshl_b32 s64, s52, 12
    v_lshl_add_u32 v250, v251, 5, v250
    s_waitcnt lgkmcnt(6)
    v_mfma_f32_16x16x32_bf16 v[144:147], a[128:131], v[120:123], v[144:147]
    ds_read_b64_tr_b16 a[148:149], v240 offset:6208
    v_mfma_f32_16x16x32_bf16 v[152:155], a[128:131], v[124:127], v[152:155]
    ds_read_b64_tr_b16 a[150:151], v240 offset:6976
    s_add_u32 s64, s64, 102400
    v_and_b32 v251, 3, v1
    v_mfma_f32_16x16x32_bf16 v[148:151], a[132:135], v[120:123], v[148:151]
    ds_read_b64_tr_b16 a[128:129], v245 offset:30816
    v_mfma_f32_16x16x32_bf16 v[156:159], a[132:135], v[124:127], v[156:159]
    ds_read_b64_tr_b16 a[130:131], v245 offset:31584
    s_add_u32 m0, s64, 16384
    v_lshl_add_u32 v250, v251, 3, v250
    v_add_u32 v92, s20, v250
    s_waitcnt lgkmcnt(6)
    v_mfma_f32_16x16x32_bf16 v[160:163], a[136:139], v[120:123], v[160:163]
    ds_read_b64_tr_b16 a[132:133], v241 offset:6240
    v_mfma_f32_16x16x32_bf16 v[168:171], a[136:139], v[124:127], v[168:171]
    ds_read_b64_tr_b16 a[134:135], v241 offset:7008
    s_add_u32 s61, s60, 0x8000
    buffer_load_dwordx4 v14, s[40:43], s61 offen sc1 lds
    v_xor_b32 v93, 32, v92
    v_mfma_f32_16x16x32_bf16 v[164:167], a[140:143], v[120:123], v[164:167]
    ds_read_b64_tr_b16 a[136:137], v244 offset:30848
    v_mfma_f32_16x16x32_bf16 v[172:175], a[140:143], v[124:127], v[172:175]
    ds_read_b64_tr_b16 a[138:139], v244 offset:31616
    s_add_u32 s61, s60, 0xfc00
    v_xor_b32 v94, 64, v92
    v_xor_b32 v95, 96, v92
    s_waitcnt lgkmcnt(6)
    v_mfma_f32_16x16x32_bf16 v[176:179], a[144:147], v[120:123], v[176:179]
    ds_read_b64_tr_b16 a[140:141], v240 offset:6272
    v_mfma_f32_16x16x32_bf16 v[184:187], a[144:147], v[124:127], v[184:187]
    ds_read_b64_tr_b16 a[142:143], v240 offset:7040
    buffer_load_dwordx4 v14, s[40:43], s61 offen offset:1024 sc1 lds
    v_mul_f32 v16, 0xc0135761, v248
    v_mfma_f32_16x16x32_bf16 v[180:183], a[148:151], v[120:123], v[180:183]
    ds_read_b64_tr_b16 a[144:145], v245 offset:30880
    v_mfma_f32_16x16x32_bf16 v[188:191], a[148:151], v[124:127], v[188:191]
    ds_read_b64_tr_b16 a[146:147], v245 offset:31648
    s_add_u32 m0, s64, 18432
    v_mul_f32 v24, v248, v248
    s_waitcnt lgkmcnt(6)
    v_mfma_f32_16x16x32_bf16 v[192:195], a[128:131], v[120:123], v[192:195]
    ds_read_b64_tr_b16 a[148:149], v241 offset:6304
    v_mfma_f32_16x16x32_bf16 v[200:203], a[128:131], v[124:127], v[200:203]
    ds_read_b64_tr_b16 a[150:151], v241 offset:7072
    s_add_u32 s61, s60, 0x20000
    v_mul_f32 v20, v16, v24
    v_mul_f32 v20, 0x3d372713, v20
    v_mfma_f32_16x16x32_bf16 v[196:199], a[132:135], v[120:123], v[196:199]
    ds_read_b64_tr_b16 a[128:129], v240 offset:12288
    v_mfma_f32_16x16x32_bf16 v[204:207], a[132:135], v[124:127], v[204:207]
    ds_read_b64_tr_b16 a[130:131], v240 offset:13056
    buffer_load_dwordx4 v14, s[40:43], s61 offen sc1 lds
    s_add_u32 s61, s60, 0x27c00
    v_rcp_f32 v24, v24
    s_waitcnt lgkmcnt(6)
    v_mfma_f32_16x16x32_bf16 v[208:211], a[136:139], v[120:123], v[208:211]
    ds_read_b64_tr_b16 a[132:133], v240 offset:24576
    v_mfma_f32_16x16x32_bf16 v[216:219], a[136:139], v[124:127], v[216:219]
    ds_read_b64_tr_b16 a[134:135], v240 offset:25344
    buffer_load_dwordx4 v14, s[40:43], s61 offen offset:1024 sc1 lds
    v_mul_f32 v18, 0xc0135761, v249
    v_mul_f32 v26, v249, v249
    v_mfma_f32_16x16x32_bf16 v[212:215], a[140:143], v[120:123], v[212:215]
    ds_read_b64_tr_b16 a[136:137], v241 offset:12320
    v_mfma_f32_16x16x32_bf16 v[220:223], a[140:143], v[124:127], v[220:223]
    ds_read_b64_tr_b16 a[138:139], v241 offset:13088
    buffer_load_dwordx4 a[0:3], v14, s[40:43], s60 offen sc1
    v_mul_f32 v22, v18, v26
    s_waitcnt lgkmcnt(6)
    v_mfma_f32_16x16x32_bf16 v[224:227], a[144:147], v[120:123], v[224:227]
    ds_read_b64_tr_b16 a[140:141], v241 offset:24608
    v_mfma_f32_16x16x32_bf16 v[232:235], a[144:147], v[124:127], v[232:235]
    ds_read_b64_tr_b16 a[142:143], v241 offset:25376
    s_add_u32 s61, s60, 98304
    v_mul_f32 v22, 0x3d372713, v22
    v_mfma_f32_16x16x32_bf16 v[228:231], a[148:151], v[120:123], v[228:231]
    ds_read_b64_tr_b16 a[144:145], v240 offset:12352
    v_mfma_f32_16x16x32_bf16 v[236:239], a[148:151], v[124:127], v[236:239]
    ds_read_b64_tr_b16 a[146:147], v240 offset:13120
    buffer_load_dwordx4 a[4:7], v14, s[40:43], s61 offen sc1
    v_rcp_f32 v26, v26
    s_lshl2_add_u32 s67, s53, s52
    s_waitcnt lgkmcnt(6)
    v_mfma_f32_16x16x32_bf16 v[144:147], a[128:131], v[128:131], v[144:147]
    ds_read_b64_tr_b16 a[148:149], v240 offset:24640
    v_mfma_f32_16x16x32_bf16 v[152:155], a[128:131], v[132:135], v[152:155]
    ds_read_b64_tr_b16 a[150:151], v240 offset:25408
    s_mul_i32 s67, s67, 120
    v_mfma_f32_16x16x32_bf16 v[148:151], a[132:135], v[128:131], v[148:151]
    ds_read_b64_tr_b16 a[128:129], v241 offset:12384
    v_mfma_f32_16x16x32_bf16 v[156:159], a[132:135], v[132:135], v[156:159]
    ds_read_b64_tr_b16 a[130:131], v241 offset:13152
    s_mul_i32 s23, s54, 3
    s_add_u32 s67, s67, s23
    s_waitcnt lgkmcnt(6)
    v_mfma_f32_16x16x32_bf16 v[160:163], a[136:139], v[128:131], v[160:163]
    ds_read_b64_tr_b16 a[132:133], v241 offset:24672
    v_mfma_f32_16x16x32_bf16 v[168:171], a[136:139], v[132:135], v[168:171]
    ds_read_b64_tr_b16 a[134:135], v241 offset:25440
    s_lshl_b32 s67, s67, 10
    v_mfma_f32_16x16x32_bf16 v[164:167], a[140:143], v[128:131], v[164:167]
    ds_read_b64_tr_b16 a[136:137], v240 offset:12416
    v_mfma_f32_16x16x32_bf16 v[172:175], a[140:143], v[132:135], v[172:175]
    ds_read_b64_tr_b16 a[138:139], v240 offset:13184
    s_add_u32 s67, s67, 7356416
    s_waitcnt lgkmcnt(6)
    v_mfma_f32_16x16x32_bf16 v[176:179], a[144:147], v[128:131], v[176:179]
    ds_read_b64_tr_b16 a[140:141], v240 offset:24704
    v_mfma_f32_16x16x32_bf16 v[184:187], a[144:147], v[132:135], v[184:187]
    ds_read_b64_tr_b16 a[142:143], v240 offset:25472
    v_add_u32 v10, s64, v14
    v_add_u32 v28, 61440, v14
    s_mul_i32 s23, s52, 15
    v_mfma_f32_16x16x32_bf16 v[180:183], a[148:151], v[128:131], v[180:183]
    ds_read_b64_tr_b16 a[144:145], v241 offset:12448
    v_mfma_f32_16x16x32_bf16 v[188:191], a[148:151], v[132:135], v[188:191]
    ds_read_b64_tr_b16 a[146:147], v241 offset:13216
    v_and_b32 v11, 15, v1
    s_lshr_b32 s23, s23, 2
    s_waitcnt lgkmcnt(6)
    v_mfma_f32_16x16x32_bf16 v[192:195], a[128:131], v[128:131], v[192:195]
    ds_read_b64_tr_b16 a[148:149], v241 offset:24736
    v_mfma_f32_16x16x32_bf16 v[200:203], a[128:131], v[132:135], v[200:203]
    ds_read_b64_tr_b16 a[150:151], v241 offset:25504
    v_lshlrev_b32 v11, 4, v11
    v_lshrrev_b32 v250, 1, v1
    v_min_u32 v250, 4, v250
    v_mfma_f32_16x16x32_bf16 v[196:199], a[132:135], v[128:131], v[196:199]
    ds_read_b64_tr_b16 a[128:129], v240 offset:18432
    v_mfma_f32_16x16x32_bf16 v[204:207], a[132:135], v[132:135], v[204:207]
    ds_read_b64_tr_b16 a[130:131], v240 offset:19200
    v_lshrrev_b32 v13, 5, v1
    v_add_u32 v250, s23, v250
    s_waitcnt lgkmcnt(6)
    v_mfma_f32_16x16x32_bf16 v[208:211], a[136:139], v[128:131], v[208:211]
    ds_read_b64_tr_b16 a[132:133], v240 offset:30720
    v_mfma_f32_16x16x32_bf16 v[216:219], a[136:139], v[132:135], v[216:219]
    ds_read_b64_tr_b16 a[134:135], v240 offset:31488
    v_lshl_add_u32 v11, v13, 8, v11
    v_min_u32 v250, 14, v250
    v_mfma_f32_16x16x32_bf16 v[212:215], a[140:143], v[128:131], v[212:215]
    ds_read_b64_tr_b16 a[136:137], v241 offset:18464
    v_mfma_f32_16x16x32_bf16 v[220:223], a[140:143], v[132:135], v[220:223]
    ds_read_b64_tr_b16 a[138:139], v241 offset:19232
    v_add_u32 v11, s64, v11
    v_and_b32 v251, 1, v1
    v_lshl_add_u32 v251, s56, 1, v251
    s_waitcnt lgkmcnt(6)
    v_mfma_f32_16x16x32_bf16 v[224:227], a[144:147], v[128:131], v[224:227]
    ds_read_b64_tr_b16 a[140:141], v241 offset:30752
    v_mfma_f32_16x16x32_bf16 v[232:235], a[144:147], v[132:135], v[232:235]
    ds_read_b64_tr_b16 a[142:143], v241 offset:31520
    s_mov_b32 s68, 0xffff
    v_lshl_add_u32 v250, v251, 4, v250
    v_mfma_f32_16x16x32_bf16 v[228:231], a[148:151], v[128:131], v[228:231]
    ds_read_b64_tr_b16 a[144:145], v240 offset:18496
    v_mfma_f32_16x16x32_bf16 v[236:239], a[148:151], v[132:135], v[236:239]
    ds_read_b64_tr_b16 a[146:147], v240 offset:19264
    s_mov_b32 s69, 0xffff
    v_lshlrev_b32 v250, 7, v250
    v_add_u32 v15, 15794176, v250
    s_waitcnt lgkmcnt(6)
    v_mfma_f32_16x16x32_bf16 v[144:147], a[128:131], v[136:139], v[144:147]
    ds_read_b64_tr_b16 a[148:149], v240 offset:30784
    v_mfma_f32_16x16x32_bf16 v[152:155], a[128:131], v[140:143], v[152:155]
    ds_read_b64_tr_b16 a[150:151], v240 offset:31552
    s_add_u32 m0, s64, 0
    v_and_b32 v9, 1, v1
    v_mfma_f32_16x16x32_bf16 v[148:151], a[132:135], v[136:139], v[148:151]
    ds_read_b64_tr_b16 a[128:129], v241 offset:18528
    v_mfma_f32_16x16x32_bf16 v[156:159], a[132:135], v[140:143], v[156:159]
    ds_read_b64_tr_b16 a[130:131], v241 offset:19296
    v_add_u32 v12, -1, v9
    s_waitcnt lgkmcnt(6)
    v_mfma_f32_16x16x32_bf16 v[160:163], a[136:139], v[136:139], v[160:163]
    ds_read_b64_tr_b16 a[132:133], v241 offset:30816
    v_mfma_f32_16x16x32_bf16 v[168:171], a[136:139], v[140:143], v[168:171]
    ds_read_b64_tr_b16 a[134:135], v241 offset:31584
    s_add_u32 s61, s60, 0xfff48000
    v_or_b32 v12, 0xfffe0000, v12
    v_and_b32 v250, 7, v1
    v_mfma_f32_16x16x32_bf16 v[164:167], a[140:143], v[136:139], v[164:167]
    ds_read_b64_tr_b16 a[136:137], v240 offset:18560
    v_mfma_f32_16x16x32_bf16 v[172:175], a[140:143], v[140:143], v[172:175]
    ds_read_b64_tr_b16 a[138:139], v240 offset:19328
    buffer_load_dwordx4 v14, s[40:43], s61 offen sc1 lds
    v_lshl_add_u32 v250, s52, 3, v250
    s_waitcnt lgkmcnt(6)
    v_mfma_f32_16x16x32_bf16 v[176:179], a[144:147], v[136:139], v[176:179]
    ds_read_b64_tr_b16 a[140:141], v240 offset:30848
    v_mfma_f32_16x16x32_bf16 v[184:187], a[144:147], v[140:143], v[184:187]
    ds_read_b64_tr_b16 a[142:143], v240 offset:31616
    s_add_u32 s61, s60, 0xfff4fc00
    v_mul_u32_u24 v250, 43, v250
    v_lshrrev_b32 v250, 8, v250
    v_mfma_f32_16x16x32_bf16 v[180:183], a[148:151], v[136:139], v[180:183]
    ds_read_b64_tr_b16 a[144:145], v241 offset:18592
    v_mfma_f32_16x16x32_bf16 v[188:191], a[148:151], v[140:143], v[188:191]
    ds_read_b64_tr_b16 a[146:147], v241 offset:19360
    buffer_load_dwordx4 v14, s[40:43], s61 offen offset:1024 sc1 lds
    s_lshr_b32 s23, s56, 1
    s_waitcnt lgkmcnt(6)
    v_mfma_f32_16x16x32_bf16 v[192:195], a[128:131], v[136:139], v[192:195]
    ds_read_b64_tr_b16 a[148:149], v241 offset:30880
    v_mfma_f32_16x16x32_bf16 v[200:203], a[128:131], v[140:143], v[200:203]
    ds_read_b64_tr_b16 a[150:151], v241 offset:31648
    s_add_u32 m0, s64, 2048
    v_lshl_add_u32 v250, s23, 4, v250
    v_mfma_f32_16x16x32_bf16 v[196:199], a[132:135], v[136:139], v[196:199]
    v_mfma_f32_16x16x32_bf16 v[204:207], a[132:135], v[140:143], v[204:207]
    s_add_u32 s61, s60, 0xfff60000
    v_lshlrev_b32 v250, 7, v250
    v_add_u32 v250, 15728640, v250
    s_waitcnt lgkmcnt(4)
    v_mfma_f32_16x16x32_bf16 v[208:211], a[136:139], v[136:139], v[208:211]
    v_mfma_f32_16x16x32_bf16 v[216:219], a[136:139], v[140:143], v[216:219]
    buffer_load_dwordx4 v14, s[40:43], s61 offen sc1 lds
    v_cmp_gt_u32 s[14:15], 32, v1
    v_mfma_f32_16x16x32_bf16 v[212:215], a[140:143], v[136:139], v[212:215]
    v_mfma_f32_16x16x32_bf16 v[220:223], a[140:143], v[140:143], v[220:223]
    s_add_u32 s61, s60, 0xfff67c00
    v_cndmask_b32 v15, v250, v15, s[14:15]
    s_waitcnt lgkmcnt(0)
    v_mfma_f32_16x16x32_bf16 v[224:227], a[144:147], v[136:139], v[224:227]
    v_mfma_f32_16x16x32_bf16 v[232:235], a[144:147], v[140:143], v[232:235]
    buffer_load_dwordx4 v14, s[40:43], s61 offen offset:1024 sc1 lds
    v_mfma_f32_16x16x32_bf16 v[228:231], a[148:151], v[136:139], v[228:231]
    v_mfma_f32_16x16x32_bf16 v[236:239], a[148:151], v[140:143], v[236:239]
    s_waitcnt lgkmcnt(0)
    s_barrier
    s_add_u32 m0, s22, 0
    s_add_u32 s66, s66, 32768
    buffer_load_dwordx4 v2, s[36:39], s66 offen offset:0 lds
    s_cmp_ge_u32 s54, 15
    s_cselect_b32 s67, 0x40000000, s67
    v_pk_mul_f32 v[32:33], v[144:145], v[144:145]
    v_pk_mul_f32 v[34:35], v[146:147], v[146:147]
    v_pk_mul_f32 v[36:37], v[160:161], v[160:161]
    v_pk_mul_f32 v[38:39], v[162:163], v[162:163]
    v_pk_fma_f32 v[32:33], v[32:33], v[20:21], v[16:17] op_sel_hi:[1,0,0]
    v_pk_fma_f32 v[34:35], v[34:35], v[20:21], v[16:17] op_sel_hi:[1,0,0]
    v_pk_fma_f32 v[36:37], v[36:37], v[20:21], v[16:17] op_sel_hi:[1,0,0]
    v_pk_fma_f32 v[38:39], v[38:39], v[20:21], v[16:17] op_sel_hi:[1,0,0]
    v_pk_mul_f32 v[32:33], v[32:33], v[144:145]
    v_pk_mul_f32 v[34:35], v[34:35], v[146:147]
    v_pk_mul_f32 v[36:37], v[36:37], v[160:161]
    v_pk_mul_f32 v[38:39], v[38:39], v[162:163]
    buffer_load_dwordx4 v3, s[36:39], s66 offen offset:1024 lds
    v_exp_f32 v32, v32
    v_exp_f32 v33, v33
    v_exp_f32 v34, v34
    v_exp_f32 v35, v35
    v_exp_f32 v36, v36
    v_exp_f32 v37, v37
    buffer_load_dwordx4 v4, s[36:39], s66 offen offset:2048 lds
    v_exp_f32 v38, v38
    v_exp_f32 v39, v39
    v_pk_mul_f32 v[144:145], v[144:145], v[148:149]
    v_pk_mul_f32 v[146:147], v[146:147], v[150:151]
    v_pk_mul_f32 v[160:161], v[160:161], v[164:165]
    v_pk_mul_f32 v[162:163], v[162:163], v[166:167]
    v_pk_fma_f32 v[32:33], v[32:33], v[24:25], v[24:25] op_sel_hi:[1,0,0]
    v_pk_fma_f32 v[34:35], v[34:35], v[24:25], v[24:25] op_sel_hi:[1,0,0]
    v_pk_fma_f32 v[36:37], v[36:37], v[24:25], v[24:25] op_sel_hi:[1,0,0]
    v_pk_fma_f32 v[38:39], v[38:39], v[24:25], v[24:25] op_sel_hi:[1,0,0]
    buffer_load_dwordx4 v5, s[36:39], s66 offen offset:3072 lds
    v_rcp_f32 v32, v32
    v_rcp_f32 v33, v33
    v_rcp_f32 v34, v34
    v_rcp_f32 v35, v35
    v_rcp_f32 v36, v36
    v_rcp_f32 v37, v37
    v_rcp_f32 v38, v38
    s_add_u32 m0, s22, 4096
    s_add_u32 s66, s66, 32768
    buffer_load_dwordx4 v2, s[36:39], s66 offen offset:0 lds
    v_rcp_f32 v39, v39
    v_pk_mul_f32 v[144:145], v[144:145], v[32:33]
    v_pk_mul_f32 v[146:147], v[146:147], v[34:35]
    v_pk_mul_f32 v[160:161], v[160:161], v[36:37]
    v_pk_mul_f32 v[162:163], v[162:163], v[38:39]
    v_cvt_pk_bf16_f32 v40, v144, v145
    v_cvt_pk_bf16_f32 v41, v146, v147
    v_cvt_pk_bf16_f32 v42, v160, v161
    v_cvt_pk_bf16_f32 v43, v162, v163
    buffer_store_dwordx4 v[40:43], v14, s[40:43], s67 offen offset:0 sc1
    buffer_load_dwordx4 v3, s[36:39], s66 offen offset:1024 lds
    v_pk_mul_f32 v[32:33], v[152:153], v[152:153]
    v_pk_mul_f32 v[34:35], v[154:155], v[154:155]
    v_pk_mul_f32 v[36:37], v[168:169], v[168:169]
    v_pk_mul_f32 v[38:39], v[170:171], v[170:171]
    v_pk_fma_f32 v[32:33], v[32:33], v[22:23], v[18:19] op_sel_hi:[1,0,0]
    v_pk_fma_f32 v[34:35], v[34:35], v[22:23], v[18:19] op_sel_hi:[1,0,0]
    v_pk_fma_f32 v[36:37], v[36:37], v[22:23], v[18:19] op_sel_hi:[1,0,0]
    v_pk_fma_f32 v[38:39], v[38:39], v[22:23], v[18:19] op_sel_hi:[1,0,0]
    v_pk_mul_f32 v[32:33], v[32:33], v[152:153]
    v_pk_mul_f32 v[34:35], v[34:35], v[154:155]
    v_pk_mul_f32 v[36:37], v[36:37], v[168:169]
    v_pk_mul_f32 v[38:39], v[38:39], v[170:171]
    buffer_load_dwordx4 v4, s[36:39], s66 offen offset:2048 lds
    v_exp_f32 v32, v32
    v_exp_f32 v33, v33
    v_exp_f32 v34, v34
    v_exp_f32 v35, v35
    v_exp_f32 v36, v36
    v_exp_f32 v37, v37
    buffer_load_dwordx4 v5, s[36:39], s66 offen offset:3072 lds
    v_exp_f32 v38, v38
    v_exp_f32 v39, v39
    v_pk_mul_f32 v[152:153], v[152:153], v[156:157]
    v_pk_mul_f32 v[154:155], v[154:155], v[158:159]
    v_pk_mul_f32 v[168:169], v[168:169], v[172:173]
    v_pk_mul_f32 v[170:171], v[170:171], v[174:175]
    v_pk_fma_f32 v[32:33], v[32:33], v[26:27], v[26:27] op_sel_hi:[1,0,0]
    v_pk_fma_f32 v[34:35], v[34:35], v[26:27], v[26:27] op_sel_hi:[1,0,0]
    v_pk_fma_f32 v[36:37], v[36:37], v[26:27], v[26:27] op_sel_hi:[1,0,0]
    v_pk_fma_f32 v[38:39], v[38:39], v[26:27], v[26:27] op_sel_hi:[1,0,0]
    v_rcp_f32 v32, v32
    s_add_u32 m0, s22, 8192
    s_add_u32 s66, s66, 32768
    buffer_load_dwordx4 v2, s[36:39], s66 offen offset:0 lds
    v_rcp_f32 v33, v33
    v_rcp_f32 v34, v34
    v_rcp_f32 v35, v35
    v_rcp_f32 v36, v36
    v_rcp_f32 v37, v37
    v_rcp_f32 v38, v38
    buffer_load_dwordx4 v3, s[36:39], s66 offen offset:1024 lds
    v_rcp_f32 v39, v39
    v_pk_mul_f32 v[152:153], v[152:153], v[32:33]
    v_pk_mul_f32 v[154:155], v[154:155], v[34:35]
    v_pk_mul_f32 v[168:169], v[168:169], v[36:37]
    v_pk_mul_f32 v[170:171], v[170:171], v[38:39]
    v_cvt_pk_bf16_f32 v44, v152, v153
    v_cvt_pk_bf16_f32 v45, v154, v155
    v_cvt_pk_bf16_f32 v46, v168, v169
    v_cvt_pk_bf16_f32 v47, v170, v171
    buffer_store_dwordx4 v[44:47], v28, s[40:43], s67 offen offset:0 sc1
    buffer_load_dwordx4 v4, s[36:39], s66 offen offset:2048 lds
    v_pk_mul_f32 v[32:33], v[176:177], v[176:177]
    v_pk_mul_f32 v[34:35], v[178:179], v[178:179]
    v_pk_mul_f32 v[36:37], v[192:193], v[192:193]
    v_pk_mul_f32 v[38:39], v[194:195], v[194:195]
    v_pk_fma_f32 v[32:33], v[32:33], v[20:21], v[16:17] op_sel_hi:[1,0,0]
    v_pk_fma_f32 v[34:35], v[34:35], v[20:21], v[16:17] op_sel_hi:[1,0,0]
    v_pk_fma_f32 v[36:37], v[36:37], v[20:21], v[16:17] op_sel_hi:[1,0,0]
    v_pk_fma_f32 v[38:39], v[38:39], v[20:21], v[16:17] op_sel_hi:[1,0,0]
    v_pk_mul_f32 v[32:33], v[32:33], v[176:177]
    v_pk_mul_f32 v[34:35], v[34:35], v[178:179]
    v_pk_mul_f32 v[36:37], v[36:37], v[192:193]
    v_pk_mul_f32 v[38:39], v[38:39], v[194:195]
    buffer_load_dwordx4 v5, s[36:39], s66 offen offset:3072 lds
    v_exp_f32 v32, v32
    v_exp_f32 v33, v33
    v_exp_f32 v34, v34
    v_exp_f32 v35, v35
    v_exp_f32 v36, v36
    v_exp_f32 v37, v37
    v_exp_f32 v38, v38
    s_waitcnt vmcnt(14)
    s_barrier
    ds_read_b128 a[40:43], v10 offset:16384
    v_exp_f32 v39, v39
    v_pk_mul_f32 v[176:177], v[176:177], v[180:181]
    v_pk_mul_f32 v[178:179], v[178:179], v[182:183]
    v_pk_mul_f32 v[192:193], v[192:193], v[196:197]
    v_pk_mul_f32 v[194:195], v[194:195], v[198:199]
    v_pk_fma_f32 v[32:33], v[32:33], v[24:25], v[24:25] op_sel_hi:[1,0,0]
    v_pk_fma_f32 v[34:35], v[34:35], v[24:25], v[24:25] op_sel_hi:[1,0,0]
    v_pk_fma_f32 v[36:37], v[36:37], v[24:25], v[24:25] op_sel_hi:[1,0,0]
    v_pk_fma_f32 v[38:39], v[38:39], v[24:25], v[24:25] op_sel_hi:[1,0,0]
    v_rcp_f32 v32, v32
    ds_read_b128 a[8:11], v10 offset:0
    v_rcp_f32 v33, v33
    v_rcp_f32 v34, v34
    v_rcp_f32 v35, v35
    v_rcp_f32 v36, v36
    v_rcp_f32 v37, v37
    v_rcp_f32 v38, v38
    v_rcp_f32 v39, v39
    ds_read_b128 a[12:15], v10 offset:2048
    v_pk_mul_f32 v[176:177], v[176:177], v[32:33]
    v_pk_mul_f32 v[178:179], v[178:179], v[34:35]
    v_pk_mul_f32 v[192:193], v[192:193], v[36:37]
    v_pk_mul_f32 v[194:195], v[194:195], v[38:39]
    v_cvt_pk_bf16_f32 v40, v176, v177
    v_cvt_pk_bf16_f32 v41, v178, v179
    v_cvt_pk_bf16_f32 v42, v192, v193
    v_cvt_pk_bf16_f32 v43, v194, v195
    buffer_store_dwordx4 v[40:43], v14, s[40:43], s67 offen offset:1024 sc1
    v_pk_mul_f32 v[32:33], v[184:185], v[184:185]
    v_pk_mul_f32 v[34:35], v[186:187], v[186:187]
    v_pk_mul_f32 v[36:37], v[200:201], v[200:201]
    v_pk_mul_f32 v[38:39], v[202:203], v[202:203]
    ds_read_b128 a[16:19], v10 offset:4096
    v_pk_fma_f32 v[32:33], v[32:33], v[22:23], v[18:19] op_sel_hi:[1,0,0]
    v_pk_fma_f32 v[34:35], v[34:35], v[22:23], v[18:19] op_sel_hi:[1,0,0]
    v_pk_fma_f32 v[36:37], v[36:37], v[22:23], v[18:19] op_sel_hi:[1,0,0]
    v_pk_fma_f32 v[38:39], v[38:39], v[22:23], v[18:19] op_sel_hi:[1,0,0]
    v_pk_mul_f32 v[32:33], v[32:33], v[184:185]
    v_pk_mul_f32 v[34:35], v[34:35], v[186:187]
    v_pk_mul_f32 v[36:37], v[36:37], v[200:201]
    v_pk_mul_f32 v[38:39], v[38:39], v[202:203]
    v_exp_f32 v32, v32
    v_exp_f32 v33, v33
    v_exp_f32 v34, v34
    ds_read_b128 a[20:23], v10 offset:6144
    v_exp_f32 v35, v35
    v_exp_f32 v36, v36
    v_exp_f32 v37, v37
    v_exp_f32 v38, v38
    v_exp_f32 v39, v39
    v_pk_mul_f32 v[184:185], v[184:185], v[188:189]
    v_pk_mul_f32 v[186:187], v[186:187], v[190:191]
    v_pk_mul_f32 v[200:201], v[200:201], v[204:205]
    ds_read_b128 a[24:27], v10 offset:8192
    v_pk_mul_f32 v[202:203], v[202:203], v[206:207]
    v_pk_fma_f32 v[32:33], v[32:33], v[26:27], v[26:27] op_sel_hi:[1,0,0]
    v_pk_fma_f32 v[34:35], v[34:35], v[26:27], v[26:27] op_sel_hi:[1,0,0]
    v_pk_fma_f32 v[36:37], v[36:37], v[26:27], v[26:27] op_sel_hi:[1,0,0]
    v_pk_fma_f32 v[38:39], v[38:39], v[26:27], v[26:27] op_sel_hi:[1,0,0]
    v_rcp_f32 v32, v32
    v_rcp_f32 v33, v33
    v_rcp_f32 v34, v34
    v_rcp_f32 v35, v35
    v_rcp_f32 v36, v36
    ds_read_b128 a[28:31], v10 offset:10240
    v_rcp_f32 v37, v37
    v_rcp_f32 v38, v38
    v_rcp_f32 v39, v39
    v_pk_mul_f32 v[184:185], v[184:185], v[32:33]
    v_pk_mul_f32 v[186:187], v[186:187], v[34:35]
    v_pk_mul_f32 v[200:201], v[200:201], v[36:37]
    v_pk_mul_f32 v[202:203], v[202:203], v[38:39]
    v_cvt_pk_bf16_f32 v44, v184, v185
    v_cvt_pk_bf16_f32 v45, v186, v187
    ds_read_b128 a[32:35], v10 offset:12288
    v_cvt_pk_bf16_f32 v46, v200, v201
    v_cvt_pk_bf16_f32 v47, v202, v203
    buffer_store_dwordx4 v[44:47], v28, s[40:43], s67 offen offset:1024 sc1
    s_cmp_ge_u32 s54, 14
    s_cselect_b32 s67, 0x40000000, s67
    v_pk_mul_f32 v[32:33], v[208:209], v[208:209]
    v_pk_mul_f32 v[34:35], v[210:211], v[210:211]
    v_pk_mul_f32 v[36:37], v[224:225], v[224:225]
    v_pk_mul_f32 v[38:39], v[226:227], v[226:227]
    v_pk_fma_f32 v[32:33], v[32:33], v[20:21], v[16:17] op_sel_hi:[1,0,0]
    v_pk_fma_f32 v[34:35], v[34:35], v[20:21], v[16:17] op_sel_hi:[1,0,0]
    v_pk_fma_f32 v[36:37], v[36:37], v[20:21], v[16:17] op_sel_hi:[1,0,0]
    v_pk_fma_f32 v[38:39], v[38:39], v[20:21], v[16:17] op_sel_hi:[1,0,0]
    v_pk_mul_f32 v[32:33], v[32:33], v[208:209]
    v_pk_mul_f32 v[34:35], v[34:35], v[210:211]
    ds_read_b128 a[36:39], v10 offset:14336
    v_pk_mul_f32 v[36:37], v[36:37], v[224:225]
    v_pk_mul_f32 v[38:39], v[38:39], v[226:227]
    v_exp_f32 v32, v32
    v_exp_f32 v33, v33
    v_exp_f32 v34, v34
    v_exp_f32 v35, v35
    v_exp_f32 v36, v36
    v_exp_f32 v37, v37
    ds_read_b128 a[44:47], v10 offset:18432
    v_exp_f32 v38, v38
    v_exp_f32 v39, v39
    v_pk_mul_f32 v[208:209], v[208:209], v[212:213]
    v_pk_mul_f32 v[210:211], v[210:211], v[214:215]
    v_pk_mul_f32 v[224:225], v[224:225], v[228:229]
    v_pk_mul_f32 v[226:227], v[226:227], v[230:231]
    v_pk_fma_f32 v[32:33], v[32:33], v[24:25], v[24:25] op_sel_hi:[1,0,0]
    v_pk_fma_f32 v[34:35], v[34:35], v[24:25], v[24:25] op_sel_hi:[1,0,0]
    v_pk_fma_f32 v[36:37], v[36:37], v[24:25], v[24:25] op_sel_hi:[1,0,0]
    v_pk_fma_f32 v[38:39], v[38:39], v[24:25], v[24:25] op_sel_hi:[1,0,0]
    v_rcp_f32 v32, v32
    s_mov_b64 exec, s[68:69]
    ds_read_b128 a[112:115], v11 offset:17408
    ds_read_b128 a[116:119], v11 offset:17920
    ds_read_b128 a[48:51], v11 offset:1024
    ds_read_b128 a[52:55], v11 offset:1536
    s_mov_b64 exec, -1
    v_rcp_f32 v33, v33
    v_rcp_f32 v34, v34
    v_rcp_f32 v35, v35
    v_rcp_f32 v36, v36
    v_rcp_f32 v37, v37
    v_rcp_f32 v38, v38
    s_mov_b64 exec, s[68:69]
    ds_read_b128 a[56:59], v11 offset:3072
    ds_read_b128 a[60:63], v11 offset:3584
    ds_read_b128 a[64:67], v11 offset:5120
    ds_read_b128 a[68:71], v11 offset:5632
    s_mov_b64 exec, -1
    v_rcp_f32 v39, v39
    v_pk_mul_f32 v[208:209], v[208:209], v[32:33]
    v_pk_mul_f32 v[210:211], v[210:211], v[34:35]
    v_pk_mul_f32 v[224:225], v[224:225], v[36:37]
    v_pk_mul_f32 v[226:227], v[226:227], v[38:39]
    v_cvt_pk_bf16_f32 v40, v208, v209
    v_cvt_pk_bf16_f32 v41, v210, v211
    v_cvt_pk_bf16_f32 v42, v224, v225
    v_cvt_pk_bf16_f32 v43, v226, v227
    buffer_store_dwordx4 v[40:43], v14, s[40:43], s67 offen offset:2048 sc1
    v_pk_mul_f32 v[32:33], v[216:217], v[216:217]
    v_pk_mul_f32 v[34:35], v[218:219], v[218:219]
    v_pk_mul_f32 v[36:37], v[232:233], v[232:233]
    s_mov_b64 exec, s[68:69]
    ds_read_b128 a[72:75], v11 offset:7168
    ds_read_b128 a[76:79], v11 offset:7680
    ds_read_b128 a[80:83], v11 offset:9216
    ds_read_b128 a[84:87], v11 offset:9728
    s_mov_b64 exec, -1
    v_pk_mul_f32 v[38:39], v[234:235], v[234:235]
    v_pk_fma_f32 v[32:33], v[32:33], v[22:23], v[18:19] op_sel_hi:[1,0,0]
    v_pk_fma_f32 v[34:35], v[34:35], v[22:23], v[18:19] op_sel_hi:[1,0,0]
    v_pk_fma_f32 v[36:37], v[36:37], v[22:23], v[18:19] op_sel_hi:[1,0,0]
    v_pk_fma_f32 v[38:39], v[38:39], v[22:23], v[18:19] op_sel_hi:[1,0,0]
    v_pk_mul_f32 v[32:33], v[32:33], v[216:217]
    v_pk_mul_f32 v[34:35], v[34:35], v[218:219]
    v_pk_mul_f32 v[36:37], v[36:37], v[232:233]
    v_pk_mul_f32 v[38:39], v[38:39], v[234:235]
    v_exp_f32 v32, v32
    v_exp_f32 v33, v33
    s_mov_b64 exec, s[68:69]
    ds_read_b128 a[88:91], v11 offset:11264
    ds_read_b128 a[92:95], v11 offset:11776
    ds_read_b128 a[96:99], v11 offset:13312
    ds_read_b128 a[100:103], v11 offset:13824
    s_mov_b64 exec, -1
    v_exp_f32 v34, v34
    v_exp_f32 v35, v35
    v_exp_f32 v36, v36
    v_exp_f32 v37, v37
    v_exp_f32 v38, v38
    v_exp_f32 v39, v39
    v_pk_mul_f32 v[216:217], v[216:217], v[220:221]
    v_pk_mul_f32 v[218:219], v[218:219], v[222:223]
    s_mov_b64 exec, s[68:69]
    ds_read_b128 a[104:107], v11 offset:15360
    ds_read_b128 a[108:111], v11 offset:15872
    ds_read_b128 a[120:123], v11 offset:19456
    ds_read_b128 a[124:127], v11 offset:19968
    s_mov_b64 exec, -1
    v_pk_mul_f32 v[232:233], v[232:233], v[236:237]
    v_pk_mul_f32 v[234:235], v[234:235], v[238:239]
    v_pk_fma_f32 v[32:33], v[32:33], v[26:27], v[26:27] op_sel_hi:[1,0,0]
    v_pk_fma_f32 v[34:35], v[34:35], v[26:27], v[26:27] op_sel_hi:[1,0,0]
    v_pk_fma_f32 v[36:37], v[36:37], v[26:27], v[26:27] op_sel_hi:[1,0,0]
    v_pk_fma_f32 v[38:39], v[38:39], v[26:27], v[26:27] op_sel_hi:[1,0,0]
    v_rcp_f32 v32, v32
    v_rcp_f32 v33, v33
    v_rcp_f32 v34, v34
    v_rcp_f32 v35, v35
    v_rcp_f32 v36, v36
    v_rcp_f32 v37, v37
    v_rcp_f32 v38, v38
    v_rcp_f32 v39, v39
    v_pk_mul_f32 v[216:217], v[216:217], v[32:33]
    v_pk_mul_f32 v[218:219], v[218:219], v[34:35]
    v_pk_mul_f32 v[232:233], v[232:233], v[36:37]
    v_pk_mul_f32 v[234:235], v[234:235], v[38:39]
    v_cvt_pk_bf16_f32 v44, v216, v217
    v_cvt_pk_bf16_f32 v45, v218, v219
    v_cvt_pk_bf16_f32 v46, v232, v233
    v_cvt_pk_bf16_f32 v47, v234, v235
    buffer_store_dwordx4 v[44:47], v28, s[40:43], s67 offen offset:2048 sc1
    s_waitcnt lgkmcnt(0)
    s_barrier
    s_cmp_lt_u32 s0, 4
    s_cbranch_scc1 Ledge
    v_mfma_f32_32x32x16_bf16 v[32:47], a[40:43], a[0:3], 0
    v_mfma_f32_32x32x16_bf16 v[16:31], a[8:11], a[0:3], 0
    v_mfma_f32_32x32x16_bf16 v[48:63], a[12:15], a[0:3], 0
    ds_read_b64_tr_b16 v[144:145], v92 offset:0
    s_nop 9
    v_cndmask_b32 v64, v16, v32, s[70:71]
    v_cndmask_b32 v65, v17, v33, s[72:73]
    v_cndmask_b32 v66, v18, v34, s[74:75]
    ds_read_b64_tr_b16 v[146:147], v92 offset:2048
    v_cndmask_b32 v67, v19, v35, s[76:77]
    v_cndmask_b32 v68, v20, v36, s[78:79]
    ds_read_b64_tr_b16 v[148:149], v93 offset:0
    v_cndmask_b32 v69, v21, v37, s[80:81]
    v_cndmask_b32 v70, v22, v38, s[82:83]
    ds_read_b64_tr_b16 v[150:151], v93 offset:2048
    v_cndmask_b32 v71, v23, v39, s[84:85]
    v_cndmask_b32 v72, v24, v40, s[86:87]
    v_cndmask_b32 v73, v25, v41, s[88:89]
    ds_read_b64_tr_b16 v[152:153], v94 offset:0
    v_cndmask_b32 v74, v26, v42, s[90:91]
    v_cndmask_b32 v75, v27, v43, s[92:93]
    ds_read_b64_tr_b16 v[154:155], v94 offset:2048
    v_cndmask_b32 v76, v28, v44, s[94:95]
    v_cndmask_b32 v77, v29, v45, s[96:97]
    ds_read_b64_tr_b16 v[156:157], v95 offset:0
    v_cndmask_b32 v78, v30, v46, s[98:99]
    v_cndmask_b32 v79, v31, v47, s[100:101]
    v_mfma_f32_32x32x16_bf16 v[16:31], a[16:19], a[0:3], 0
    ds_read_b64_tr_b16 v[158:159], v95 offset:2048
    v_exp_f32 v64, v64
    ds_read_b64_tr_b16 v[208:209], v92 offset:4096
    v_exp_f32 v65, v65
    ds_read_b64_tr_b16 v[210:211], v92 offset:6144
    v_exp_f32 v66, v66
    ds_read_b64_tr_b16 v[212:213], v93 offset:4096
    v_exp_f32 v67, v67
    ds_read_b64_tr_b16 v[214:215], v93 offset:6144
    v_exp_f32 v68, v68
    ds_read_b64_tr_b16 v[216:217], v94 offset:4096
    v_exp_f32 v69, v69
    v_exp_f32 v70, v70
    ds_read_b64_tr_b16 v[218:219], v94 offset:6144
    v_exp_f32 v71, v71
    ds_read_b64_tr_b16 v[220:221], v95 offset:4096
    v_exp_f32 v72, v72
    ds_read_b64_tr_b16 v[222:223], v95 offset:6144
    v_exp_f32 v73, v73
    ds_read_b64_tr_b16 v[224:225], v92 offset:8192
    v_exp_f32 v74, v74
    ds_read_b64_tr_b16 v[226:227], v92 offset:10240
    v_exp_f32 v75, v75
    ds_read_b64_tr_b16 v[228:229], v93 offset:8192
    v_exp_f32 v76, v76
    v_exp_f32 v77, v77
    ds_read_b64_tr_b16 v[230:231], v93 offset:10240
    v_exp_f32 v78, v78
    ds_read_b64_tr_b16 v[232:233], v94 offset:8192
    v_exp_f32 v79, v79
    ds_read_b64_tr_b16 v[234:235], v94 offset:10240
    v_cvt_pk_bf16_f32 v128, v64, v65
    v_cvt_pk_bf16_f32 v129, v66, v67
    ds_read_b64_tr_b16 v[236:237], v95 offset:8192
    v_cvt_pk_bf16_f32 v130, v68, v69
    v_cvt_pk_bf16_f32 v131, v70, v71
    ds_read_b64_tr_b16 v[238:239], v95 offset:10240
    v_cvt_pk_bf16_f32 v132, v72, v73
    v_cvt_pk_bf16_f32 v133, v74, v75
    ds_read_b64_tr_b16 v[192:193], v92 offset:12288
    v_cvt_pk_bf16_f32 v134, v76, v77
    v_cvt_pk_bf16_f32 v135, v78, v79
    v_and_b32 v136, v128, v80
    ds_read_b64_tr_b16 v[194:195], v92 offset:14336
    v_and_b32 v137, v129, v81
    v_and_b32 v138, v130, v82
    ds_read_b64_tr_b16 v[196:197], v93 offset:12288
    v_and_b32 v139, v131, v83
    v_and_b32 v140, v132, v84
    ds_read_b64_tr_b16 v[198:199], v93 offset:14336
    v_and_b32 v141, v133, v85
    v_and_b32 v142, v134, v86
    v_and_b32 v143, v135, v87
    ds_read_b64_tr_b16 v[200:201], v94 offset:12288
    v_xor_b32 v128, v128, v136
    v_xor_b32 v129, v129, v137
    ds_read_b64_tr_b16 v[202:203], v94 offset:14336
    v_xor_b32 v130, v130, v138
    v_xor_b32 v131, v131, v139
    ds_read_b64_tr_b16 v[204:205], v95 offset:12288
    v_xor_b32 v132, v132, v140
    v_xor_b32 v133, v133, v141
    v_xor_b32 v134, v134, v142
    ds_read_b64_tr_b16 v[206:207], v95 offset:14336
    v_xor_b32 v135, v135, v143
    v_mfma_f32_32x32x16_bf16 v[96:111], a[112:115], v[136:139], 0
    s_add_u32 m0, s21, 0
    s_add_u32 s66, s66, 32768
    buffer_load_dwordx4 v2, s[36:39], s66 offen offset:0 lds
    v_exp_f32 v48, v48
    v_exp_f32 v49, v49
    v_exp_f32 v50, v50
    v_mfma_f32_32x32x16_bf16 v[96:111], a[116:119], v[140:143], v[96:111]
    v_exp_f32 v51, v51
    v_exp_f32 v52, v52
    buffer_load_dwordx4 v3, s[36:39], s66 offen offset:1024 lds
    v_exp_f32 v53, v53
    v_mfma_f32_32x32x16_bf16 v[96:111], a[48:51], v[128:131], v[96:111]
    v_exp_f32 v54, v54
    v_exp_f32 v55, v55
    v_exp_f32 v56, v56
    v_mfma_f32_32x32x16_bf16 v[96:111], a[52:55], v[132:135], v[96:111]
    buffer_load_dwordx4 v4, s[36:39], s66 offen offset:2048 lds
    v_exp_f32 v57, v57
    v_exp_f32 v58, v58
    v_exp_f32 v59, v59
    v_mfma_f32_32x32x16_bf16 v[32:47], a[20:23], a[0:3], 0
    v_exp_f32 v60, v60
    v_exp_f32 v61, v61
    buffer_load_dwordx4 v5, s[36:39], s66 offen offset:3072 lds
    v_exp_f32 v62, v62
    v_exp_f32 v63, v63
    v_cvt_pk_bf16_f32 v128, v48, v49
    v_cvt_pk_bf16_f32 v129, v50, v51
    v_cvt_pk_bf16_f32 v130, v52, v53
    v_cvt_pk_bf16_f32 v131, v54, v55
    v_cvt_pk_bf16_f32 v132, v56, v57
    v_cvt_pk_bf16_f32 v133, v58, v59
    v_cvt_pk_bf16_f32 v134, v60, v61
    v_cvt_pk_bf16_f32 v135, v62, v63
    s_lshl2_add_u32 s3, s53, s52
    s_lshl4_add_u32 s3, s3, s54
    s_lshl_b32 s3, s3, 7
    s_add_u32 s3, s3, 15794176
    s_waitcnt vmcnt(4)
    v_mov_b32 v7, s48
    s_mov_b64 exec, 1
    buffer_store_dword v7, off, s[40:43], s3 sc1
    s_mov_b64 exec, -1
    s_add_u32 m0, s21, 4096
    s_add_u32 s66, s66, 32768
    buffer_load_dwordx4 v2, s[36:39], s66 offen offset:0 lds
    v_mfma_f32_32x32x16_bf16 v[96:111], a[56:59], v[128:131], v[96:111]
    v_exp_f32 v16, v16
    v_exp_f32 v17, v17
    v_exp_f32 v18, v18
    v_exp_f32 v19, v19
    v_mfma_f32_32x32x16_bf16 v[96:111], a[60:63], v[132:135], v[96:111]
    v_exp_f32 v20, v20
    buffer_load_dwordx4 v3, s[36:39], s66 offen offset:1024 lds
    v_exp_f32 v21, v21
    v_exp_f32 v22, v22
    v_exp_f32 v23, v23
    v_mfma_f32_32x32x16_bf16 v[48:63], a[24:27], a[0:3], 0
    v_exp_f32 v24, v24
    v_exp_f32 v25, v25
    v_exp_f32 v26, v26
    buffer_load_dwordx4 v4, s[36:39], s66 offen offset:2048 lds
    v_exp_f32 v27, v27
    v_exp_f32 v28, v28
    v_exp_f32 v29, v29
    v_exp_f32 v30, v30
    v_exp_f32 v31, v31
    v_cvt_pk_bf16_f32 v128, v16, v17
    v_cvt_pk_bf16_f32 v129, v18, v19
    v_cvt_pk_bf16_f32 v130, v20, v21
    v_cvt_pk_bf16_f32 v131, v22, v23
    buffer_load_dwordx4 v5, s[36:39], s66 offen offset:3072 lds
    v_cvt_pk_bf16_f32 v132, v24, v25
    v_cvt_pk_bf16_f32 v133, v26, v27
    v_cvt_pk_bf16_f32 v134, v28, v29
    v_cvt_pk_bf16_f32 v135, v30, v31
    v_mfma_f32_32x32x16_bf16 v[96:111], a[64:67], v[128:131], v[96:111]
    v_exp_f32 v32, v32
    v_exp_f32 v33, v33
    v_exp_f32 v34, v34
    v_exp_f32 v35, v35
    s_add_u32 m0, s21, 8192
    s_add_u32 s66, s66, 32768
    buffer_load_dwordx4 v2, s[36:39], s66 offen offset:0 lds
    v_mfma_f32_32x32x16_bf16 v[96:111], a[68:71], v[132:135], v[96:111]
    v_exp_f32 v36, v36
    v_exp_f32 v37, v37
    v_exp_f32 v38, v38
    v_exp_f32 v39, v39
    v_mfma_f32_32x32x16_bf16 v[16:31], a[28:31], a[0:3], 0
    v_exp_f32 v40, v40
    buffer_load_dwordx4 v3, s[36:39], s66 offen offset:1024 lds
    v_exp_f32 v41, v41
    v_exp_f32 v42, v42
    v_exp_f32 v43, v43
    v_exp_f32 v44, v44
    v_exp_f32 v45, v45
    v_exp_f32 v46, v46
    v_exp_f32 v47, v47
    buffer_load_dwordx4 v4, s[36:39], s66 offen offset:2048 lds
    v_cvt_pk_bf16_f32 v128, v32, v33
    v_cvt_pk_bf16_f32 v129, v34, v35
    v_cvt_pk_bf16_f32 v130, v36, v37
    v_cvt_pk_bf16_f32 v131, v38, v39
    v_cvt_pk_bf16_f32 v132, v40, v41
    v_cvt_pk_bf16_f32 v133, v42, v43
    v_cvt_pk_bf16_f32 v134, v44, v45
    v_cvt_pk_bf16_f32 v135, v46, v47
    v_mfma_f32_32x32x16_bf16 v[96:111], a[72:75], v[128:131], v[96:111]
    v_exp_f32 v48, v48
    v_exp_f32 v49, v49
    buffer_load_dwordx4 v5, s[36:39], s66 offen offset:3072 lds
    v_exp_f32 v50, v50
    v_exp_f32 v51, v51
    v_mfma_f32_32x32x16_bf16 v[96:111], a[76:79], v[132:135], v[96:111]
    v_exp_f32 v52, v52
    v_exp_f32 v53, v53
    v_exp_f32 v54, v54
    v_exp_f32 v55, v55
    s_waitcnt lgkmcnt(0)
    v_mfma_f32_32x32x16_bf16 v[32:47], a[32:35], a[0:3], 0
    v_exp_f32 v56, v56
    v_exp_f32 v57, v57
    v_exp_f32 v58, v58
    v_exp_f32 v59, v59
    v_exp_f32 v60, v60
    s_add_u32 m0, s20, 0
    s_add_u32 s66, s66, 32768
    buffer_load_dwordx4 v2, s[28:31], s66 offen offset:0 lds
    v_exp_f32 v61, v61
    v_exp_f32 v62, v62
    v_exp_f32 v63, v63
    v_cvt_pk_bf16_f32 v128, v48, v49
    v_cvt_pk_bf16_f32 v129, v50, v51
    v_cvt_pk_bf16_f32 v130, v52, v53
    v_cvt_pk_bf16_f32 v131, v54, v55
    v_cvt_pk_bf16_f32 v132, v56, v57
    v_cvt_pk_bf16_f32 v133, v58, v59
    buffer_load_dwordx4 v3, s[28:31], s66 offen offset:1024 lds
    v_cvt_pk_bf16_f32 v134, v60, v61
    v_cvt_pk_bf16_f32 v135, v62, v63
    v_mfma_f32_32x32x16_bf16 v[96:111], a[80:83], v[128:131], v[96:111]
    v_exp_f32 v16, v16
    v_exp_f32 v17, v17
    v_exp_f32 v18, v18
    v_exp_f32 v19, v19
    v_mfma_f32_32x32x16_bf16 v[96:111], a[84:87], v[132:135], v[96:111]
    buffer_load_dwordx4 v4, s[28:31], s66 offen offset:2048 lds
    v_exp_f32 v20, v20
    v_exp_f32 v21, v21
    v_exp_f32 v22, v22
    v_exp_f32 v23, v23
    v_mfma_f32_32x32x16_bf16 v[48:63], a[36:39], a[0:3], 0
    v_exp_f32 v24, v24
    buffer_load_dwordx4 v5, s[28:31], s66 offen offset:3072 lds
    v_exp_f32 v25, v25
    v_exp_f32 v26, v26
    v_exp_f32 v27, v27
    v_exp_f32 v28, v28
    v_exp_f32 v29, v29
    v_exp_f32 v30, v30
    v_exp_f32 v31, v31
    s_add_u32 m0, s20, 4096
    s_lshl_b32 s66, s52, 17
    buffer_load_dwordx4 v2, s[32:35], s66 offen offset:0 lds
    v_cvt_pk_bf16_f32 v128, v16, v17
    v_cvt_pk_bf16_f32 v129, v18, v19
    v_cvt_pk_bf16_f32 v130, v20, v21
    v_cvt_pk_bf16_f32 v131, v22, v23
    v_cvt_pk_bf16_f32 v132, v24, v25
    v_cvt_pk_bf16_f32 v133, v26, v27
    v_cvt_pk_bf16_f32 v134, v28, v29
    v_cvt_pk_bf16_f32 v135, v30, v31
    v_mfma_f32_32x32x16_bf16 v[96:111], a[88:91], v[128:131], v[96:111]
    v_exp_f32 v32, v32
    buffer_load_dwordx4 v3, s[32:35], s66 offen offset:1024 lds
    v_exp_f32 v33, v33
    v_exp_f32 v34, v34
    v_exp_f32 v35, v35
    v_mfma_f32_32x32x16_bf16 v[96:111], a[92:95], v[132:135], v[96:111]
    v_exp_f32 v36, v36
    v_exp_f32 v37, v37
    buffer_load_dwordx4 v4, s[32:35], s66 offen offset:2048 lds
    v_exp_f32 v38, v38
    v_exp_f32 v39, v39
    v_exp_f32 v40, v40
    v_exp_f32 v41, v41
    v_exp_f32 v42, v42
    v_exp_f32 v43, v43
    v_exp_f32 v44, v44
    buffer_load_dwordx4 v5, s[32:35], s66 offen offset:3072 lds
    v_exp_f32 v45, v45
    v_exp_f32 v46, v46
    v_exp_f32 v47, v47
    v_cvt_pk_bf16_f32 v128, v32, v33
    v_cvt_pk_bf16_f32 v129, v34, v35
    v_cvt_pk_bf16_f32 v130, v36, v37
    v_cvt_pk_bf16_f32 v131, v38, v39
    v_cvt_pk_bf16_f32 v132, v40, v41
    v_cvt_pk_bf16_f32 v133, v42, v43
    s_add_u32 m0, s20, 8192
    s_add_u32 s66, s66, 32768
    buffer_load_dwordx4 v2, s[32:35], s66 offen offset:0 lds
    v_cvt_pk_bf16_f32 v134, v44, v45
    v_cvt_pk_bf16_f32 v135, v46, v47
    v_mfma_f32_32x32x16_bf16 v[96:111], a[96:99], v[128:131], v[96:111]
    v_exp_f32 v48, v48
    v_exp_f32 v49, v49
    v_exp_f32 v50, v50
    v_exp_f32 v51, v51
    buffer_load_dwordx4 v3, s[32:35], s66 offen offset:1024 lds
    v_mfma_f32_32x32x16_bf16 v[96:111], a[100:103], v[132:135], v[96:111]
    v_exp_f32 v52, v52
    v_exp_f32 v53, v53
    v_exp_f32 v54, v54
    v_exp_f32 v55, v55
    v_exp_f32 v56, v56
    v_exp_f32 v57, v57
    buffer_load_dwordx4 v4, s[32:35], s66 offen offset:2048 lds
    v_exp_f32 v58, v58
    v_exp_f32 v59, v59
    v_exp_f32 v60, v60
    v_exp_f32 v61, v61
    v_exp_f32 v62, v62
    v_exp_f32 v63, v63
    buffer_load_dwordx4 v5, s[32:35], s66 offen offset:3072 lds
    v_cvt_pk_bf16_f32 v128, v48, v49
    v_cvt_pk_bf16_f32 v129, v50, v51
    v_cvt_pk_bf16_f32 v130, v52, v53
    v_cvt_pk_bf16_f32 v131, v54, v55
    v_cvt_pk_bf16_f32 v132, v56, v57
    v_cvt_pk_bf16_f32 v133, v58, v59
    v_cvt_pk_bf16_f32 v134, v60, v61
    v_cvt_pk_bf16_f32 v135, v62, v63
    v_mfma_f32_32x32x16_bf16 v[96:111], a[104:107], v[128:131], v[96:111]
    s_nop 0
    v_mfma_f32_32x32x16_bf16 v[96:111], a[108:111], v[132:135], v[96:111]
    v_mfma_f32_32x32x16_bf16 v[32:47], a[44:47], a[4:7], 0
    v_mfma_f32_32x32x16_bf16 v[16:31], a[12:15], a[4:7], 0
    v_mfma_f32_32x32x16_bf16 v[48:63], a[16:19], a[4:7], 0
    s_nop 8
    v_subrev_u32 v11, 0x2b800000, v104
    v_cmp_le_u32 vcc, 0x23000000, v11
    s_nop 0
    s_cbranch_vccnz Lfb_0_0
Lfr_0_0:
    v_rcp_f32 v11, v104
    s_nop 0
    v_mul_f32 v96, v96, v11
    v_mul_f32 v97, v97, v11
    v_and_b32 v96, v12, v96
    v_mul_f32 v98, v98, v11
    v_mul_f32 v99, v99, v11
    v_mul_f32 v100, v100, v11
    v_mul_f32 v101, v101, v11
    v_mul_f32 v102, v102, v11
    v_mul_f32 v103, v103, v11
    v_cvt_pk_bf16_f32 v104, v96, v97
    v_cvt_pk_bf16_f32 v105, v98, v99
    v_cvt_pk_bf16_f32 v106, v100, v101
    v_cvt_pk_bf16_f32 v107, v102, v103
    v_or_b32 v104, v9, v104
    buffer_store_dwordx4 v[104:107], v14, s[40:43], s60 offen sc1
    s_lshl_b32 s58, s56, 16
    s_lshl_b32 s59, s52, 14
    s_add_u32 s58, s58, s59
    s_lshl_b32 s59, s57, 7
    s_add_u32 s58, s58, s59
    v_lshrrev_b32 v250, 3, v1
    v_and_b32 v251, 7, v1
    v_lshlrev_b32 v252, 4, v251
    v_lshl_add_u32 v252, v250, 10, v252
    v_add_u32 v253, 8192, v252
    buffer_load_dwordx4 v[240:243], v252, s[24:27], s58 offen
    v_cndmask_b32 v64, v16, v32, s[70:71]
    v_cndmask_b32 v65, v17, v33, s[72:73]
    v_cndmask_b32 v66, v18, v34, s[74:75]
    v_cndmask_b32 v67, v19, v35, s[76:77]
    v_cndmask_b32 v68, v20, v36, s[78:79]
    v_cndmask_b32 v69, v21, v37, s[80:81]
    v_cndmask_b32 v70, v22, v38, s[82:83]
    v_cndmask_b32 v71, v23, v39, s[84:85]
    v_cndmask_b32 v72, v24, v40, s[86:87]
    v_cndmask_b32 v73, v25, v41, s[88:89]
    v_cndmask_b32 v74, v26, v42, s[90:91]
    v_cndmask_b32 v75, v27, v43, s[92:93]
    v_cndmask_b32 v76, v28, v44, s[94:95]
    v_cndmask_b32 v77, v29, v45, s[96:97]
    v_cndmask_b32 v78, v30, v46, s[98:99]
    v_cndmask_b32 v79, v31, v47, s[100:101]
    v_mfma_f32_32x32x16_bf16 v[16:31], a[20:23], a[4:7], 0
    v_exp_f32 v64, v64
    v_exp_f32 v65, v65
    v_exp_f32 v66, v66
    v_exp_f32 v67, v67
    buffer_load_dwordx4 v[244:247], v253, s[24:27], s58 offen
    v_exp_f32 v68, v68
    v_exp_f32 v69, v69
    v_exp_f32 v70, v70
    v_exp_f32 v71, v71
    v_exp_f32 v72, v72
    v_exp_f32 v73, v73
    v_exp_f32 v74, v74
    v_exp_f32 v75, v75
    v_exp_f32 v76, v76
    v_exp_f32 v77, v77
    v_exp_f32 v78, v78
    v_exp_f32 v79, v79
    v_cvt_pk_bf16_f32 v128, v64, v65
    s_add_u32 m0, s20, 12288
    s_add_u32 s66, s66, 32768
    buffer_load_dwordx4 v2, s[32:35], s66 offen offset:0 lds
    v_cvt_pk_bf16_f32 v129, v66, v67
    v_cvt_pk_bf16_f32 v130, v68, v69
    v_cvt_pk_bf16_f32 v131, v70, v71
    v_cvt_pk_bf16_f32 v132, v72, v73
    v_cvt_pk_bf16_f32 v133, v74, v75
    v_cvt_pk_bf16_f32 v134, v76, v77
    v_cvt_pk_bf16_f32 v135, v78, v79
    v_and_b32 v136, v128, v80
    v_and_b32 v137, v129, v81
    v_and_b32 v138, v130, v82
    v_and_b32 v139, v131, v83
    v_and_b32 v140, v132, v84
    v_and_b32 v141, v133, v85
    v_and_b32 v142, v134, v86
    v_and_b32 v143, v135, v87
    v_xor_b32 v128, v128, v136
    v_xor_b32 v129, v129, v137
    v_xor_b32 v130, v130, v138
    v_xor_b32 v131, v131, v139
    v_xor_b32 v132, v132, v140
    v_xor_b32 v133, v133, v141
    v_xor_b32 v134, v134, v142
    v_xor_b32 v135, v135, v143
    v_mfma_f32_32x32x16_bf16 v[112:127], a[120:123], v[136:139], 0
    buffer_load_dwordx4 v3, s[32:35], s66 offen offset:1024 lds
    v_exp_f32 v48, v48
    v_exp_f32 v49, v49
    v_exp_f32 v50, v50
    v_mfma_f32_32x32x16_bf16 v[112:127], a[124:127], v[140:143], v[112:127]
    v_exp_f32 v51, v51
    v_exp_f32 v52, v52
    v_exp_f32 v53, v53
    v_mfma_f32_32x32x16_bf16 v[112:127], a[56:59], v[128:131], v[112:127]
    v_exp_f32 v54, v54
    v_exp_f32 v55, v55
    v_exp_f32 v56, v56
    v_mfma_f32_32x32x16_bf16 v[112:127], a[60:63], v[132:135], v[112:127]
    v_exp_f32 v57, v57
    buffer_load_dwordx4 v4, s[32:35], s66 offen offset:2048 lds
    v_exp_f32 v58, v58
    v_exp_f32 v59, v59
    v_mfma_f32_32x32x16_bf16 v[32:47], a[24:27], a[4:7], 0
    v_exp_f32 v60, v60
    v_exp_f32 v61, v61
    v_exp_f32 v62, v62
    v_exp_f32 v63, v63
    v_cvt_pk_bf16_f32 v128, v48, v49
    v_cvt_pk_bf16_f32 v129, v50, v51
    v_cvt_pk_bf16_f32 v130, v52, v53
    v_cvt_pk_bf16_f32 v131, v54, v55
    v_cvt_pk_bf16_f32 v132, v56, v57
    v_cvt_pk_bf16_f32 v133, v58, v59
    v_cvt_pk_bf16_f32 v134, v60, v61
    v_cvt_pk_bf16_f32 v135, v62, v63
    v_mfma_f32_32x32x16_bf16 v[112:127], a[64:67], v[128:131], v[112:127]
    v_exp_f32 v16, v16
    buffer_load_dwordx4 v5, s[32:35], s66 offen offset:3072 lds
    v_exp_f32 v17, v17
    v_exp_f32 v18, v18
    v_exp_f32 v19, v19
    v_mfma_f32_32x32x16_bf16 v[112:127], a[68:71], v[132:135], v[112:127]
    v_exp_f32 v20, v20
    v_exp_f32 v21, v21
    v_exp_f32 v22, v22
    v_exp_f32 v23, v23
    v_mfma_f32_32x32x16_bf16 v[48:63], a[28:31], a[4:7], 0
    v_exp_f32 v24, v24
    v_exp_f32 v25, v25
    v_exp_f32 v26, v26
    buffer_load_dword v254, v15, s[40:43], 0 offen sc1
    v_exp_f32 v27, v27
    v_exp_f32 v28, v28
    v_exp_f32 v29, v29
    v_exp_f32 v30, v30
    v_exp_f32 v31, v31
    v_cvt_pk_bf16_f32 v128, v16, v17
    v_cvt_pk_bf16_f32 v129, v18, v19
    v_cvt_pk_bf16_f32 v130, v20, v21
    v_cvt_pk_bf16_f32 v131, v22, v23
    v_cvt_pk_bf16_f32 v132, v24, v25
    v_cvt_pk_bf16_f32 v133, v26, v27
    v_cvt_pk_bf16_f32 v134, v28, v29
    v_cvt_pk_bf16_f32 v135, v30, v31
    v_mfma_f32_32x32x16_bf16 v[112:127], a[72:75], v[128:131], v[112:127]
    v_exp_f32 v32, v32
    v_exp_f32 v33, v33
    v_exp_f32 v34, v34
    v_exp_f32 v35, v35
    v_mfma_f32_32x32x16_bf16 v[112:127], a[76:79], v[132:135], v[112:127]
    v_exp_f32 v36, v36
    v_exp_f32 v37, v37
    v_exp_f32 v38, v38
    v_exp_f32 v39, v39
    v_mfma_f32_32x32x16_bf16 v[16:31], a[32:35], a[4:7], 0
    v_exp_f32 v40, v40
    v_exp_f32 v41, v41
    v_exp_f32 v42, v42
    v_exp_f32 v43, v43
    v_exp_f32 v44, v44
    v_exp_f32 v45, v45
    v_exp_f32 v46, v46
    v_exp_f32 v47, v47
    v_cvt_pk_bf16_f32 v128, v32, v33
    v_cvt_pk_bf16_f32 v129, v34, v35
    v_cvt_pk_bf16_f32 v130, v36, v37
    v_cvt_pk_bf16_f32 v131, v38, v39
    v_cvt_pk_bf16_f32 v132, v40, v41
    v_cvt_pk_bf16_f32 v133, v42, v43
    v_cvt_pk_bf16_f32 v134, v44, v45
    v_cvt_pk_bf16_f32 v135, v46, v47
    s_waitcnt vmcnt(0)
    v_cmp_ne_u32 vcc, s48, v254
    s_nop 0
    s_cbranch_vccnz Lsp_11
Lok_12:
    buffer_load_dwordx4 a[128:131], v88, s[40:43], s65 offen offset:0 sc1
    v_mfma_f32_32x32x16_bf16 v[112:127], a[80:83], v[128:131], v[112:127]
    v_exp_f32 v48, v48
    v_exp_f32 v49, v49
    v_exp_f32 v50, v50
    v_exp_f32 v51, v51
    v_mfma_f32_32x32x16_bf16 v[112:127], a[84:87], v[132:135], v[112:127]
    v_exp_f32 v52, v52
    v_exp_f32 v53, v53
    buffer_load_dwordx4 a[132:135], v89, s[40:43], s65 offen offset:0 sc1
    v_exp_f32 v54, v54
    v_exp_f32 v55, v55
    v_mfma_f32_32x32x16_bf16 v[32:47], a[36:39], a[4:7], 0
    v_exp_f32 v56, v56
    v_exp_f32 v57, v57
    v_exp_f32 v58, v58
    v_exp_f32 v59, v59
    v_exp_f32 v60, v60
    buffer_load_dwordx4 a[136:139], v90, s[40:43], s65 offen offset:0 sc1
    v_exp_f32 v61, v61
    v_exp_f32 v62, v62
    v_exp_f32 v63, v63
    v_cvt_pk_bf16_f32 v128, v48, v49
    v_cvt_pk_bf16_f32 v129, v50, v51
    v_cvt_pk_bf16_f32 v130, v52, v53
    v_cvt_pk_bf16_f32 v131, v54, v55
    v_cvt_pk_bf16_f32 v132, v56, v57
    v_cvt_pk_bf16_f32 v133, v58, v59
    v_cvt_pk_bf16_f32 v134, v60, v61
    v_cvt_pk_bf16_f32 v135, v62, v63
    buffer_load_dwordx4 a[140:143], v91, s[40:43], s65 offen offset:0 sc1
    v_mfma_f32_32x32x16_bf16 v[112:127], a[88:91], v[128:131], v[112:127]
    v_exp_f32 v16, v16
    v_exp_f32 v17, v17
    v_exp_f32 v18, v18
    v_exp_f32 v19, v19
    v_mfma_f32_32x32x16_bf16 v[112:127], a[92:95], v[132:135], v[112:127]
    v_exp_f32 v20, v20
    v_exp_f32 v21, v21
    buffer_load_dwordx4 a[144:147], v88, s[40:43], s65 offen offset:1024 sc1
    v_exp_f32 v22, v22
    v_exp_f32 v23, v23
    v_mfma_f32_32x32x16_bf16 v[48:63], a[40:43], a[4:7], 0
    v_exp_f32 v24, v24
    v_exp_f32 v25, v25
    v_exp_f32 v26, v26
    v_exp_f32 v27, v27
    v_exp_f32 v28, v28
    buffer_load_dwordx4 a[148:151], v89, s[40:43], s65 offen offset:1024 sc1
    v_exp_f32 v29, v29
    v_exp_f32 v30, v30
    v_exp_f32 v31, v31
    v_cvt_pk_bf16_f32 v128, v16, v17
    v_cvt_pk_bf16_f32 v129, v18, v19
    v_cvt_pk_bf16_f32 v130, v20, v21
    v_cvt_pk_bf16_f32 v131, v22, v23
    v_cvt_pk_bf16_f32 v132, v24, v25
    v_cvt_pk_bf16_f32 v133, v26, v27
    v_cvt_pk_bf16_f32 v134, v28, v29
    v_cvt_pk_bf16_f32 v135, v30, v31
    buffer_load_dwordx4 a[152:155], v90, s[40:43], s65 offen offset:1024 sc1
    v_mfma_f32_32x32x16_bf16 v[112:127], a[96:99], v[128:131], v[112:127]
    v_exp_f32 v32, v32
    v_exp_f32 v33, v33
    v_exp_f32 v34, v34
    v_exp_f32 v35, v35
    v_mfma_f32_32x32x16_bf16 v[112:127], a[100:103], v[132:135], v[112:127]
    v_exp_f32 v36, v36
    v_exp_f32 v37, v37
    buffer_load_dwordx4 a[156:159], v91, s[40:43], s65 offen offset:1024 sc1
    v_exp_f32 v38, v38
    v_exp_f32 v39, v39
    v_exp_f32 v40, v40
    v_exp_f32 v41, v41
    v_exp_f32 v42, v42
    v_exp_f32 v43, v43
    v_exp_f32 v44, v44
    v_exp_f32 v45, v45
    buffer_load_dwordx4 a[160:163], v88, s[40:43], s65 offen offset:2048 sc1
    v_exp_f32 v46, v46
    v_exp_f32 v47, v47
    v_cvt_pk_bf16_f32 v128, v32, v33
    v_cvt_pk_bf16_f32 v129, v34, v35
    v_cvt_pk_bf16_f32 v130, v36, v37
    v_cvt_pk_bf16_f32 v131, v38, v39
    v_cvt_pk_bf16_f32 v132, v40, v41
    v_cvt_pk_bf16_f32 v133, v42, v43
    v_cvt_pk_bf16_f32 v134, v44, v45
    v_cvt_pk_bf16_f32 v135, v46, v47
    v_mfma_f32_32x32x16_bf16 v[112:127], a[104:107], v[128:131], v[112:127]
    buffer_load_dwordx4 a[164:167], v89, s[40:43], s65 offen offset:2048 sc1
    v_exp_f32 v48, v48
    v_exp_f32 v49, v49
    v_exp_f32 v50, v50
    v_exp_f32 v51, v51
    v_mfma_f32_32x32x16_bf16 v[112:127], a[108:111], v[132:135], v[112:127]
    v_exp_f32 v52, v52
    v_exp_f32 v53, v53
    v_exp_f32 v54, v54
    buffer_load_dwordx4 a[168:171], v90, s[40:43], s65 offen offset:2048 sc1
    v_exp_f32 v55, v55
    v_exp_f32 v56, v56
    v_exp_f32 v57, v57
    v_exp_f32 v58, v58
    v_exp_f32 v59, v59
    v_exp_f32 v60, v60
    v_exp_f32 v61, v61
    v_exp_f32 v62, v62
    buffer_load_dwordx4 a[172:175], v91, s[40:43], s65 offen offset:2048 sc1
    v_exp_f32 v63, v63
    v_cvt_pk_bf16_f32 v128, v48, v49
    v_cvt_pk_bf16_f32 v129, v50, v51
    v_cvt_pk_bf16_f32 v130, v52, v53
    v_cvt_pk_bf16_f32 v131, v54, v55
    v_cvt_pk_bf16_f32 v132, v56, v57
    v_cvt_pk_bf16_f32 v133, v58, v59
    v_cvt_pk_bf16_f32 v134, v60, v61
    v_cvt_pk_bf16_f32 v135, v62, v63
    v_mfma_f32_32x32x16_bf16 v[112:127], a[112:115], v[128:131], v[112:127]
    s_nop 0
    v_mfma_f32_32x32x16_bf16 v[112:127], a[116:119], v[132:135], v[112:127]
    s_nop 11
    v_subrev_u32 v11, 0x2b800000, v120
    v_cmp_le_u32 vcc, 0x23000000, v11
    s_nop 0
    s_cbranch_vccnz Lfb_0_1
Lfr_0_1:
    s_add_u32 s60, s60, 98304
    v_rcp_f32 v11, v120
    s_nop 0
    v_mul_f32 v112, v112, v11
    v_mul_f32 v113, v113, v11
    v_and_b32 v112, v12, v112
    v_mul_f32 v114, v114, v11
    v_mul_f32 v115, v115, v11
    v_mul_f32 v116, v116, v11
    v_mul_f32 v117, v117, v11
    v_mul_f32 v118, v118, v11
    v_mul_f32 v119, v119, v11
    v_cvt_pk_bf16_f32 v120, v112, v113
    v_cvt_pk_bf16_f32 v121, v114, v115
    v_cvt_pk_bf16_f32 v122, v116, v117
    v_cvt_pk_bf16_f32 v123, v118, v119
    v_or_b32 v120, v9, v120
    buffer_store_dwordx4 v[120:123], v14, s[40:43], s60 offen sc1
Lp3_17:
    s_waitcnt vmcnt(9)
    v_mfma_f32_16x16x32_bf16 v[16:19], v[144:147], a[128:131], 0
    v_mfma_f32_16x16x32_bf16 v[32:35], v[144:147], a[132:135], 0
    buffer_load_dwordx4 a[176:179], v88, s[40:43], s65 offen offset:3072 sc1
    v_mfma_f32_16x16x32_bf16 v[48:51], v[144:147], a[136:139], 0
    buffer_load_dwordx4 a[180:183], v89, s[40:43], s65 offen offset:3072 sc1
    v_mfma_f32_16x16x32_bf16 v[64:67], v[144:147], a[140:143], 0
    v_mfma_f32_16x16x32_bf16 v[20:23], v[148:151], a[128:131], 0
    buffer_load_dwordx4 a[184:187], v90, s[40:43], s65 offen offset:3072 sc1
    v_mfma_f32_16x16x32_bf16 v[36:39], v[148:151], a[132:135], 0
    v_mfma_f32_16x16x32_bf16 v[52:55], v[148:151], a[136:139], 0
    buffer_load_dwordx4 a[188:191], v91, s[40:43], s65 offen offset:3072 sc1
    v_mfma_f32_16x16x32_bf16 v[68:71], v[148:151], a[140:143], 0
    v_mfma_f32_16x16x32_bf16 v[24:27], v[152:155], a[128:131], 0
    s_add_u32 s65, s65, 4096
    v_mfma_f32_16x16x32_bf16 v[40:43], v[152:155], a[132:135], 0
    buffer_load_dwordx4 a[192:195], v88, s[40:43], s65 offen offset:0 sc1
    v_mfma_f32_16x16x32_bf16 v[56:59], v[152:155], a[136:139], 0
    buffer_load_dwordx4 a[196:199], v89, s[40:43], s65 offen offset:0 sc1
    v_mfma_f32_16x16x32_bf16 v[72:75], v[152:155], a[140:143], 0
    v_mfma_f32_16x16x32_bf16 v[28:31], v[156:159], a[128:131], 0
    buffer_load_dwordx4 a[200:203], v90, s[40:43], s65 offen offset:0 sc1
    v_mfma_f32_16x16x32_bf16 v[44:47], v[156:159], a[132:135], 0
    v_mfma_f32_16x16x32_bf16 v[60:63], v[156:159], a[136:139], 0
    buffer_load_dwordx4 a[204:207], v91, s[40:43], s65 offen offset:0 sc1
    v_mfma_f32_16x16x32_bf16 v[76:79], v[156:159], a[140:143], 0
    s_waitcnt vmcnt(13)
    v_mfma_f32_16x16x32_bf16 v[16:19], v[208:211], a[144:147], v[16:19]
    v_mfma_f32_16x16x32_bf16 v[32:35], v[208:211], a[148:151], v[32:35]
    buffer_load_dwordx4 a[208:211], v88, s[40:43], s65 offen offset:1024 sc1
    v_mfma_f32_16x16x32_bf16 v[48:51], v[208:211], a[152:155], v[48:51]
    v_mfma_f32_16x16x32_bf16 v[64:67], v[208:211], a[156:159], v[64:67]
    v_mfma_f32_16x16x32_bf16 v[20:23], v[212:215], a[144:147], v[20:23]
    buffer_load_dwordx4 a[212:215], v89, s[40:43], s65 offen offset:1024 sc1
    v_mfma_f32_16x16x32_bf16 v[36:39], v[212:215], a[148:151], v[36:39]
    v_mfma_f32_16x16x32_bf16 v[52:55], v[212:215], a[152:155], v[52:55]
    v_mfma_f32_16x16x32_bf16 v[68:71], v[212:215], a[156:159], v[68:71]
    v_mfma_f32_16x16x32_bf16 v[24:27], v[216:219], a[144:147], v[24:27]
    buffer_load_dwordx4 a[216:219], v90, s[40:43], s65 offen offset:1024 sc1
    v_mfma_f32_16x16x32_bf16 v[40:43], v[216:219], a[148:151], v[40:43]
    v_mfma_f32_16x16x32_bf16 v[56:59], v[216:219], a[152:155], v[56:59]
    v_mfma_f32_16x16x32_bf16 v[72:75], v[216:219], a[156:159], v[72:75]
    v_mfma_f32_16x16x32_bf16 v[28:31], v[220:223], a[144:147], v[28:31]
    buffer_load_dwordx4 a[220:223], v91, s[40:43], s65 offen offset:1024 sc1
    v_mfma_f32_16x16x32_bf16 v[44:47], v[220:223], a[148:151], v[44:47]
    v_mfma_f32_16x16x32_bf16 v[60:63], v[220:223], a[152:155], v[60:63]
    v_mfma_f32_16x16x32_bf16 v[76:79], v[220:223], a[156:159], v[76:79]
    s_waitcnt vmcnt(13)
    v_mfma_f32_16x16x32_bf16 v[16:19], v[224:227], a[160:163], v[16:19]
    v_mfma_f32_16x16x32_bf16 v[32:35], v[224:227], a[164:167], v[32:35]
    buffer_load_dwordx4 a[224:227], v88, s[40:43], s65 offen offset:2048 sc1
    v_mfma_f32_16x16x32_bf16 v[48:51], v[224:227], a[168:171], v[48:51]
    v_mfma_f32_16x16x32_bf16 v[64:67], v[224:227], a[172:175], v[64:67]
    v_mfma_f32_16x16x32_bf16 v[20:23], v[228:231], a[160:163], v[20:23]
    buffer_load_dwordx4 a[228:231], v89, s[40:43], s65 offen offset:2048 sc1
    v_mfma_f32_16x16x32_bf16 v[36:39], v[228:231], a[164:167], v[36:39]
    v_mfma_f32_16x16x32_bf16 v[52:55], v[228:231], a[168:171], v[52:55]
    v_mfma_f32_16x16x32_bf16 v[68:71], v[228:231], a[172:175], v[68:71]
    v_mfma_f32_16x16x32_bf16 v[24:27], v[232:235], a[160:163], v[24:27]
    buffer_load_dwordx4 a[232:235], v90, s[40:43], s65 offen offset:2048 sc1
    v_mfma_f32_16x16x32_bf16 v[40:43], v[232:235], a[164:167], v[40:43]
    v_mfma_f32_16x16x32_bf16 v[56:59], v[232:235], a[168:171], v[56:59]
    v_mfma_f32_16x16x32_bf16 v[72:75], v[232:235], a[172:175], v[72:75]
    v_mfma_f32_16x16x32_bf16 v[28:31], v[236:239], a[160:163], v[28:31]
    buffer_load_dwordx4 a[236:239], v91, s[40:43], s65 offen offset:2048 sc1
    v_mfma_f32_16x16x32_bf16 v[44:47], v[236:239], a[164:167], v[44:47]
    v_mfma_f32_16x16x32_bf16 v[60:63], v[236:239], a[168:171], v[60:63]
    v_mfma_f32_16x16x32_bf16 v[76:79], v[236:239], a[172:175], v[76:79]
    s_waitcnt vmcnt(12)
    v_mfma_f32_16x16x32_bf16 v[16:19], v[192:195], a[176:179], v[16:19]
    s_sub_u32 s3, s22, s20
    v_add_u32 v92, s3, v92
    v_mfma_f32_16x16x32_bf16 v[32:35], v[192:195], a[180:183], v[32:35]
    v_add_u32 v93, s3, v93
    buffer_load_dwordx4 a[240:243], v88, s[40:43], s65 offen offset:3072 sc1
    v_mfma_f32_16x16x32_bf16 v[48:51], v[192:195], a[184:187], v[48:51]
    v_add_u32 v94, s3, v94
    v_mfma_f32_16x16x32_bf16 v[64:67], v[192:195], a[188:191], v[64:67]
    v_add_u32 v95, s3, v95
    v_mfma_f32_16x16x32_bf16 v[20:23], v[196:199], a[176:179], v[20:23]
    ds_read_b64_tr_b16 v[160:161], v92 offset:0
    buffer_load_dwordx4 a[244:247], v89, s[40:43], s65 offen offset:3072 sc1
    v_mfma_f32_16x16x32_bf16 v[36:39], v[196:199], a[180:183], v[36:39]
    ds_read_b64_tr_b16 v[162:163], v92 offset:2048
    v_mfma_f32_16x16x32_bf16 v[52:55], v[196:199], a[184:187], v[52:55]
    ds_read_b64_tr_b16 v[164:165], v93 offset:0
    v_mfma_f32_16x16x32_bf16 v[68:71], v[196:199], a[188:191], v[68:71]
    ds_read_b64_tr_b16 v[166:167], v93 offset:2048
    v_mfma_f32_16x16x32_bf16 v[24:27], v[200:203], a[176:179], v[24:27]
    ds_read_b64_tr_b16 v[168:169], v94 offset:0
    buffer_load_dwordx4 a[248:251], v90, s[40:43], s65 offen offset:3072 sc1
    v_mfma_f32_16x16x32_bf16 v[40:43], v[200:203], a[180:183], v[40:43]
    ds_read_b64_tr_b16 v[170:171], v94 offset:2048
    v_mfma_f32_16x16x32_bf16 v[56:59], v[200:203], a[184:187], v[56:59]
    ds_read_b64_tr_b16 v[172:173], v95 offset:0
    v_mfma_f32_16x16x32_bf16 v[72:75], v[200:203], a[188:191], v[72:75]
    ds_read_b64_tr_b16 v[174:175], v95 offset:2048
    v_mfma_f32_16x16x32_bf16 v[28:31], v[204:207], a[176:179], v[28:31]
    buffer_load_dwordx4 a[252:255], v91, s[40:43], s65 offen offset:3072 sc1
    v_mfma_f32_16x16x32_bf16 v[44:47], v[204:207], a[180:183], v[44:47]
    v_mfma_f32_16x16x32_bf16 v[60:63], v[204:207], a[184:187], v[60:63]
    v_mfma_f32_16x16x32_bf16 v[76:79], v[204:207], a[188:191], v[76:79]
    s_waitcnt vmcnt(12) lgkmcnt(4)
    v_mfma_f32_16x16x32_bf16 v[16:19], v[160:163], a[192:195], v[16:19]
    ds_read_b64_tr_b16 v[176:177], v92 offset:4096
    ds_read_b64_tr_b16 v[178:179], v92 offset:6144
    s_add_u32 s65, s65, 4096
    v_mfma_f32_16x16x32_bf16 v[32:35], v[160:163], a[196:199], v[32:35]
    ds_read_b64_tr_b16 v[180:181], v93 offset:4096
    buffer_load_dwordx4 a[128:131], v88, s[40:43], s65 offen offset:0 sc1
    v_mfma_f32_16x16x32_bf16 v[48:51], v[160:163], a[200:203], v[48:51]
    ds_read_b64_tr_b16 v[182:183], v93 offset:6144
    ds_read_b64_tr_b16 v[184:185], v94 offset:4096
    v_mfma_f32_16x16x32_bf16 v[64:67], v[160:163], a[204:207], v[64:67]
    ds_read_b64_tr_b16 v[186:187], v94 offset:6144
    v_mfma_f32_16x16x32_bf16 v[20:23], v[164:167], a[192:195], v[20:23]
    ds_read_b64_tr_b16 v[188:189], v95 offset:4096
    ds_read_b64_tr_b16 v[190:191], v95 offset:6144
    buffer_load_dwordx4 a[132:135], v89, s[40:43], s65 offen offset:0 sc1
    v_mfma_f32_16x16x32_bf16 v[36:39], v[164:167], a[196:199], v[36:39]
    v_lshrrev_b32 v6, 5, v1
    v_mfma_f32_16x16x32_bf16 v[52:55], v[164:167], a[200:203], v[52:55]
    v_lshlrev_b32 v6, 10, v6
    s_sub_u32 s23, s20, s22
    v_mfma_f32_16x16x32_bf16 v[68:71], v[164:167], a[204:207], v[68:71]
    v_add_u32 v6, s23, v6
    s_waitcnt lgkmcnt(8)
    v_mfma_f32_16x16x32_bf16 v[24:27], v[168:171], a[192:195], v[24:27]
    v_add_u32 v248, v6, v92
    v_add_u32 v249, v6, v93
    buffer_load_dwordx4 a[136:139], v90, s[40:43], s65 offen offset:0 sc1
    v_mfma_f32_16x16x32_bf16 v[40:43], v[168:171], a[196:199], v[40:43]
    v_add_u32 v254, v6, v94
    v_mfma_f32_16x16x32_bf16 v[56:59], v[168:171], a[200:203], v[56:59]
    v_add_u32 v15, v6, v95
    ds_read_b64_tr_b16 v[192:193], v248 offset:4096
    v_mfma_f32_16x16x32_bf16 v[72:75], v[168:171], a[204:207], v[72:75]
    ds_read_b64_tr_b16 v[194:195], v248 offset:5120
    v_mfma_f32_16x16x32_bf16 v[28:31], v[172:175], a[192:195], v[28:31]
    ds_read_b64_tr_b16 v[196:197], v249 offset:4096
    ds_read_b64_tr_b16 v[198:199], v249 offset:5120
    buffer_load_dwordx4 a[140:143], v91, s[40:43], s65 offen offset:0 sc1
    v_mfma_f32_16x16x32_bf16 v[44:47], v[172:175], a[196:199], v[44:47]
    ds_read_b64_tr_b16 v[200:201], v254 offset:4096
    v_mfma_f32_16x16x32_bf16 v[60:63], v[172:175], a[200:203], v[60:63]
    ds_read_b64_tr_b16 v[202:203], v254 offset:5120
    ds_read_b64_tr_b16 v[204:205], v15 offset:4096
    v_mfma_f32_16x16x32_bf16 v[76:79], v[172:175], a[204:207], v[76:79]
    ds_read_b64_tr_b16 v[206:207], v15 offset:5120
    s_waitcnt vmcnt(12) lgkmcnt(12)
    v_mfma_f32_16x16x32_bf16 v[16:19], v[176:179], a[208:211], v[16:19]
    ds_read_b64_tr_b16 v[160:161], v92 offset:8192
    v_mfma_f32_16x16x32_bf16 v[32:35], v[176:179], a[212:215], v[32:35]
    ds_read_b64_tr_b16 v[162:163], v92 offset:10240
    buffer_load_dwordx4 a[144:147], v88, s[40:43], s65 offen offset:1024 sc1
    v_mfma_f32_16x16x32_bf16 v[48:51], v[176:179], a[216:219], v[48:51]
    ds_read_b64_tr_b16 v[164:165], v93 offset:8192
    v_mfma_f32_16x16x32_bf16 v[64:67], v[176:179], a[220:223], v[64:67]
    ds_read_b64_tr_b16 v[166:167], v93 offset:10240
    v_mfma_f32_16x16x32_bf16 v[20:23], v[180:183], a[208:211], v[20:23]
    ds_read_b64_tr_b16 v[168:169], v94 offset:8192
    buffer_load_dwordx4 a[148:151], v89, s[40:43], s65 offen offset:1024 sc1
    v_mfma_f32_16x16x32_bf16 v[36:39], v[180:183], a[212:215], v[36:39]
    ds_read_b64_tr_b16 v[170:171], v94 offset:10240
    v_mfma_f32_16x16x32_bf16 v[52:55], v[180:183], a[216:219], v[52:55]
    ds_read_b64_tr_b16 v[172:173], v95 offset:8192
    v_mfma_f32_16x16x32_bf16 v[68:71], v[180:183], a[220:223], v[68:71]
    ds_read_b64_tr_b16 v[174:175], v95 offset:10240
    s_waitcnt lgkmcnt(15)
    v_mfma_f32_16x16x32_bf16 v[24:27], v[184:187], a[208:211], v[24:27]
    ds_read_b64_tr_b16 v[224:225], v248 offset:8192
    buffer_load_dwordx4 a[152:155], v90, s[40:43], s65 offen offset:1024 sc1
    v_mfma_f32_16x16x32_bf16 v[40:43], v[184:187], a[212:215], v[40:43]
    ds_read_b64_tr_b16 v[226:227], v248 offset:9216
    v_mfma_f32_16x16x32_bf16 v[56:59], v[184:187], a[216:219], v[56:59]
    ds_read_b64_tr_b16 v[228:229], v249 offset:8192
    v_mfma_f32_16x16x32_bf16 v[72:75], v[184:187], a[220:223], v[72:75]
    ds_read_b64_tr_b16 v[230:231], v249 offset:9216
    v_mfma_f32_16x16x32_bf16 v[28:31], v[188:191], a[208:211], v[28:31]
    ds_read_b64_tr_b16 v[232:233], v254 offset:8192
    buffer_load_dwordx4 a[156:159], v91, s[40:43], s65 offen offset:1024 sc1
    v_mfma_f32_16x16x32_bf16 v[44:47], v[188:191], a[212:215], v[44:47]
    ds_read_b64_tr_b16 v[234:235], v254 offset:9216
    v_mfma_f32_16x16x32_bf16 v[60:63], v[188:191], a[216:219], v[60:63]
    ds_read_b64_tr_b16 v[236:237], v15 offset:8192
    v_mfma_f32_16x16x32_bf16 v[76:79], v[188:191], a[220:223], v[76:79]
    ds_read_b64_tr_b16 v[238:239], v15 offset:9216
    s_waitcnt vmcnt(12) lgkmcnt(12)
    v_mfma_f32_16x16x32_bf16 v[16:19], v[160:163], a[224:227], v[16:19]
    s_sub_u32 s3, s21, s22
    v_add_u32 v92, s3, v92
    s_add_u32 m0, s22, 0
    s_add_u32 s66, s66, 32768
    v_mfma_f32_16x16x32_bf16 v[32:35], v[160:163], a[228:231], v[32:35]
    v_add_u32 v93, s3, v93
    buffer_load_dwordx4 v2, s[32:35], s66 offen offset:0 lds
    v_mfma_f32_16x16x32_bf16 v[48:51], v[160:163], a[232:235], v[48:51]
    v_add_u32 v94, s3, v94
    v_mfma_f32_16x16x32_bf16 v[64:67], v[160:163], a[236:239], v[64:67]
    v_add_u32 v95, s3, v95
    v_mfma_f32_16x16x32_bf16 v[20:23], v[164:167], a[224:227], v[20:23]
    ds_read_b64_tr_b16 v[176:177], v92 offset:0
    buffer_load_dwordx4 v3, s[32:35], s66 offen offset:1024 lds
    v_mfma_f32_16x16x32_bf16 v[36:39], v[164:167], a[228:231], v[36:39]
    ds_read_b64_tr_b16 v[178:179], v92 offset:2048
    v_mfma_f32_16x16x32_bf16 v[52:55], v[164:167], a[232:235], v[52:55]
    ds_read_b64_tr_b16 v[180:181], v93 offset:0
    v_mfma_f32_16x16x32_bf16 v[68:71], v[164:167], a[236:239], v[68:71]
    ds_read_b64_tr_b16 v[182:183], v93 offset:2048
    s_waitcnt lgkmcnt(12)
    v_mfma_f32_16x16x32_bf16 v[24:27], v[168:171], a[224:227], v[24:27]
    ds_read_b64_tr_b16 v[184:185], v94 offset:0
    buffer_load_dwordx4 v4, s[32:35], s66 offen offset:2048 lds
    v_mfma_f32_16x16x32_bf16 v[40:43], v[168:171], a[228:231], v[40:43]
    ds_read_b64_tr_b16 v[186:187], v94 offset:2048
    v_mfma_f32_16x16x32_bf16 v[56:59], v[168:171], a[232:235], v[56:59]
    ds_read_b64_tr_b16 v[188:189], v95 offset:0
    v_mfma_f32_16x16x32_bf16 v[72:75], v[168:171], a[236:239], v[72:75]
    ds_read_b64_tr_b16 v[190:191], v95 offset:2048
    v_mfma_f32_16x16x32_bf16 v[28:31], v[172:175], a[224:227], v[28:31]
    buffer_load_dwordx4 v5, s[32:35], s66 offen offset:3072 lds
    v_mfma_f32_16x16x32_bf16 v[44:47], v[172:175], a[228:231], v[44:47]
    v_mfma_f32_16x16x32_bf16 v[60:63], v[172:175], a[232:235], v[60:63]
    v_mfma_f32_16x16x32_bf16 v[76:79], v[172:175], a[236:239], v[76:79]
    s_waitcnt vmcnt(12) lgkmcnt(4)
    v_mfma_f32_16x16x32_bf16 v[16:19], v[176:179], a[240:243], v[16:19]
    ds_read_b64_tr_b16 v[160:161], v92 offset:4096
    v_and_b32 v12, 15, v1
    v_mfma_f32_16x16x32_bf16 v[32:35], v[176:179], a[244:247], v[32:35]
    ds_read_b64_tr_b16 v[162:163], v92 offset:6144
    buffer_load_dwordx4 a[160:163], v88, s[40:43], s65 offen offset:2048 sc1
    v_mfma_f32_16x16x32_bf16 v[48:51], v[176:179], a[248:251], v[48:51]
    ds_read_b64_tr_b16 v[164:165], v93 offset:4096
    v_mfma_f32_16x16x32_bf16 v[64:67], v[176:179], a[252:255], v[64:67]
    ds_read_b64_tr_b16 v[166:167], v93 offset:6144
    v_lshlrev_b32 v12, 4, v12
    v_mfma_f32_16x16x32_bf16 v[20:23], v[180:183], a[240:243], v[20:23]
    ds_read_b64_tr_b16 v[168:169], v94 offset:4096
    buffer_load_dwordx4 a[164:167], v89, s[40:43], s65 offen offset:2048 sc1
    v_mfma_f32_16x16x32_bf16 v[36:39], v[180:183], a[244:247], v[36:39]
    ds_read_b64_tr_b16 v[170:171], v94 offset:6144
    v_mfma_f32_16x16x32_bf16 v[52:55], v[180:183], a[248:251], v[52:55]
    ds_read_b64_tr_b16 v[172:173], v95 offset:4096
    v_lshrrev_b32 v13, 4, v1
    v_mfma_f32_16x16x32_bf16 v[68:71], v[180:183], a[252:255], v[68:71]
    ds_read_b64_tr_b16 v[174:175], v95 offset:6144
    s_waitcnt lgkmcnt(8)
    v_mfma_f32_16x16x32_bf16 v[24:27], v[184:187], a[240:243], v[24:27]
    ds_read_b64_tr_b16 v[208:209], v248 offset:12288
    buffer_load_dwordx4 a[168:171], v90, s[40:43], s65 offen offset:2048 sc1
    v_mfma_f32_16x16x32_bf16 v[40:43], v[184:187], a[244:247], v[40:43]
    ds_read_b64_tr_b16 v[210:211], v248 offset:13312
    v_lshl_add_u32 v12, v13, 9, v12
    v_mfma_f32_16x16x32_bf16 v[56:59], v[184:187], a[248:251], v[56:59]
    ds_read_b64_tr_b16 v[212:213], v249 offset:12288
    v_mfma_f32_16x16x32_bf16 v[72:75], v[184:187], a[252:255], v[72:75]
    ds_read_b64_tr_b16 v[214:215], v249 offset:13312
    v_mfma_f32_16x16x32_bf16 v[28:31], v[188:191], a[240:243], v[28:31]
    ds_read_b64_tr_b16 v[216:217], v254 offset:12288
    buffer_load_dwordx4 a[172:175], v91, s[40:43], s65 offen offset:2048 sc1
    v_add_u32 v13, 98304, v12
    v_mfma_f32_16x16x32_bf16 v[44:47], v[188:191], a[244:247], v[44:47]
    ds_read_b64_tr_b16 v[218:219], v254 offset:13312
    v_mfma_f32_16x16x32_bf16 v[60:63], v[188:191], a[248:251], v[60:63]
    ds_read_b64_tr_b16 v[220:221], v15 offset:12288
    v_mfma_f32_16x16x32_bf16 v[76:79], v[188:191], a[252:255], v[76:79]
    ds_read_b64_tr_b16 v[222:223], v15 offset:13312
    s_waitcnt vmcnt(12) lgkmcnt(12)
    v_mfma_f32_16x16x32_bf16 v[16:19], v[160:163], a[128:131], v[16:19]
    ds_read_b64_tr_b16 v[176:177], v92 offset:8192
    s_mul_i32 s65, s56, 24
    s_add_u32 s65, s65, s52
    s_lshl_b32 s65, s65, 13
    s_add_u32 s62, s65, 4096
    s_mov_b32 s36, s18
    v_mfma_f32_16x16x32_bf16 v[32:35], v[160:163], a[132:135], v[32:35]
    ds_read_b64_tr_b16 v[178:179], v92 offset:10240
    buffer_load_dwordx4 v[96:99], v12, s[40:43], s65 offen offset:0 sc1
    v_mfma_f32_16x16x32_bf16 v[48:51], v[160:163], a[136:139], v[48:51]
    v_mfma_f32_16x16x32_bf16 v[64:67], v[160:163], a[140:143], v[64:67]
    ds_read_b64_tr_b16 v[180:181], v93 offset:8192
    v_mfma_f32_16x16x32_bf16 v[20:23], v[164:167], a[128:131], v[20:23]
    ds_read_b64_tr_b16 v[182:183], v93 offset:10240
    buffer_load_dwordx4 v[100:103], v12, s[40:43], s65 offen offset:2048 sc1
    s_mov_b32 s37, s19
    v_mfma_f32_16x16x32_bf16 v[36:39], v[164:167], a[132:135], v[36:39]
    v_mfma_f32_16x16x32_bf16 v[52:55], v[164:167], a[136:139], v[52:55]
    ds_read_b64_tr_b16 v[184:185], v94 offset:8192
    v_mfma_f32_16x16x32_bf16 v[68:71], v[164:167], a[140:143], v[68:71]
    ds_read_b64_tr_b16 v[186:187], v94 offset:10240
    s_waitcnt lgkmcnt(14)
    v_mfma_f32_16x16x32_bf16 v[24:27], v[168:171], a[128:131], v[24:27]
    buffer_load_dwordx4 v[104:107], v12, s[40:43], s62 offen offset:0 sc1
    s_mov_b32 s38, 2097152
    v_mfma_f32_16x16x32_bf16 v[40:43], v[168:171], a[132:135], v[40:43]
    ds_read_b64_tr_b16 v[188:189], v95 offset:8192
    v_mfma_f32_16x16x32_bf16 v[56:59], v[168:171], a[136:139], v[56:59]
    ds_read_b64_tr_b16 v[190:191], v95 offset:10240
    v_mfma_f32_16x16x32_bf16 v[72:75], v[168:171], a[140:143], v[72:75]
    v_mfma_f32_16x16x32_bf16 v[28:31], v[172:175], a[128:131], v[28:31]
    buffer_load_dwordx4 v[108:111], v12, s[40:43], s62 offen offset:2048 sc1
    s_mov_b32 s39, 0x20000
    v_mfma_f32_16x16x32_bf16 v[44:47], v[172:175], a[132:135], v[44:47]
    v_mfma_f32_16x16x32_bf16 v[60:63], v[172:175], a[136:139], v[60:63]
    v_mfma_f32_16x16x32_bf16 v[76:79], v[172:175], a[140:143], v[76:79]
    s_waitcnt vmcnt(12) lgkmcnt(4)
    v_mfma_f32_16x16x32_bf16 v[16:19], v[176:179], a[144:147], v[16:19]
    s_sub_u32 s3, s20, s21
    v_add_u32 v92, s3, v92
    v_and_b32 v6, 15, v1
    v_lshrrev_b32 v7, 4, v1
    v_mfma_f32_16x16x32_bf16 v[32:35], v[176:179], a[148:151], v[32:35]
    v_add_u32 v93, s3, v93
    buffer_load_dwordx4 v[112:115], v12, s[40:43], s65 offen offset:256 sc1
    v_and_b32 v8, 3, v6
    v_mfma_f32_16x16x32_bf16 v[48:51], v[176:179], a[152:155], v[48:51]
    v_add_u32 v94, s3, v94
    v_xor_b32 v7, v7, v8
    v_mfma_f32_16x16x32_bf16 v[64:67], v[176:179], a[156:159], v[64:67]
    v_add_u32 v95, s3, v95
    v_lshlrev_b32 v7, 4, v7
    v_mfma_f32_16x16x32_bf16 v[20:23], v[180:183], a[144:147], v[20:23]
    ds_read_b64_tr_b16 v[160:161], v92 offset:0
    buffer_load_dwordx4 v[116:119], v12, s[40:43], s65 offen offset:2304 sc1
    v_lshl_add_u32 v7, v6, 8, v7
    v_mfma_f32_16x16x32_bf16 v[36:39], v[180:183], a[148:151], v[36:39]
    ds_read_b64_tr_b16 v[162:163], v92 offset:2048
    v_bfe_u32 v8, v1, 2, 1
    v_lshl_add_u32 v6, v8, 6, v7
    v_mfma_f32_16x16x32_bf16 v[52:55], v[180:183], a[152:155], v[52:55]
    ds_read_b64_tr_b16 v[164:165], v93 offset:0
    v_add_u32 v6, s20, v6
    v_mfma_f32_16x16x32_bf16 v[68:71], v[180:183], a[156:159], v[68:71]
    ds_read_b64_tr_b16 v[166:167], v93 offset:2048
    v_xor_b32 v8, 64, v6
    s_waitcnt lgkmcnt(4)
    v_mfma_f32_16x16x32_bf16 v[24:27], v[184:187], a[144:147], v[24:27]
    ds_read_b64_tr_b16 v[168:169], v94 offset:0
    buffer_load_dwordx4 v[120:123], v12, s[40:43], s62 offen offset:256 sc1
    v_lshlrev_b32 v7, 1, v251
    v_mfma_f32_16x16x32_bf16 v[40:43], v[184:187], a[148:151], v[40:43]
    ds_read_b64_tr_b16 v[170:171], v94 offset:2048
    v_xor_b32 v7, v7, v250
    v_mfma_f32_16x16x32_bf16 v[56:59], v[184:187], a[152:155], v[56:59]
    ds_read_b64_tr_b16 v[172:173], v95 offset:0
    v_lshlrev_b32 v7, 4, v7
    v_lshl_add_u32 v7, v250, 8, v7
    v_mfma_f32_16x16x32_bf16 v[72:75], v[184:187], a[156:159], v[72:75]
    ds_read_b64_tr_b16 v[174:175], v95 offset:2048
    s_lshl_b32 s59, s52, 12
    v_mfma_f32_16x16x32_bf16 v[28:31], v[188:191], a[144:147], v[28:31]
    buffer_load_dwordx4 v[124:127], v12, s[40:43], s62 offen offset:2304 sc1
    s_add_u32 s59, s59, 36864
    v_mfma_f32_16x16x32_bf16 v[44:47], v[188:191], a[148:151], v[44:47]
    v_add_u32 v7, s59, v7
    v_mfma_f32_16x16x32_bf16 v[60:63], v[188:191], a[152:155], v[60:63]
    v_xor_b32 v10, 16, v7
    v_mfma_f32_16x16x32_bf16 v[76:79], v[188:191], a[156:159], v[76:79]
    s_mov_b32 s60, 0xffff0000
    s_waitcnt vmcnt(8) lgkmcnt(4)
    v_mfma_f32_16x16x32_bf16 v[16:19], v[160:163], a[160:163], v[16:19]
    s_sub_u32 s23, s22, s20
    v_add_u32 v248, s23, v248
    v_mfma_f32_16x16x32_bf16 v[32:35], v[160:163], a[164:167], v[32:35]
    v_add_u32 v249, s23, v249
    buffer_load_dwordx4 v[128:131], v13, s[40:43], s65 offen offset:0 sc1
    v_mfma_f32_16x16x32_bf16 v[48:51], v[160:163], a[168:171], v[48:51]
    v_add_u32 v254, s23, v254
    v_mfma_f32_16x16x32_bf16 v[64:67], v[160:163], a[172:175], v[64:67]
    v_add_u32 v15, s23, v15
    v_mfma_f32_16x16x32_bf16 v[20:23], v[164:167], a[160:163], v[20:23]
    ds_read_b64_tr_b16 v[176:177], v248 offset:0
    buffer_load_dwordx4 v[132:135], v13, s[40:43], s65 offen offset:2048 sc1
    v_mfma_f32_16x16x32_bf16 v[36:39], v[164:167], a[164:167], v[36:39]
    ds_read_b64_tr_b16 v[178:179], v248 offset:1024
    v_mfma_f32_16x16x32_bf16 v[52:55], v[164:167], a[168:171], v[52:55]
    ds_read_b64_tr_b16 v[180:181], v249 offset:0
    v_mfma_f32_16x16x32_bf16 v[68:71], v[164:167], a[172:175], v[68:71]
    ds_read_b64_tr_b16 v[182:183], v249 offset:1024
    s_waitcnt lgkmcnt(4)
    v_mfma_f32_16x16x32_bf16 v[24:27], v[168:171], a[160:163], v[24:27]
    ds_read_b64_tr_b16 v[184:185], v254 offset:0
    buffer_load_dwordx4 v[136:139], v13, s[40:43], s62 offen offset:0 sc1
    v_mfma_f32_16x16x32_bf16 v[40:43], v[168:171], a[164:167], v[40:43]
    ds_read_b64_tr_b16 v[186:187], v254 offset:1024
    v_mfma_f32_16x16x32_bf16 v[56:59], v[168:171], a[168:171], v[56:59]
    ds_read_b64_tr_b16 v[188:189], v15 offset:0
    v_mfma_f32_16x16x32_bf16 v[72:75], v[168:171], a[172:175], v[72:75]
    ds_read_b64_tr_b16 v[190:191], v15 offset:1024
    v_mfma_f32_16x16x32_bf16 v[28:31], v[172:175], a[160:163], v[28:31]
    buffer_load_dwordx4 v[140:143], v13, s[40:43], s62 offen offset:2048 sc1
    v_mfma_f32_16x16x32_bf16 v[44:47], v[172:175], a[164:167], v[44:47]
    v_mfma_f32_16x16x32_bf16 v[60:63], v[172:175], a[168:171], v[60:63]
    v_mfma_f32_16x16x32_bf16 v[76:79], v[172:175], a[172:175], v[76:79]
    s_waitcnt vmcnt(9)
    v_bitop3_b32 v2, v96, v100, v104 bitop3:0x80
    s_waitcnt vmcnt(8)
    v_bitop3_b32 v2, v2, v108, v9 bitop3:0x80
    v_cmp_ne_u32 vcc, v9, v2
    s_nop 0
    s_cbranch_vccnz Lsp_18
Lok_19:
    v_mfma_f32_16x16x32_bf16 v[16:19], v[192:195], v[96:99], v[16:19]
    v_lshlrev_b32 v160, 16, v240
    v_mfma_f32_16x16x32_bf16 v[20:23], v[196:199], v[96:99], v[20:23]
    buffer_load_dwordx4 v[144:147], v13, s[40:43], s65 offen offset:256 sc1
    v_and_b32 v161, s60, v240
    v_mfma_f32_16x16x32_bf16 v[24:27], v[200:203], v[96:99], v[24:27]
    v_lshlrev_b32 v162, 16, v241
    v_mfma_f32_16x16x32_bf16 v[28:31], v[204:207], v[96:99], v[28:31]
    v_and_b32 v163, s60, v241
    v_mfma_f32_16x16x32_bf16 v[16:19], v[224:227], v[100:103], v[16:19]
    buffer_load_dwordx4 v[148:151], v13, s[40:43], s65 offen offset:2304 sc1
    v_lshlrev_b32 v164, 16, v242
    v_mfma_f32_16x16x32_bf16 v[20:23], v[228:231], v[100:103], v[20:23]
    v_and_b32 v165, s60, v242
    v_mfma_f32_16x16x32_bf16 v[24:27], v[232:235], v[100:103], v[24:27]
    v_lshlrev_b32 v166, 16, v243
    v_mfma_f32_16x16x32_bf16 v[28:31], v[236:239], v[100:103], v[28:31]
    v_and_b32 v167, s60, v243
    v_mfma_f32_16x16x32_bf16 v[16:19], v[208:211], v[104:107], v[16:19]
    buffer_load_dwordx4 v[152:155], v13, s[40:43], s62 offen offset:256 sc1
    v_lshlrev_b32 v168, 16, v244
    v_mfma_f32_16x16x32_bf16 v[20:23], v[212:215], v[104:107], v[20:23]
    v_and_b32 v169, s60, v244
    v_mfma_f32_16x16x32_bf16 v[24:27], v[216:219], v[104:107], v[24:27]
    v_lshlrev_b32 v170, 16, v245
    v_mfma_f32_16x16x32_bf16 v[28:31], v[220:223], v[104:107], v[28:31]
    v_and_b32 v171, s60, v245
    s_waitcnt lgkmcnt(6)
    v_mfma_f32_16x16x32_bf16 v[16:19], v[176:179], v[108:111], v[16:19]
    buffer_load_dwordx4 v[156:159], v13, s[40:43], s62 offen offset:2304 sc1
    v_lshlrev_b32 v172, 16, v246
    s_waitcnt lgkmcnt(4)
    v_mfma_f32_16x16x32_bf16 v[20:23], v[180:183], v[108:111], v[20:23]
    v_and_b32 v173, s60, v246
    s_waitcnt lgkmcnt(2)
    v_mfma_f32_16x16x32_bf16 v[24:27], v[184:187], v[108:111], v[24:27]
    v_lshlrev_b32 v174, 16, v247
    s_waitcnt lgkmcnt(0)
    v_mfma_f32_16x16x32_bf16 v[28:31], v[188:191], v[108:111], v[28:31]
    v_and_b32 v175, s60, v247
    s_waitcnt vmcnt(9)
    v_bitop3_b32 v2, v112, v116, v120 bitop3:0x80
    s_waitcnt vmcnt(8)
    v_bitop3_b32 v2, v2, v124, v9 bitop3:0x80
    v_cmp_ne_u32 vcc, v9, v2
    s_nop 0
    s_cbranch_vccnz Lsp_20
Lok_21:
    v_mfma_f32_16x16x32_bf16 v[32:35], v[192:195], v[112:115], v[32:35]
    v_mfma_f32_16x16x32_bf16 v[36:39], v[196:199], v[112:115], v[36:39]
    v_mfma_f32_16x16x32_bf16 v[40:43], v[200:203], v[112:115], v[40:43]
    ds_write_b128 v6, v[16:19] offset:0
    v_mfma_f32_16x16x32_bf16 v[44:47], v[204:207], v[112:115], v[44:47]
    v_mfma_f32_16x16x32_bf16 v[32:35], v[224:227], v[116:119], v[32:35]
    v_mfma_f32_16x16x32_bf16 v[36:39], v[228:231], v[116:119], v[36:39]
    v_mfma_f32_16x16x32_bf16 v[40:43], v[232:235], v[116:119], v[40:43]
    ds_write_b128 v8, v[20:23] offset:0
    v_mfma_f32_16x16x32_bf16 v[44:47], v[236:239], v[116:119], v[44:47]
    v_mfma_f32_16x16x32_bf16 v[32:35], v[208:211], v[120:123], v[32:35]
    v_mfma_f32_16x16x32_bf16 v[36:39], v[212:215], v[120:123], v[36:39]
    v_mfma_f32_16x16x32_bf16 v[40:43], v[216:219], v[120:123], v[40:43]
    ds_write_b128 v6, v[24:27] offset:128
    v_mfma_f32_16x16x32_bf16 v[44:47], v[220:223], v[120:123], v[44:47]
    v_mfma_f32_16x16x32_bf16 v[32:35], v[176:179], v[124:127], v[32:35]
    v_mfma_f32_16x16x32_bf16 v[36:39], v[180:183], v[124:127], v[36:39]
    v_mfma_f32_16x16x32_bf16 v[40:43], v[184:187], v[124:127], v[40:43]
    ds_write_b128 v8, v[28:31] offset:128
    v_mfma_f32_16x16x32_bf16 v[44:47], v[188:191], v[124:127], v[44:47]
    s_waitcnt vmcnt(5)
    v_bitop3_b32 v2, v128, v132, v136 bitop3:0x80
    s_waitcnt vmcnt(4)
    v_bitop3_b32 v2, v2, v140, v9 bitop3:0x80
    v_cmp_ne_u32 vcc, v9, v2
    s_nop 0
    s_cbranch_vccnz Lsp_22
Lok_23:
    v_mfma_f32_16x16x32_bf16 v[48:51], v[192:195], v[128:131], v[48:51]
    v_mfma_f32_16x16x32_bf16 v[52:55], v[196:199], v[128:131], v[52:55]
    v_mfma_f32_16x16x32_bf16 v[56:59], v[200:203], v[128:131], v[56:59]
    ds_write_b128 v6, v[32:35] offset:4096
    v_mfma_f32_16x16x32_bf16 v[60:63], v[204:207], v[128:131], v[60:63]
    v_mfma_f32_16x16x32_bf16 v[48:51], v[224:227], v[132:135], v[48:51]
    v_mfma_f32_16x16x32_bf16 v[52:55], v[228:231], v[132:135], v[52:55]
    v_mfma_f32_16x16x32_bf16 v[56:59], v[232:235], v[132:135], v[56:59]
    ds_write_b128 v8, v[36:39] offset:4096
    v_mfma_f32_16x16x32_bf16 v[60:63], v[236:239], v[132:135], v[60:63]
    v_mfma_f32_16x16x32_bf16 v[48:51], v[208:211], v[136:139], v[48:51]
    v_mfma_f32_16x16x32_bf16 v[52:55], v[212:215], v[136:139], v[52:55]
    v_mfma_f32_16x16x32_bf16 v[56:59], v[216:219], v[136:139], v[56:59]
    ds_write_b128 v6, v[40:43] offset:4224
    v_mfma_f32_16x16x32_bf16 v[60:63], v[220:223], v[136:139], v[60:63]
    v_mfma_f32_16x16x32_bf16 v[48:51], v[176:179], v[140:143], v[48:51]
    v_mfma_f32_16x16x32_bf16 v[52:55], v[180:183], v[140:143], v[52:55]
    v_mfma_f32_16x16x32_bf16 v[56:59], v[184:187], v[140:143], v[56:59]
    ds_write_b128 v8, v[44:47] offset:4224
    v_mfma_f32_16x16x32_bf16 v[60:63], v[188:191], v[140:143], v[60:63]
    s_waitcnt vmcnt(1)
    v_bitop3_b32 v2, v144, v148, v152 bitop3:0x80
    s_waitcnt vmcnt(0)
    v_bitop3_b32 v2, v2, v156, v9 bitop3:0x80
    v_cmp_ne_u32 vcc, v9, v2
    s_nop 0
    s_cbranch_vccnz Lsp_24
Lok_25:
    v_mfma_f32_16x16x32_bf16 v[64:67], v[192:195], v[144:147], v[64:67]
    v_mfma_f32_16x16x32_bf16 v[68:71], v[196:199], v[144:147], v[68:71]
    v_mfma_f32_16x16x32_bf16 v[72:75], v[200:203], v[144:147], v[72:75]
    ds_write_b128 v6, v[48:51] offset:8192
    v_mfma_f32_16x16x32_bf16 v[76:79], v[204:207], v[144:147], v[76:79]
    v_mfma_f32_16x16x32_bf16 v[64:67], v[224:227], v[148:151], v[64:67]
    v_mfma_f32_16x16x32_bf16 v[68:71], v[228:231], v[148:151], v[68:71]
    v_mfma_f32_16x16x32_bf16 v[72:75], v[232:235], v[148:151], v[72:75]
    ds_write_b128 v8, v[52:55] offset:8192
    v_mfma_f32_16x16x32_bf16 v[76:79], v[236:239], v[148:151], v[76:79]
    v_mfma_f32_16x16x32_bf16 v[64:67], v[208:211], v[152:155], v[64:67]
    v_mfma_f32_16x16x32_bf16 v[68:71], v[212:215], v[152:155], v[68:71]
    v_mfma_f32_16x16x32_bf16 v[72:75], v[216:219], v[152:155], v[72:75]
    ds_write_b128 v6, v[56:59] offset:8320
    v_mfma_f32_16x16x32_bf16 v[76:79], v[220:223], v[152:155], v[76:79]
    v_mfma_f32_16x16x32_bf16 v[64:67], v[176:179], v[156:159], v[64:67]
    v_mfma_f32_16x16x32_bf16 v[68:71], v[180:183], v[156:159], v[68:71]
    v_mfma_f32_16x16x32_bf16 v[72:75], v[184:187], v[156:159], v[72:75]
    ds_write_b128 v8, v[60:63] offset:8320
    v_mfma_f32_16x16x32_bf16 v[76:79], v[188:191], v[156:159], v[76:79]
    s_nop 3
    ds_write_b128 v6, v[64:67] offset:12288
    ds_write_b128 v8, v[68:71] offset:12288
    ds_write_b128 v6, v[72:75] offset:12416
    s_nop 0
    ds_write_b128 v8, v[76:79] offset:12416
    s_waitcnt lgkmcnt(0)
    s_barrier
    ds_read_b128 v[96:99], v7 offset:0
    ds_read_b128 v[100:103], v10 offset:0
    ds_read_b128 v[104:107], v7 offset:16384
    ds_read_b128 v[108:111], v10 offset:16384
    ds_read_b128 v[112:115], v7 offset:32768
    ds_read_b128 v[116:119], v10 offset:32768
    ds_read_b128 v[120:123], v7 offset:49152
    ds_read_b128 v[124:127], v10 offset:49152
    ds_read_b128 v[128:131], v7 offset:2048
    ds_read_b128 v[132:135], v10 offset:2048
    ds_read_b128 v[136:139], v7 offset:18432
    ds_read_b128 v[140:143], v10 offset:18432
    ds_read_b128 v[144:147], v7 offset:34816
    ds_read_b128 v[148:151], v10 offset:34816
    ds_read_b128 v[152:155], v7 offset:51200
    ds_read_b128 v[156:159], v10 offset:51200
    s_waitcnt lgkmcnt(15)
    v_pk_add_f32 v[160:161], v[160:161], v[96:97]
    v_pk_add_f32 v[162:163], v[162:163], v[98:99]
    s_waitcnt lgkmcnt(14)
    v_pk_add_f32 v[164:165], v[164:165], v[100:101]
    v_pk_add_f32 v[166:167], v[166:167], v[102:103]
    s_waitcnt lgkmcnt(13)
    v_pk_add_f32 v[160:161], v[160:161], v[104:105]
    v_pk_add_f32 v[162:163], v[162:163], v[106:107]
    s_waitcnt lgkmcnt(12)
    v_pk_add_f32 v[164:165], v[164:165], v[108:109]
    v_pk_add_f32 v[166:167], v[166:167], v[110:111]
    s_waitcnt lgkmcnt(11)
    v_pk_add_f32 v[160:161], v[160:161], v[112:113]
    v_pk_add_f32 v[162:163], v[162:163], v[114:115]
    s_waitcnt lgkmcnt(10)
    v_pk_add_f32 v[164:165], v[164:165], v[116:117]
    v_pk_add_f32 v[166:167], v[166:167], v[118:119]
    s_waitcnt lgkmcnt(9)
    v_pk_add_f32 v[160:161], v[160:161], v[120:121]
    v_pk_add_f32 v[162:163], v[162:163], v[122:123]
    s_waitcnt lgkmcnt(8)
    v_pk_add_f32 v[164:165], v[164:165], v[124:125]
    v_pk_add_f32 v[166:167], v[166:167], v[126:127]
    v_cvt_pk_bf16_f32 v240, v160, v161
    v_cvt_pk_bf16_f32 v241, v162, v163
    v_cvt_pk_bf16_f32 v242, v164, v165
    v_cvt_pk_bf16_f32 v243, v166, v167
    buffer_store_dwordx4 v[240:243], v252, s[36:39], s58 offen sc1
    s_waitcnt lgkmcnt(7)
    v_pk_add_f32 v[168:169], v[168:169], v[128:129]
    v_pk_add_f32 v[170:171], v[170:171], v[130:131]
    s_waitcnt lgkmcnt(6)
    v_pk_add_f32 v[172:173], v[172:173], v[132:133]
    v_pk_add_f32 v[174:175], v[174:175], v[134:135]
    s_waitcnt lgkmcnt(5)
    v_pk_add_f32 v[168:169], v[168:169], v[136:137]
    v_pk_add_f32 v[170:171], v[170:171], v[138:139]
    s_waitcnt lgkmcnt(4)
    v_pk_add_f32 v[172:173], v[172:173], v[140:141]
    v_pk_add_f32 v[174:175], v[174:175], v[142:143]
    s_waitcnt lgkmcnt(3)
    v_pk_add_f32 v[168:169], v[168:169], v[144:145]
    v_pk_add_f32 v[170:171], v[170:171], v[146:147]
    s_waitcnt lgkmcnt(2)
    v_pk_add_f32 v[172:173], v[172:173], v[148:149]
    v_pk_add_f32 v[174:175], v[174:175], v[150:151]
    s_waitcnt lgkmcnt(1)
    v_pk_add_f32 v[168:169], v[168:169], v[152:153]
    v_pk_add_f32 v[170:171], v[170:171], v[154:155]
    s_waitcnt lgkmcnt(0)
    v_pk_add_f32 v[172:173], v[172:173], v[156:157]
    v_pk_add_f32 v[174:175], v[174:175], v[158:159]
    v_cvt_pk_bf16_f32 v244, v168, v169
    v_cvt_pk_bf16_f32 v245, v170, v171
    v_cvt_pk_bf16_f32 v246, v172, v173
    v_cvt_pk_bf16_f32 v247, v174, v175
    buffer_store_dwordx4 v[244:247], v253, s[36:39], s58 offen sc1
Lend:
    s_endpgm
Lvsel:
    s_cmp_gt_u32 s54, 10
    s_cbranch_scc1 Lnv6_4
Lnv2_3:
    s_waitcnt lgkmcnt(6)
    v_mfma_f32_16x16x32_bf16 v[144:147], a[128:131], v[16:19], 0
    ds_read_b64_tr_b16 a[148:149], v243 offset:160
    v_mfma_f32_16x16x32_bf16 v[148:151], a[128:131], v[20:23], 0
    ds_read_b64_tr_b16 a[150:151], v243 offset:928
    s_add_u32 m0, s59, 114688
    v_mfma_f32_16x16x32_bf16 v[152:155], a[132:135], v[16:19], 0
    ds_read_b64_tr_b16 a[128:129], v242 offset:6144
    v_mfma_f32_16x16x32_bf16 v[156:159], a[132:135], v[20:23], 0
    ds_read_b64_tr_b16 a[130:131], v242 offset:6912
    buffer_load_dwordx4 v11, s[36:39], s62 offen offset:0 lds
    s_waitcnt lgkmcnt(6)
    v_mfma_f32_16x16x32_bf16 v[160:163], a[136:139], v[16:19], 0
    ds_read_b64_tr_b16 a[132:133], v243 offset:6176
    v_mfma_f32_16x16x32_bf16 v[164:167], a[136:139], v[20:23], 0
    ds_read_b64_tr_b16 a[134:135], v243 offset:6944
    buffer_load_dwordx4 v12, s[36:39], s62 offen offset:1024 lds
    v_mfma_f32_16x16x32_bf16 v[168:171], a[140:143], v[16:19], 0
    ds_read_b64_tr_b16 a[136:137], v242 offset:6208
    v_mfma_f32_16x16x32_bf16 v[172:175], a[140:143], v[20:23], 0
    ds_read_b64_tr_b16 a[138:139], v242 offset:6976
    buffer_load_dwordx4 v13, s[36:39], s62 offen offset:2048 lds
    s_waitcnt lgkmcnt(6)
    v_mfma_f32_16x16x32_bf16 v[176:179], v[16:19], a[144:147], 0
    ds_read_b64_tr_b16 a[140:141], v243 offset:6240
    v_mfma_f32_16x16x32_bf16 v[180:183], v[20:23], a[144:147], 0
    ds_read_b64_tr_b16 a[142:143], v243 offset:7008
    s_add_u32 m0, s59, 126976
    v_mfma_f32_16x16x32_bf16 v[184:187], v[16:19], a[148:151], 0
    ds_read_b64_tr_b16 a[144:145], v242 offset:6272
    v_mfma_f32_16x16x32_bf16 v[188:191], v[20:23], a[148:151], 0
    ds_read_b64_tr_b16 a[146:147], v242 offset:7040
    buffer_load_dwordx4 v11, s[36:39], s63 offen offset:0 lds
    s_waitcnt lgkmcnt(6)
    v_mfma_f32_16x16x32_bf16 v[144:147], a[128:131], v[24:27], v[144:147]
    ds_read_b64_tr_b16 a[148:149], v243 offset:6304
    v_mfma_f32_16x16x32_bf16 v[148:151], a[128:131], v[28:31], v[148:151]
    ds_read_b64_tr_b16 a[150:151], v243 offset:7072
    buffer_load_dwordx4 v12, s[36:39], s63 offen offset:1024 lds
    v_mfma_f32_16x16x32_bf16 v[152:155], a[132:135], v[24:27], v[152:155]
    ds_read_b64_tr_b16 a[128:129], v242 offset:12288
    v_mfma_f32_16x16x32_bf16 v[156:159], a[132:135], v[28:31], v[156:159]
    ds_read_b64_tr_b16 a[130:131], v242 offset:13056
    buffer_load_dwordx4 v13, s[36:39], s63 offen offset:2048 lds
    s_waitcnt lgkmcnt(6)
    v_mfma_f32_16x16x32_bf16 v[160:163], a[136:139], v[24:27], v[160:163]
    ds_read_b64_tr_b16 a[132:133], v243 offset:12320
    v_mfma_f32_16x16x32_bf16 v[164:167], a[136:139], v[28:31], v[164:167]
    ds_read_b64_tr_b16 a[134:135], v243 offset:13088
    s_add_u32 m0, s59, 139264
    v_mfma_f32_16x16x32_bf16 v[168:171], a[140:143], v[24:27], v[168:171]
    ds_read_b64_tr_b16 a[136:137], v242 offset:12352
    v_mfma_f32_16x16x32_bf16 v[172:175], a[140:143], v[28:31], v[172:175]
    ds_read_b64_tr_b16 a[138:139], v242 offset:13120
    buffer_load_dwordx4 v11, s[36:39], s65 offen offset:0 lds
    s_waitcnt lgkmcnt(6)
    v_mfma_f32_16x16x32_bf16 v[176:179], v[24:27], a[144:147], v[176:179]
    ds_read_b64_tr_b16 a[140:141], v243 offset:12384
    v_mfma_f32_16x16x32_bf16 v[180:183], v[28:31], a[144:147], v[180:183]
    ds_read_b64_tr_b16 a[142:143], v243 offset:13152
    buffer_load_dwordx4 v12, s[36:39], s65 offen offset:1024 lds
    v_mfma_f32_16x16x32_bf16 v[184:187], v[24:27], a[148:151], v[184:187]
    ds_read_b64_tr_b16 a[144:145], v242 offset:12416
    v_mfma_f32_16x16x32_bf16 v[188:191], v[28:31], a[148:151], v[188:191]
    ds_read_b64_tr_b16 a[146:147], v242 offset:13184
    buffer_load_dwordx4 v13, s[36:39], s65 offen offset:2048 lds
    s_waitcnt lgkmcnt(6)
    v_mfma_f32_16x16x32_bf16 v[144:147], a[128:131], v[32:35], v[144:147]
    ds_read_b64_tr_b16 a[148:149], v243 offset:12448
    v_mfma_f32_16x16x32_bf16 v[148:151], a[128:131], v[36:39], v[148:151]
    ds_read_b64_tr_b16 a[150:151], v243 offset:13216
    s_add_u32 m0, s59, 151552
    v_mfma_f32_16x16x32_bf16 v[152:155], a[132:135], v[32:35], v[152:155]
    ds_read_b64_tr_b16 a[128:129], v242 offset:18432
    v_mfma_f32_16x16x32_bf16 v[156:159], a[132:135], v[36:39], v[156:159]
    ds_read_b64_tr_b16 a[130:131], v242 offset:19200
    buffer_load_dwordx4 v11, s[36:39], s61 offen offset:0 lds
    s_waitcnt lgkmcnt(6)
    v_mfma_f32_16x16x32_bf16 v[160:163], a[136:139], v[32:35], v[160:163]
    ds_read_b64_tr_b16 a[132:133], v243 offset:18464
    v_mfma_f32_16x16x32_bf16 v[164:167], a[136:139], v[36:39], v[164:167]
    ds_read_b64_tr_b16 a[134:135], v243 offset:19232
    buffer_load_dwordx4 v12, s[36:39], s61 offen offset:1024 lds
    v_mfma_f32_16x16x32_bf16 v[168:171], a[140:143], v[32:35], v[168:171]
    ds_read_b64_tr_b16 a[136:137], v242 offset:18496
    v_mfma_f32_16x16x32_bf16 v[172:175], a[140:143], v[36:39], v[172:175]
    ds_read_b64_tr_b16 a[138:139], v242 offset:19264
    buffer_load_dwordx4 v13, s[36:39], s61 offen offset:2048 lds
    s_waitcnt lgkmcnt(6)
    v_mfma_f32_16x16x32_bf16 v[176:179], v[32:35], a[144:147], v[176:179]
    ds_read_b64_tr_b16 a[140:141], v243 offset:18528
    v_mfma_f32_16x16x32_bf16 v[180:183], v[36:39], a[144:147], v[180:183]
    ds_read_b64_tr_b16 a[142:143], v243 offset:19296
    s_add_u32 m0, s59, 0
    v_mfma_f32_16x16x32_bf16 v[184:187], v[32:35], a[148:151], v[184:187]
    ds_read_b64_tr_b16 a[144:145], v242 offset:18560
    v_mfma_f32_16x16x32_bf16 v[188:191], v[36:39], a[148:151], v[188:191]
    ds_read_b64_tr_b16 a[146:147], v242 offset:19328
    buffer_load_dwordx4 v8, s[28:31], s4 offen offset:0 lds
    s_waitcnt lgkmcnt(6)
    v_mfma_f32_16x16x32_bf16 v[144:147], a[128:131], v[40:43], v[144:147]
    ds_read_b64_tr_b16 a[148:149], v243 offset:18592
    v_mfma_f32_16x16x32_bf16 v[148:151], a[128:131], v[44:47], v[148:151]
    ds_read_b64_tr_b16 a[150:151], v243 offset:19360
    v_mfma_f32_16x16x32_bf16 v[152:155], a[132:135], v[40:43], v[152:155]
    s_waitcnt vmcnt(13)
    s_barrier
    ds_read_b64_tr_b16 a[128:129], v242 offset:24576
    v_mfma_f32_16x16x32_bf16 v[156:159], a[132:135], v[44:47], v[156:159]
    ds_read_b64_tr_b16 a[130:131], v242 offset:25344
    buffer_load_dwordx4 v9, s[28:31], s4 offen offset:1024 lds
    s_waitcnt lgkmcnt(6)
    v_mfma_f32_16x16x32_bf16 v[160:163], a[136:139], v[40:43], v[160:163]
    ds_read_b64_tr_b16 a[132:133], v243 offset:24608
    v_mfma_f32_16x16x32_bf16 v[164:167], a[136:139], v[44:47], v[164:167]
    ds_read_b64_tr_b16 a[134:135], v243 offset:25376
    v_mfma_f32_16x16x32_bf16 v[168:171], a[140:143], v[40:43], v[168:171]
    ds_read_b64_tr_b16 a[136:137], v242 offset:24640
    v_mfma_f32_16x16x32_bf16 v[172:175], a[140:143], v[44:47], v[172:175]
    ds_read_b64_tr_b16 a[138:139], v242 offset:25408
    buffer_load_dwordx4 v10, s[28:31], s4 offen offset:2048 lds
    s_waitcnt lgkmcnt(6)
    v_mfma_f32_16x16x32_bf16 v[176:179], v[40:43], a[144:147], v[176:179]
    ds_read_b64_tr_b16 a[140:141], v243 offset:24672
    v_mfma_f32_16x16x32_bf16 v[180:183], v[44:47], a[144:147], v[180:183]
    ds_read_b64_tr_b16 a[142:143], v243 offset:25440
    v_mfma_f32_16x16x32_bf16 v[184:187], v[40:43], a[148:151], v[184:187]
    ds_read_b64_tr_b16 a[144:145], v242 offset:24704
    v_mfma_f32_16x16x32_bf16 v[188:191], v[44:47], a[148:151], v[188:191]
    ds_read_b64_tr_b16 a[146:147], v242 offset:25472
    s_add_u32 m0, s59, 12288
    s_waitcnt lgkmcnt(6)
    v_mfma_f32_16x16x32_bf16 v[144:147], a[128:131], v[48:51], v[144:147]
    ds_read_b64_tr_b16 a[148:149], v243 offset:24736
    v_mfma_f32_16x16x32_bf16 v[148:151], a[128:131], v[52:55], v[148:151]
    ds_read_b64_tr_b16 a[150:151], v243 offset:25504
    buffer_load_dwordx4 v8, s[32:35], s4 offen offset:0 lds
    v_mfma_f32_16x16x32_bf16 v[152:155], a[132:135], v[48:51], v[152:155]
    ds_read_b64_tr_b16 a[128:129], v242 offset:30720
    v_mfma_f32_16x16x32_bf16 v[156:159], a[132:135], v[52:55], v[156:159]
    ds_read_b64_tr_b16 a[130:131], v242 offset:31488
    s_waitcnt lgkmcnt(6)
    v_mfma_f32_16x16x32_bf16 v[160:163], a[136:139], v[48:51], v[160:163]
    ds_read_b64_tr_b16 a[132:133], v243 offset:30752
    v_mfma_f32_16x16x32_bf16 v[164:167], a[136:139], v[52:55], v[164:167]
    ds_read_b64_tr_b16 a[134:135], v243 offset:31520
    buffer_load_dwordx4 v9, s[32:35], s4 offen offset:1024 lds
    v_mfma_f32_16x16x32_bf16 v[168:171], a[140:143], v[48:51], v[168:171]
    ds_read_b64_tr_b16 a[136:137], v242 offset:30784
    v_mfma_f32_16x16x32_bf16 v[172:175], a[140:143], v[52:55], v[172:175]
    ds_read_b64_tr_b16 a[138:139], v242 offset:31552
    s_waitcnt lgkmcnt(6)
    v_mfma_f32_16x16x32_bf16 v[176:179], v[48:51], a[144:147], v[176:179]
    ds_read_b64_tr_b16 a[140:141], v243 offset:30816
    v_mfma_f32_16x16x32_bf16 v[180:183], v[52:55], a[144:147], v[180:183]
    ds_read_b64_tr_b16 a[142:143], v243 offset:31584
    buffer_load_dwordx4 v10, s[32:35], s4 offen offset:2048 lds
    v_mfma_f32_16x16x32_bf16 v[184:187], v[48:51], a[148:151], v[184:187]
    ds_read_b64_tr_b16 a[144:145], v242 offset:30848
    v_mfma_f32_16x16x32_bf16 v[188:191], v[52:55], a[148:151], v[188:191]
    ds_read_b64_tr_b16 a[146:147], v242 offset:31616
    s_waitcnt lgkmcnt(6)
    v_mfma_f32_16x16x32_bf16 v[144:147], a[128:131], v[56:59], v[144:147]
    ds_read_b64_tr_b16 a[148:149], v243 offset:30880
    v_mfma_f32_16x16x32_bf16 v[148:151], a[128:131], v[60:63], v[148:151]
    ds_read_b64_tr_b16 a[150:151], v243 offset:31648
    buffer_load_dwordx2 v[252:253], off, s[44:47], 0 sc1
    v_mfma_f32_16x16x32_bf16 v[152:155], a[132:135], v[56:59], v[152:155]
    ds_read_b64_tr_b16 a[128:129], v242 offset:36864
    v_mfma_f32_16x16x32_bf16 v[156:159], a[132:135], v[60:63], v[156:159]
    ds_read_b64_tr_b16 a[130:131], v242 offset:37632
    s_waitcnt lgkmcnt(6)
    v_mfma_f32_16x16x32_bf16 v[160:163], a[136:139], v[56:59], v[160:163]
    ds_read_b64_tr_b16 a[132:133], v243 offset:36896
    v_mfma_f32_16x16x32_bf16 v[164:167], a[136:139], v[60:63], v[164:167]
    ds_read_b64_tr_b16 a[134:135], v243 offset:37664
    v_mfma_f32_16x16x32_bf16 v[168:171], a[140:143], v[56:59], v[168:171]
    ds_read_b64_tr_b16 a[136:137], v242 offset:36928
    v_mfma_f32_16x16x32_bf16 v[172:175], a[140:143], v[60:63], v[172:175]
    ds_read_b64_tr_b16 a[138:139], v242 offset:37696
    s_waitcnt lgkmcnt(6)
    v_mfma_f32_16x16x32_bf16 v[176:179], v[56:59], a[144:147], v[176:179]
    ds_read_b64_tr_b16 a[140:141], v243 offset:36960
    v_mfma_f32_16x16x32_bf16 v[180:183], v[60:63], a[144:147], v[180:183]
    ds_read_b64_tr_b16 a[142:143], v243 offset:37728
    v_mfma_f32_16x16x32_bf16 v[184:187], v[56:59], a[148:151], v[184:187]
    ds_read_b64_tr_b16 a[144:145], v242 offset:36992
    v_mfma_f32_16x16x32_bf16 v[188:191], v[60:63], a[148:151], v[188:191]
    ds_read_b64_tr_b16 a[146:147], v242 offset:37760
    s_waitcnt lgkmcnt(6)
    v_mfma_f32_16x16x32_bf16 v[144:147], a[128:131], v[64:67], v[144:147]
    ds_read_b64_tr_b16 a[148:149], v243 offset:37024
    v_mfma_f32_16x16x32_bf16 v[148:151], a[128:131], v[68:71], v[148:151]
    ds_read_b64_tr_b16 a[150:151], v243 offset:37792
    v_mfma_f32_16x16x32_bf16 v[152:155], a[132:135], v[64:67], v[152:155]
    ds_read_b64_tr_b16 a[128:129], v242 offset:43008
    v_mfma_f32_16x16x32_bf16 v[156:159], a[132:135], v[68:71], v[156:159]
    ds_read_b64_tr_b16 a[130:131], v242 offset:43776
    s_waitcnt lgkmcnt(6)
    v_mfma_f32_16x16x32_bf16 v[160:163], a[136:139], v[64:67], v[160:163]
    ds_read_b64_tr_b16 a[132:133], v243 offset:43040
    v_mfma_f32_16x16x32_bf16 v[164:167], a[136:139], v[68:71], v[164:167]
    ds_read_b64_tr_b16 a[134:135], v243 offset:43808
    v_mfma_f32_16x16x32_bf16 v[168:171], a[140:143], v[64:67], v[168:171]
    ds_read_b64_tr_b16 a[136:137], v242 offset:43072
    v_mfma_f32_16x16x32_bf16 v[172:175], a[140:143], v[68:71], v[172:175]
    ds_read_b64_tr_b16 a[138:139], v242 offset:43840
    s_waitcnt lgkmcnt(6)
    v_mfma_f32_16x16x32_bf16 v[176:179], v[64:67], a[144:147], v[176:179]
    ds_read_b64_tr_b16 a[140:141], v243 offset:43104
    v_mfma_f32_16x16x32_bf16 v[180:183], v[68:71], a[144:147], v[180:183]
    ds_read_b64_tr_b16 a[142:143], v243 offset:43872
    v_mfma_f32_16x16x32_bf16 v[184:187], v[64:67], a[148:151], v[184:187]
    ds_read_b64_tr_b16 a[144:145], v242 offset:43136
    v_mfma_f32_16x16x32_bf16 v[188:191], v[68:71], a[148:151], v[188:191]
    ds_read_b64_tr_b16 a[146:147], v242 offset:43904
    s_waitcnt lgkmcnt(6)
    v_mfma_f32_16x16x32_bf16 v[144:147], a[128:131], v[72:75], v[144:147]
    ds_read_b64_tr_b16 a[148:149], v243 offset:43168
    v_mfma_f32_16x16x32_bf16 v[148:151], a[128:131], v[76:79], v[148:151]
    ds_read_b64_tr_b16 a[150:151], v243 offset:43936
    v_mfma_f32_16x16x32_bf16 v[152:155], a[132:135], v[72:75], v[152:155]
    s_waitcnt vmcnt(13)
    s_barrier
    ds_read_b64_tr_b16 a[128:129], v242 offset:49152
    v_mfma_f32_16x16x32_bf16 v[156:159], a[132:135], v[76:79], v[156:159]
    ds_read_b64_tr_b16 a[130:131], v242 offset:49920
    s_waitcnt lgkmcnt(6)
    v_mfma_f32_16x16x32_bf16 v[160:163], a[136:139], v[72:75], v[160:163]
    ds_read_b64_tr_b16 a[132:133], v243 offset:49184
    v_mfma_f32_16x16x32_bf16 v[164:167], a[136:139], v[76:79], v[164:167]
    ds_read_b64_tr_b16 a[134:135], v243 offset:49952
    s_mov_b32 s36, s16
    v_mfma_f32_16x16x32_bf16 v[168:171], a[140:143], v[72:75], v[168:171]
    ds_read_b64_tr_b16 a[136:137], v242 offset:49216
    v_mfma_f32_16x16x32_bf16 v[172:175], a[140:143], v[76:79], v[172:175]
    ds_read_b64_tr_b16 a[138:139], v242 offset:49984
    s_mov_b32 s37, s17
    s_waitcnt lgkmcnt(6)
    v_mfma_f32_16x16x32_bf16 v[176:179], v[72:75], a[144:147], v[176:179]
    ds_read_b64_tr_b16 a[140:141], v243 offset:49248
    v_mfma_f32_16x16x32_bf16 v[180:183], v[76:79], a[144:147], v[180:183]
    ds_read_b64_tr_b16 a[142:143], v243 offset:50016
    s_mov_b32 s38, 1409024
    v_mfma_f32_16x16x32_bf16 v[184:187], v[72:75], a[148:151], v[184:187]
    ds_read_b64_tr_b16 a[144:145], v242 offset:49280
    v_mfma_f32_16x16x32_bf16 v[188:191], v[76:79], a[148:151], v[188:191]
    ds_read_b64_tr_b16 a[146:147], v242 offset:50048
    s_mov_b32 s39, 0x20000
    s_waitcnt lgkmcnt(6)
    v_mfma_f32_16x16x32_bf16 v[144:147], a[128:131], v[80:83], v[144:147]
    ds_read_b64_tr_b16 a[148:149], v243 offset:49312
    v_mfma_f32_16x16x32_bf16 v[148:151], a[128:131], v[84:87], v[148:151]
    ds_read_b64_tr_b16 a[150:151], v243 offset:50080
    s_lshl2_add_u32 s67, s49, s52
    v_mfma_f32_16x16x32_bf16 v[152:155], a[132:135], v[80:83], v[152:155]
    ds_read_b64_tr_b16 a[128:129], v242 offset:55296
    v_mfma_f32_16x16x32_bf16 v[156:159], a[132:135], v[84:87], v[156:159]
    ds_read_b64_tr_b16 a[130:131], v242 offset:56064
    v_min_u32 v254, 42, v1
    s_waitcnt lgkmcnt(6)
    v_mfma_f32_16x16x32_bf16 v[160:163], a[136:139], v[80:83], v[160:163]
    ds_read_b64_tr_b16 a[132:133], v243 offset:55328
    v_mfma_f32_16x16x32_bf16 v[164:167], a[136:139], v[84:87], v[164:167]
    ds_read_b64_tr_b16 a[134:135], v243 offset:56096
    v_mov_b32 v15, 43
    v_mfma_f32_16x16x32_bf16 v[168:171], a[140:143], v[80:83], v[168:171]
    ds_read_b64_tr_b16 a[136:137], v242 offset:55360
    v_mfma_f32_16x16x32_bf16 v[172:175], a[140:143], v[84:87], v[172:175]
    ds_read_b64_tr_b16 a[138:139], v242 offset:56128
    v_mad_u32_u24 v254, v15, s67, v254
    s_waitcnt lgkmcnt(6)
    v_mfma_f32_16x16x32_bf16 v[176:179], v[80:83], a[144:147], v[176:179]
    ds_read_b64_tr_b16 a[140:141], v243 offset:55392
    v_mfma_f32_16x16x32_bf16 v[180:183], v[84:87], a[144:147], v[180:183]
    ds_read_b64_tr_b16 a[142:143], v243 offset:56160
    v_and_b32 v15, 3, v254
    v_mfma_f32_16x16x32_bf16 v[184:187], v[80:83], a[148:151], v[184:187]
    ds_read_b64_tr_b16 a[144:145], v242 offset:55424
    v_mfma_f32_16x16x32_bf16 v[188:191], v[84:87], a[148:151], v[188:191]
    ds_read_b64_tr_b16 a[146:147], v242 offset:56192
    v_lshrrev_b32 v254, 2, v254
    s_waitcnt lgkmcnt(6)
    v_mfma_f32_16x16x32_bf16 v[144:147], a[128:131], v[88:91], v[144:147]
    ds_read_b64_tr_b16 a[148:149], v243 offset:55456
    v_mfma_f32_16x16x32_bf16 v[148:151], a[128:131], v[92:95], v[148:151]
    ds_read_b64_tr_b16 a[150:151], v243 offset:56224
    v_lshlrev_b32 v15, 7, v15
    v_mfma_f32_16x16x32_bf16 v[152:155], a[132:135], v[88:91], v[152:155]
    ds_read_b64_tr_b16 a[128:129], v244 offset:0
    v_mfma_f32_16x16x32_bf16 v[156:159], a[132:135], v[92:95], v[156:159]
    ds_read_b64_tr_b16 a[130:131], v244 offset:768
    v_lshl_add_u32 v15, v254, 10, v15
    s_waitcnt lgkmcnt(6)
    v_mfma_f32_16x16x32_bf16 v[160:163], a[136:139], v[88:91], v[160:163]
    ds_read_b64_tr_b16 a[132:133], v245 offset:32
    v_mfma_f32_16x16x32_bf16 v[164:167], a[136:139], v[92:95], v[164:167]
    ds_read_b64_tr_b16 a[134:135], v245 offset:800
    s_add_u32 m0, s59, 24576
    s_and_b32 s64, s2, 1
    v_mfma_f32_16x16x32_bf16 v[168:171], a[140:143], v[88:91], v[168:171]
    ds_read_b64_tr_b16 a[136:137], v244 offset:64
    v_mfma_f32_16x16x32_bf16 v[172:175], a[140:143], v[92:95], v[172:175]
    ds_read_b64_tr_b16 a[138:139], v244 offset:832
    buffer_load_dwordx4 v8, s[28:31], s5 offen offset:0 lds
    s_lshl_b32 s64, s64, 9
    s_waitcnt lgkmcnt(6)
    v_mfma_f32_16x16x32_bf16 v[176:179], v[88:91], a[144:147], v[176:179]
    ds_read_b64_tr_b16 a[140:141], v245 offset:96
    v_mfma_f32_16x16x32_bf16 v[180:183], v[92:95], a[144:147], v[180:183]
    ds_read_b64_tr_b16 a[142:143], v245 offset:864
    v_add_f32 v216, v216, v217
    v_add_f32 v218, v218, v219
    v_mfma_f32_16x16x32_bf16 v[184:187], v[88:91], a[148:151], v[184:187]
    ds_read_b64_tr_b16 a[144:145], v244 offset:128
    v_mfma_f32_16x16x32_bf16 v[188:191], v[92:95], a[148:151], v[188:191]
    ds_read_b64_tr_b16 a[146:147], v244 offset:896
    buffer_load_dwordx4 v9, s[28:31], s5 offen offset:1024 lds
    v_mov_b32 v217, v216
    s_waitcnt lgkmcnt(6)
    v_mfma_f32_16x16x32_bf16 v[144:147], a[128:131], v[96:99], v[144:147]
    ds_read_b64_tr_b16 a[148:149], v245 offset:160
    v_mfma_f32_16x16x32_bf16 v[148:151], a[128:131], v[100:103], v[148:151]
    ds_read_b64_tr_b16 a[150:151], v245 offset:928
    v_mov_b32 v219, v218
    v_mfma_f32_16x16x32_bf16 v[152:155], a[132:135], v[96:99], v[152:155]
    ds_read_b64_tr_b16 a[128:129], v244 offset:6144
    v_mfma_f32_16x16x32_bf16 v[156:159], a[132:135], v[100:103], v[156:159]
    ds_read_b64_tr_b16 a[130:131], v244 offset:6912
    buffer_load_dwordx4 v10, s[28:31], s5 offen offset:2048 lds
    v_permlane16_swap_b32 v216, v217
    s_waitcnt lgkmcnt(6)
    v_mfma_f32_16x16x32_bf16 v[160:163], a[136:139], v[96:99], v[160:163]
    ds_read_b64_tr_b16 a[132:133], v245 offset:6176
    v_mfma_f32_16x16x32_bf16 v[164:167], a[136:139], v[100:103], v[164:167]
    ds_read_b64_tr_b16 a[134:135], v245 offset:6944
    v_permlane16_swap_b32 v218, v219
    v_mfma_f32_16x16x32_bf16 v[168:171], a[140:143], v[96:99], v[168:171]
    ds_read_b64_tr_b16 a[136:137], v244 offset:6208
    v_mfma_f32_16x16x32_bf16 v[172:175], a[140:143], v[100:103], v[172:175]
    ds_read_b64_tr_b16 a[138:139], v244 offset:6976
    s_add_u32 m0, s59, 36864
    v_add_f32 v216, v216, v217
    s_waitcnt lgkmcnt(6)
    v_mfma_f32_16x16x32_bf16 v[176:179], v[96:99], a[144:147], v[176:179]
    ds_read_b64_tr_b16 a[140:141], v245 offset:6240
    v_mfma_f32_16x16x32_bf16 v[180:183], v[100:103], a[144:147], v[180:183]
    ds_read_b64_tr_b16 a[142:143], v245 offset:7008
    buffer_load_dwordx4 v8, s[32:35], s5 offen offset:0 lds
    v_add_f32 v218, v218, v219
    v_mfma_f32_16x16x32_bf16 v[184:187], v[96:99], a[148:151], v[184:187]
    ds_read_b64_tr_b16 a[144:145], v244 offset:6272
    v_mfma_f32_16x16x32_bf16 v[188:191], v[100:103], a[148:151], v[188:191]
    ds_read_b64_tr_b16 a[146:147], v244 offset:7040
    v_mov_b32 v217, v216
    s_waitcnt lgkmcnt(6)
    v_mfma_f32_16x16x32_bf16 v[144:147], a[128:131], v[104:107], v[144:147]
    ds_read_b64_tr_b16 a[148:149], v245 offset:6304
    v_mfma_f32_16x16x32_bf16 v[148:151], a[128:131], v[108:111], v[148:151]
    ds_read_b64_tr_b16 a[150:151], v245 offset:7072
    buffer_load_dwordx4 v9, s[32:35], s5 offen offset:1024 lds
    v_mov_b32 v219, v218
    v_permlane32_swap_b32 v216, v217
    v_mfma_f32_16x16x32_bf16 v[152:155], a[132:135], v[104:107], v[152:155]
    s_waitcnt vmcnt(12)
    s_barrier
    ds_read_b64_tr_b16 a[128:129], v244 offset:12288
    v_mfma_f32_16x16x32_bf16 v[156:159], a[132:135], v[108:111], v[156:159]
    ds_read_b64_tr_b16 a[130:131], v244 offset:13056
    v_permlane32_swap_b32 v218, v219
    s_waitcnt lgkmcnt(6)
    v_mfma_f32_16x16x32_bf16 v[160:163], a[136:139], v[104:107], v[160:163]
    ds_read_b64_tr_b16 a[132:133], v245 offset:12320
    v_mfma_f32_16x16x32_bf16 v[164:167], a[136:139], v[108:111], v[164:167]
    ds_read_b64_tr_b16 a[134:135], v245 offset:13088
    buffer_load_dwordx4 v10, s[32:35], s5 offen offset:2048 lds
    v_add_f32 v216, v216, v217
    v_mfma_f32_16x16x32_bf16 v[168:171], a[140:143], v[104:107], v[168:171]
    ds_read_b64_tr_b16 a[136:137], v244 offset:12352
    v_mfma_f32_16x16x32_bf16 v[172:175], a[140:143], v[108:111], v[172:175]
    ds_read_b64_tr_b16 a[138:139], v244 offset:13120
    v_add_f32 v218, v218, v219
    s_waitcnt lgkmcnt(6)
    v_mfma_f32_16x16x32_bf16 v[176:179], v[104:107], a[144:147], v[176:179]
    ds_read_b64_tr_b16 a[140:141], v245 offset:12384
    v_mfma_f32_16x16x32_bf16 v[180:183], v[108:111], a[144:147], v[180:183]
    ds_read_b64_tr_b16 a[142:143], v245 offset:13152
    v_mul_f32 v216, 0x3b000000, v216
    v_mfma_f32_16x16x32_bf16 v[184:187], v[104:107], a[148:151], v[184:187]
    ds_read_b64_tr_b16 a[144:145], v244 offset:12416
    v_mfma_f32_16x16x32_bf16 v[188:191], v[108:111], a[148:151], v[188:191]
    ds_read_b64_tr_b16 a[146:147], v244 offset:13184
    v_fma_f32 v216, -v220, v220, v216
    s_waitcnt lgkmcnt(6)
    v_mfma_f32_16x16x32_bf16 v[144:147], a[128:131], v[112:115], v[144:147]
    ds_read_b64_tr_b16 a[148:149], v245 offset:12448
    v_mfma_f32_16x16x32_bf16 v[148:151], a[128:131], v[116:119], v[148:151]
    ds_read_b64_tr_b16 a[150:151], v245 offset:13216
    v_max_f32 v216, 0, v216
    v_mfma_f32_16x16x32_bf16 v[152:155], a[132:135], v[112:115], v[152:155]
    ds_read_b64_tr_b16 a[128:129], v244 offset:18432
    v_mfma_f32_16x16x32_bf16 v[156:159], a[132:135], v[116:119], v[156:159]
    ds_read_b64_tr_b16 a[130:131], v244 offset:19200
    v_add_f32 v216, 0x3727c5ac, v216
    s_waitcnt lgkmcnt(6)
    v_mfma_f32_16x16x32_bf16 v[160:163], a[136:139], v[112:115], v[160:163]
    ds_read_b64_tr_b16 a[132:133], v245 offset:18464
    v_mfma_f32_16x16x32_bf16 v[164:167], a[136:139], v[116:119], v[164:167]
    ds_read_b64_tr_b16 a[134:135], v245 offset:19232
    s_add_u32 m0, s59, 49152
    v_rsq_f32 v248, v216
    v_mfma_f32_16x16x32_bf16 v[168:171], a[140:143], v[112:115], v[168:171]
    ds_read_b64_tr_b16 a[136:137], v244 offset:18496
    v_mfma_f32_16x16x32_bf16 v[172:175], a[140:143], v[116:119], v[172:175]
    ds_read_b64_tr_b16 a[138:139], v244 offset:19264
    buffer_load_dwordx4 v8, s[28:31], s6 offen offset:0 lds
    v_mul_f32 v218, 0x3b000000, v218
    v_fma_f32 v218, -v224, v224, v218
    s_waitcnt lgkmcnt(6)
    v_mfma_f32_16x16x32_bf16 v[176:179], v[112:115], a[144:147], v[176:179]
    ds_read_b64_tr_b16 a[140:141], v245 offset:18528
    v_mfma_f32_16x16x32_bf16 v[180:183], v[116:119], a[144:147], v[180:183]
    ds_read_b64_tr_b16 a[142:143], v245 offset:19296
    v_max_f32 v218, 0, v218
    v_mfma_f32_16x16x32_bf16 v[184:187], v[112:115], a[148:151], v[184:187]
    ds_read_b64_tr_b16 a[144:145], v244 offset:18560
    v_mfma_f32_16x16x32_bf16 v[188:191], v[116:119], a[148:151], v[188:191]
    ds_read_b64_tr_b16 a[146:147], v244 offset:19328
    buffer_load_dwordx4 v9, s[28:31], s6 offen offset:1024 lds
    v_add_f32 v218, 0x3727c5ac, v218
    s_waitcnt lgkmcnt(6)
    v_mfma_f32_16x16x32_bf16 v[144:147], a[128:131], v[120:123], v[144:147]
    ds_read_b64_tr_b16 a[148:149], v245 offset:18592
    v_mfma_f32_16x16x32_bf16 v[148:151], a[128:131], v[124:127], v[148:151]
    ds_read_b64_tr_b16 a[150:151], v245 offset:19360
    v_rsq_f32 v249, v218
    v_mfma_f32_16x16x32_bf16 v[152:155], a[132:135], v[120:123], v[152:155]
    ds_read_b64_tr_b16 a[128:129], v244 offset:24576
    v_mfma_f32_16x16x32_bf16 v[156:159], a[132:135], v[124:127], v[156:159]
    ds_read_b64_tr_b16 a[130:131], v244 offset:25344
    buffer_load_dwordx4 v10, s[28:31], s6 offen offset:2048 lds
    v_lshrrev_b32 v250, 4, v1
    s_waitcnt lgkmcnt(6)
    v_mfma_f32_16x16x32_bf16 v[160:163], a[136:139], v[120:123], v[160:163]
    ds_read_b64_tr_b16 a[132:133], v245 offset:24608
    v_mfma_f32_16x16x32_bf16 v[164:167], a[136:139], v[124:127], v[164:167]
    ds_read_b64_tr_b16 a[134:135], v245 offset:25376
    v_lshlrev_b32 v250, 4, v250
    v_mfma_f32_16x16x32_bf16 v[168:171], a[140:143], v[120:123], v[168:171]
    ds_read_b64_tr_b16 a[136:137], v244 offset:24640
    v_mfma_f32_16x16x32_bf16 v[172:175], a[140:143], v[124:127], v[172:175]
    ds_read_b64_tr_b16 a[138:139], v244 offset:25408
    s_add_u32 m0, s59, 65536
    v_add_u32 v251, 0, v250
    s_waitcnt lgkmcnt(6)
    v_mfma_f32_16x16x32_bf16 v[176:179], v[120:123], a[144:147], v[176:179]
    ds_read_b64_tr_b16 a[140:141], v245 offset:24672
    v_mfma_f32_16x16x32_bf16 v[180:183], v[124:127], a[144:147], v[180:183]
    ds_read_b64_tr_b16 a[142:143], v245 offset:25440
    buffer_load_dwordx4 v8, s[32:35], s6 offen offset:0 lds
    ds_bpermute_b32 v192, v251, v248
    v_mfma_f32_16x16x32_bf16 v[184:187], v[120:123], a[148:151], v[184:187]
    ds_read_b64_tr_b16 a[144:145], v244 offset:24704
    v_mfma_f32_16x16x32_bf16 v[188:191], v[124:127], a[148:151], v[188:191]
    ds_read_b64_tr_b16 a[146:147], v244 offset:25472
    ds_bpermute_b32 v196, v251, v249
    v_add_u32 v251, 4, v250
    s_waitcnt lgkmcnt(8)
    v_mfma_f32_16x16x32_bf16 v[144:147], a[128:131], v[128:131], v[144:147]
    ds_read_b64_tr_b16 a[148:149], v245 offset:24736
    v_mfma_f32_16x16x32_bf16 v[148:151], a[128:131], v[132:135], v[148:151]
    ds_read_b64_tr_b16 a[150:151], v245 offset:25504
    buffer_load_dwordx4 v9, s[32:35], s6 offen offset:1024 lds
    ds_bpermute_b32 v193, v251, v248
    v_mfma_f32_16x16x32_bf16 v[152:155], a[132:135], v[128:131], v[152:155]
    ds_read_b64_tr_b16 a[128:129], v244 offset:30720
    v_mfma_f32_16x16x32_bf16 v[156:159], a[132:135], v[132:135], v[156:159]
    ds_read_b64_tr_b16 a[130:131], v244 offset:31488
    ds_bpermute_b32 v197, v251, v249
    s_waitcnt lgkmcnt(10)
    v_mfma_f32_16x16x32_bf16 v[160:163], a[136:139], v[128:131], v[160:163]
    ds_read_b64_tr_b16 a[132:133], v245 offset:30752
    v_mfma_f32_16x16x32_bf16 v[164:167], a[136:139], v[132:135], v[164:167]
    ds_read_b64_tr_b16 a[134:135], v245 offset:31520
    buffer_load_dwordx4 v10, s[32:35], s6 offen offset:2048 lds
    v_add_u32 v251, 8, v250
    v_mfma_f32_16x16x32_bf16 v[168:171], a[140:143], v[128:131], v[168:171]
    ds_read_b64_tr_b16 a[136:137], v244 offset:30784
    v_mfma_f32_16x16x32_bf16 v[172:175], a[140:143], v[132:135], v[172:175]
    ds_read_b64_tr_b16 a[138:139], v244 offset:31552
    ds_bpermute_b32 v194, v251, v248
    s_waitcnt lgkmcnt(9)
    v_mfma_f32_16x16x32_bf16 v[176:179], v[128:131], a[144:147], v[176:179]
    ds_read_b64_tr_b16 a[140:141], v245 offset:30816
    v_mfma_f32_16x16x32_bf16 v[180:183], v[132:135], a[144:147], v[180:183]
    ds_read_b64_tr_b16 a[142:143], v245 offset:31584
    ds_bpermute_b32 v198, v251, v249
    v_mfma_f32_16x16x32_bf16 v[184:187], v[128:131], a[148:151], v[184:187]
    ds_read_b64_tr_b16 a[144:145], v244 offset:30848
    v_mfma_f32_16x16x32_bf16 v[188:191], v[132:135], a[148:151], v[188:191]
    ds_read_b64_tr_b16 a[146:147], v244 offset:31616
    v_add_u32 v251, 12, v250
    s_waitcnt lgkmcnt(8)
    v_mfma_f32_16x16x32_bf16 v[144:147], a[128:131], v[136:139], v[144:147]
    ds_read_b64_tr_b16 a[148:149], v245 offset:30880
    v_mfma_f32_16x16x32_bf16 v[148:151], a[128:131], v[140:143], v[148:151]
    ds_read_b64_tr_b16 a[150:151], v245 offset:31648
    ds_bpermute_b32 v195, v251, v248
    v_mfma_f32_16x16x32_bf16 v[152:155], a[132:135], v[136:139], v[152:155]
    s_waitcnt vmcnt(13)
    s_barrier
    ds_read_b64_tr_b16 a[128:129], v240 offset:0
    v_mfma_f32_16x16x32_bf16 v[156:159], a[132:135], v[140:143], v[156:159]
    ds_read_b64_tr_b16 a[130:131], v240 offset:768
    ds_bpermute_b32 v199, v251, v249
    s_waitcnt lgkmcnt(9)
    v_mfma_f32_16x16x32_bf16 v[160:163], a[136:139], v[136:139], v[160:163]
    ds_read_b64_tr_b16 a[132:133], v240 offset:12288
    v_mfma_f32_16x16x32_bf16 v[164:167], a[136:139], v[140:143], v[164:167]
    ds_read_b64_tr_b16 a[134:135], v240 offset:13056
    v_mfma_f32_16x16x32_bf16 v[168:171], a[140:143], v[136:139], v[168:171]
    ds_read_b64_tr_b16 a[136:137], v241 offset:32
    v_mfma_f32_16x16x32_bf16 v[172:175], a[140:143], v[140:143], v[172:175]
    ds_read_b64_tr_b16 a[138:139], v241 offset:800
    s_waitcnt lgkmcnt(8)
    v_mfma_f32_16x16x32_bf16 v[176:179], v[136:139], a[144:147], v[176:179]
    ds_read_b64_tr_b16 a[140:141], v241 offset:12320
    v_mfma_f32_16x16x32_bf16 v[180:183], v[140:143], a[144:147], v[180:183]
    ds_read_b64_tr_b16 a[142:143], v241 offset:13088
    v_mfma_f32_16x16x32_bf16 v[184:187], v[136:139], a[148:151], v[184:187]
    ds_read_b64_tr_b16 a[144:145], v240 offset:64
    v_mfma_f32_16x16x32_bf16 v[188:191], v[140:143], a[148:151], v[188:191]
    ds_read_b64_tr_b16 a[146:147], v240 offset:832
    v_mul_f32 v208, 0x3f19be61, v248
    v_mul_f32 v210, 0x3f19be61, v249
    s_lshl2_add_u32 s62, s53, s52
    s_lshl4_add_u32 s62, s62, s54
    s_mul_i32 s62, s62, 6144
    s_add_u32 s62, s62, 0
    s_add_u32 s63, s62, 4096
    s_cmp_lt_u32 s54, 6
    s_cselect_b32 s3, 1, 0
    v_bitop3_b32 v212, s3, v1, v1 bitop3:0x3f
    v_pk_mul_f32 v[144:145], v[144:145], v[208:209] op_sel_hi:[1,0]
    v_pk_mul_f32 v[146:147], v[146:147], v[208:209] op_sel_hi:[1,0]
    v_pk_mul_f32 v[148:149], v[148:149], v[210:211] op_sel_hi:[1,0]
    v_pk_mul_f32 v[150:151], v[150:151], v[210:211] op_sel_hi:[1,0]
    v_pk_mul_f32 v[152:153], v[152:153], v[208:209] op_sel_hi:[1,0]
    v_pk_mul_f32 v[154:155], v[154:155], v[208:209] op_sel_hi:[1,0]
    v_pk_mul_f32 v[156:157], v[156:157], v[210:211] op_sel_hi:[1,0]
    v_pk_mul_f32 v[158:159], v[158:159], v[210:211] op_sel_hi:[1,0]
    v_cvt_pk_bf16_f32 v144, v144, v145
    v_cvt_pk_bf16_f32 v145, v146, v147
    v_cvt_pk_bf16_f32 v146, v148, v149
    v_cvt_pk_bf16_f32 v147, v150, v151
    v_cvt_pk_bf16_f32 v152, v152, v153
    v_cvt_pk_bf16_f32 v153, v154, v155
    v_cvt_pk_bf16_f32 v154, v156, v157
    v_cvt_pk_bf16_f32 v155, v158, v159
    v_permlane16_swap_b32 v144, v146
    v_permlane16_swap_b32 v145, v147
    v_and_b32 v144, v212, v144
    buffer_store_dwordx4 v[144:147], v14, s[40:43], s62 offen offset:0 sc1
    v_permlane16_swap_b32 v152, v154
    v_permlane16_swap_b32 v153, v155
    v_and_b32 v152, v212, v152
    buffer_store_dwordx4 v[152:155], v14, s[40:43], s62 offen offset:1024 sc1
    s_cmp_lt_u32 s54, 5
    s_cselect_b32 s3, 1, 0
    v_bitop3_b32 v212, s3, v1, v1 bitop3:0x3f
    v_pk_mul_f32 v[160:161], v[160:161], v[208:209] op_sel_hi:[1,0]
    v_pk_mul_f32 v[162:163], v[162:163], v[208:209] op_sel_hi:[1,0]
    v_pk_mul_f32 v[164:165], v[164:165], v[210:211] op_sel_hi:[1,0]
    v_pk_mul_f32 v[166:167], v[166:167], v[210:211] op_sel_hi:[1,0]
    v_pk_mul_f32 v[168:169], v[168:169], v[208:209] op_sel_hi:[1,0]
    v_pk_mul_f32 v[170:171], v[170:171], v[208:209] op_sel_hi:[1,0]
    v_pk_mul_f32 v[172:173], v[172:173], v[210:211] op_sel_hi:[1,0]
    v_pk_mul_f32 v[174:175], v[174:175], v[210:211] op_sel_hi:[1,0]
    v_cvt_pk_bf16_f32 v160, v160, v161
    v_cvt_pk_bf16_f32 v161, v162, v163
    v_cvt_pk_bf16_f32 v162, v164, v165
    v_cvt_pk_bf16_f32 v163, v166, v167
    v_cvt_pk_bf16_f32 v168, v168, v169
    v_cvt_pk_bf16_f32 v169, v170, v171
    v_cvt_pk_bf16_f32 v170, v172, v173
    v_cvt_pk_bf16_f32 v171, v174, v175
    v_permlane16_swap_b32 v160, v162
    v_permlane16_swap_b32 v161, v163
    v_and_b32 v160, v212, v160
    buffer_store_dwordx4 v[160:163], v14, s[40:43], s62 offen offset:2048 sc1
    v_permlane16_swap_b32 v168, v170
    v_permlane16_swap_b32 v169, v171
    v_and_b32 v168, v212, v168
    buffer_store_dwordx4 v[168:171], v14, s[40:43], s62 offen offset:3072 sc1
    v_pk_mul_f32 v[176:177], v[176:177], v[192:193]
    s_waitcnt lgkmcnt(11)
    v_pk_mul_f32 v[178:179], v[178:179], v[194:195]
    v_pk_mul_f32 v[180:181], v[180:181], v[196:197]
    s_waitcnt lgkmcnt(8)
    v_pk_mul_f32 v[182:183], v[182:183], v[198:199]
    v_pk_mul_f32 v[184:185], v[184:185], v[192:193]
    v_pk_mul_f32 v[186:187], v[186:187], v[194:195]
    v_pk_mul_f32 v[188:189], v[188:189], v[196:197]
    v_pk_mul_f32 v[190:191], v[190:191], v[198:199]
    v_cvt_pk_bf16_f32 v176, v176, v177
    v_cvt_pk_bf16_f32 v177, v178, v179
    v_cvt_pk_bf16_f32 v178, v180, v181
    v_cvt_pk_bf16_f32 v179, v182, v183
    v_cvt_pk_bf16_f32 v184, v184, v185
    v_cvt_pk_bf16_f32 v185, v186, v187
    v_cvt_pk_bf16_f32 v186, v188, v189
    v_cvt_pk_bf16_f32 v187, v190, v191
    v_permlane32_swap_b32 v176, v178
    v_permlane32_swap_b32 v177, v179
    buffer_store_dwordx4 v[176:179], v14, s[40:43], s63 offen offset:0 sc1
    v_permlane32_swap_b32 v184, v186
    v_permlane32_swap_b32 v185, v187
    buffer_store_dwordx4 v[184:187], v14, s[40:43], s63 offen offset:1024 sc1
    s_branch Lgu_5
Lnv6_4:
    s_waitcnt lgkmcnt(6)
    v_mfma_f32_16x16x32_bf16 v[144:147], v[16:19], a[128:131], 0
    ds_read_b64_tr_b16 a[148:149], v243 offset:160
    v_mfma_f32_16x16x32_bf16 v[148:151], v[20:23], a[128:131], 0
    ds_read_b64_tr_b16 a[150:151], v243 offset:928
    s_add_u32 m0, s59, 114688
    v_mfma_f32_16x16x32_bf16 v[152:155], v[16:19], a[132:135], 0
    ds_read_b64_tr_b16 a[128:129], v242 offset:6144
    v_mfma_f32_16x16x32_bf16 v[156:159], v[20:23], a[132:135], 0
    ds_read_b64_tr_b16 a[130:131], v242 offset:6912
    buffer_load_dwordx4 v11, s[36:39], s62 offen offset:0 lds
    s_waitcnt lgkmcnt(6)
    v_mfma_f32_16x16x32_bf16 v[160:163], v[16:19], a[136:139], 0
    ds_read_b64_tr_b16 a[132:133], v243 offset:6176
    v_mfma_f32_16x16x32_bf16 v[164:167], v[20:23], a[136:139], 0
    ds_read_b64_tr_b16 a[134:135], v243 offset:6944
    buffer_load_dwordx4 v12, s[36:39], s62 offen offset:1024 lds
    v_mfma_f32_16x16x32_bf16 v[168:171], v[16:19], a[140:143], 0
    ds_read_b64_tr_b16 a[136:137], v242 offset:6208
    v_mfma_f32_16x16x32_bf16 v[172:175], v[20:23], a[140:143], 0
    ds_read_b64_tr_b16 a[138:139], v242 offset:6976
    buffer_load_dwordx4 v13, s[36:39], s62 offen offset:2048 lds
    s_waitcnt lgkmcnt(6)
    v_mfma_f32_16x16x32_bf16 v[176:179], v[16:19], a[144:147], 0
    ds_read_b64_tr_b16 a[140:141], v243 offset:6240
    v_mfma_f32_16x16x32_bf16 v[180:183], v[20:23], a[144:147], 0
    ds_read_b64_tr_b16 a[142:143], v243 offset:7008
    s_add_u32 m0, s59, 126976
    v_mfma_f32_16x16x32_bf16 v[184:187], v[16:19], a[148:151], 0
    ds_read_b64_tr_b16 a[144:145], v242 offset:6272
    v_mfma_f32_16x16x32_bf16 v[188:191], v[20:23], a[148:151], 0
    ds_read_b64_tr_b16 a[146:147], v242 offset:7040
    buffer_load_dwordx4 v11, s[36:39], s63 offen offset:0 lds
    s_waitcnt lgkmcnt(6)
    v_mfma_f32_16x16x32_bf16 v[144:147], v[24:27], a[128:131], v[144:147]
    ds_read_b64_tr_b16 a[148:149], v243 offset:6304
    v_mfma_f32_16x16x32_bf16 v[148:151], v[28:31], a[128:131], v[148:151]
    ds_read_b64_tr_b16 a[150:151], v243 offset:7072
    buffer_load_dwordx4 v12, s[36:39], s63 offen offset:1024 lds
    v_mfma_f32_16x16x32_bf16 v[152:155], v[24:27], a[132:135], v[152:155]
    ds_read_b64_tr_b16 a[128:129], v242 offset:12288
    v_mfma_f32_16x16x32_bf16 v[156:159], v[28:31], a[132:135], v[156:159]
    ds_read_b64_tr_b16 a[130:131], v242 offset:13056
    buffer_load_dwordx4 v13, s[36:39], s63 offen offset:2048 lds
    s_waitcnt lgkmcnt(6)
    v_mfma_f32_16x16x32_bf16 v[160:163], v[24:27], a[136:139], v[160:163]
    ds_read_b64_tr_b16 a[132:133], v243 offset:12320
    v_mfma_f32_16x16x32_bf16 v[164:167], v[28:31], a[136:139], v[164:167]
    ds_read_b64_tr_b16 a[134:135], v243 offset:13088
    s_add_u32 m0, s59, 139264
    v_mfma_f32_16x16x32_bf16 v[168:171], v[24:27], a[140:143], v[168:171]
    ds_read_b64_tr_b16 a[136:137], v242 offset:12352
    v_mfma_f32_16x16x32_bf16 v[172:175], v[28:31], a[140:143], v[172:175]
    ds_read_b64_tr_b16 a[138:139], v242 offset:13120
    buffer_load_dwordx4 v11, s[36:39], s65 offen offset:0 lds
    s_waitcnt lgkmcnt(6)
    v_mfma_f32_16x16x32_bf16 v[176:179], v[24:27], a[144:147], v[176:179]
    ds_read_b64_tr_b16 a[140:141], v243 offset:12384
    v_mfma_f32_16x16x32_bf16 v[180:183], v[28:31], a[144:147], v[180:183]
    ds_read_b64_tr_b16 a[142:143], v243 offset:13152
    buffer_load_dwordx4 v12, s[36:39], s65 offen offset:1024 lds
    v_mfma_f32_16x16x32_bf16 v[184:187], v[24:27], a[148:151], v[184:187]
    ds_read_b64_tr_b16 a[144:145], v242 offset:12416
    v_mfma_f32_16x16x32_bf16 v[188:191], v[28:31], a[148:151], v[188:191]
    ds_read_b64_tr_b16 a[146:147], v242 offset:13184
    buffer_load_dwordx4 v13, s[36:39], s65 offen offset:2048 lds
    s_waitcnt lgkmcnt(6)
    v_mfma_f32_16x16x32_bf16 v[144:147], v[32:35], a[128:131], v[144:147]
    ds_read_b64_tr_b16 a[148:149], v243 offset:12448
    v_mfma_f32_16x16x32_bf16 v[148:151], v[36:39], a[128:131], v[148:151]
    ds_read_b64_tr_b16 a[150:151], v243 offset:13216
    s_add_u32 m0, s59, 151552
    v_mfma_f32_16x16x32_bf16 v[152:155], v[32:35], a[132:135], v[152:155]
    ds_read_b64_tr_b16 a[128:129], v242 offset:18432
    v_mfma_f32_16x16x32_bf16 v[156:159], v[36:39], a[132:135], v[156:159]
    ds_read_b64_tr_b16 a[130:131], v242 offset:19200
    buffer_load_dwordx4 v11, s[36:39], s61 offen offset:0 lds
    s_waitcnt lgkmcnt(6)
    v_mfma_f32_16x16x32_bf16 v[160:163], v[32:35], a[136:139], v[160:163]
    ds_read_b64_tr_b16 a[132:133], v243 offset:18464
    v_mfma_f32_16x16x32_bf16 v[164:167], v[36:39], a[136:139], v[164:167]
    ds_read_b64_tr_b16 a[134:135], v243 offset:19232
    buffer_load_dwordx4 v12, s[36:39], s61 offen offset:1024 lds
    v_mfma_f32_16x16x32_bf16 v[168:171], v[32:35], a[140:143], v[168:171]
    ds_read_b64_tr_b16 a[136:137], v242 offset:18496
    v_mfma_f32_16x16x32_bf16 v[172:175], v[36:39], a[140:143], v[172:175]
    ds_read_b64_tr_b16 a[138:139], v242 offset:19264
    buffer_load_dwordx4 v13, s[36:39], s61 offen offset:2048 lds
    s_waitcnt lgkmcnt(6)
    v_mfma_f32_16x16x32_bf16 v[176:179], v[32:35], a[144:147], v[176:179]
    ds_read_b64_tr_b16 a[140:141], v243 offset:18528
    v_mfma_f32_16x16x32_bf16 v[180:183], v[36:39], a[144:147], v[180:183]
    ds_read_b64_tr_b16 a[142:143], v243 offset:19296
    s_add_u32 m0, s59, 0
    v_mfma_f32_16x16x32_bf16 v[184:187], v[32:35], a[148:151], v[184:187]
    ds_read_b64_tr_b16 a[144:145], v242 offset:18560
    v_mfma_f32_16x16x32_bf16 v[188:191], v[36:39], a[148:151], v[188:191]
    ds_read_b64_tr_b16 a[146:147], v242 offset:19328
    buffer_load_dwordx4 v8, s[28:31], s4 offen offset:0 lds
    s_waitcnt lgkmcnt(6)
    v_mfma_f32_16x16x32_bf16 v[144:147], v[40:43], a[128:131], v[144:147]
    ds_read_b64_tr_b16 a[148:149], v243 offset:18592
    v_mfma_f32_16x16x32_bf16 v[148:151], v[44:47], a[128:131], v[148:151]
    ds_read_b64_tr_b16 a[150:151], v243 offset:19360
    v_mfma_f32_16x16x32_bf16 v[152:155], v[40:43], a[132:135], v[152:155]
    s_waitcnt vmcnt(13)
    s_barrier
    ds_read_b64_tr_b16 a[128:129], v242 offset:24576
    v_mfma_f32_16x16x32_bf16 v[156:159], v[44:47], a[132:135], v[156:159]
    ds_read_b64_tr_b16 a[130:131], v242 offset:25344
    buffer_load_dwordx4 v9, s[28:31], s4 offen offset:1024 lds
    s_waitcnt lgkmcnt(6)
    v_mfma_f32_16x16x32_bf16 v[160:163], v[40:43], a[136:139], v[160:163]
    ds_read_b64_tr_b16 a[132:133], v243 offset:24608
    v_mfma_f32_16x16x32_bf16 v[164:167], v[44:47], a[136:139], v[164:167]
    ds_read_b64_tr_b16 a[134:135], v243 offset:25376
    v_mfma_f32_16x16x32_bf16 v[168:171], v[40:43], a[140:143], v[168:171]
    ds_read_b64_tr_b16 a[136:137], v242 offset:24640
    v_mfma_f32_16x16x32_bf16 v[172:175], v[44:47], a[140:143], v[172:175]
    ds_read_b64_tr_b16 a[138:139], v242 offset:25408
    buffer_load_dwordx4 v10, s[28:31], s4 offen offset:2048 lds
    s_waitcnt lgkmcnt(6)
    v_mfma_f32_16x16x32_bf16 v[176:179], v[40:43], a[144:147], v[176:179]
    ds_read_b64_tr_b16 a[140:141], v243 offset:24672
    v_mfma_f32_16x16x32_bf16 v[180:183], v[44:47], a[144:147], v[180:183]
    ds_read_b64_tr_b16 a[142:143], v243 offset:25440
    v_mfma_f32_16x16x32_bf16 v[184:187], v[40:43], a[148:151], v[184:187]
    ds_read_b64_tr_b16 a[144:145], v242 offset:24704
    v_mfma_f32_16x16x32_bf16 v[188:191], v[44:47], a[148:151], v[188:191]
    ds_read_b64_tr_b16 a[146:147], v242 offset:25472
    s_add_u32 m0, s59, 12288
    s_waitcnt lgkmcnt(6)
    v_mfma_f32_16x16x32_bf16 v[144:147], v[48:51], a[128:131], v[144:147]
    ds_read_b64_tr_b16 a[148:149], v243 offset:24736
    v_mfma_f32_16x16x32_bf16 v[148:151], v[52:55], a[128:131], v[148:151]
    ds_read_b64_tr_b16 a[150:151], v243 offset:25504
    buffer_load_dwordx4 v8, s[32:35], s4 offen offset:0 lds
    v_mfma_f32_16x16x32_bf16 v[152:155], v[48:51], a[132:135], v[152:155]
    ds_read_b64_tr_b16 a[128:129], v242 offset:30720
    v_mfma_f32_16x16x32_bf16 v[156:159], v[52:55], a[132:135], v[156:159]
    ds_read_b64_tr_b16 a[130:131], v242 offset:31488
    s_waitcnt lgkmcnt(6)
    v_mfma_f32_16x16x32_bf16 v[160:163], v[48:51], a[136:139], v[160:163]
    ds_read_b64_tr_b16 a[132:133], v243 offset:30752
    v_mfma_f32_16x16x32_bf16 v[164:167], v[52:55], a[136:139], v[164:167]
    ds_read_b64_tr_b16 a[134:135], v243 offset:31520
    buffer_load_dwordx4 v9, s[32:35], s4 offen offset:1024 lds
    v_mfma_f32_16x16x32_bf16 v[168:171], v[48:51], a[140:143], v[168:171]
    ds_read_b64_tr_b16 a[136:137], v242 offset:30784
    v_mfma_f32_16x16x32_bf16 v[172:175], v[52:55], a[140:143], v[172:175]
    ds_read_b64_tr_b16 a[138:139], v242 offset:31552
    s_waitcnt lgkmcnt(6)
    v_mfma_f32_16x16x32_bf16 v[176:179], v[48:51], a[144:147], v[176:179]
    ds_read_b64_tr_b16 a[140:141], v243 offset:30816
    v_mfma_f32_16x16x32_bf16 v[180:183], v[52:55], a[144:147], v[180:183]
    ds_read_b64_tr_b16 a[142:143], v243 offset:31584
    buffer_load_dwordx4 v10, s[32:35], s4 offen offset:2048 lds
    v_mfma_f32_16x16x32_bf16 v[184:187], v[48:51], a[148:151], v[184:187]
    ds_read_b64_tr_b16 a[144:145], v242 offset:30848
    v_mfma_f32_16x16x32_bf16 v[188:191], v[52:55], a[148:151], v[188:191]
    ds_read_b64_tr_b16 a[146:147], v242 offset:31616
    s_waitcnt lgkmcnt(6)
    v_mfma_f32_16x16x32_bf16 v[144:147], v[56:59], a[128:131], v[144:147]
    ds_read_b64_tr_b16 a[148:149], v243 offset:30880
    v_mfma_f32_16x16x32_bf16 v[148:151], v[60:63], a[128:131], v[148:151]
    ds_read_b64_tr_b16 a[150:151], v243 offset:31648
    buffer_load_dwordx2 v[252:253], off, s[44:47], 0 sc1
    v_mfma_f32_16x16x32_bf16 v[152:155], v[56:59], a[132:135], v[152:155]
    ds_read_b64_tr_b16 a[128:129], v242 offset:36864
    v_mfma_f32_16x16x32_bf16 v[156:159], v[60:63], a[132:135], v[156:159]
    ds_read_b64_tr_b16 a[130:131], v242 offset:37632
    s_waitcnt lgkmcnt(6)
    v_mfma_f32_16x16x32_bf16 v[160:163], v[56:59], a[136:139], v[160:163]
    ds_read_b64_tr_b16 a[132:133], v243 offset:36896
    v_mfma_f32_16x16x32_bf16 v[164:167], v[60:63], a[136:139], v[164:167]
    ds_read_b64_tr_b16 a[134:135], v243 offset:37664
    v_mfma_f32_16x16x32_bf16 v[168:171], v[56:59], a[140:143], v[168:171]
    ds_read_b64_tr_b16 a[136:137], v242 offset:36928
    v_mfma_f32_16x16x32_bf16 v[172:175], v[60:63], a[140:143], v[172:175]
    ds_read_b64_tr_b16 a[138:139], v242 offset:37696
    s_waitcnt lgkmcnt(6)
    v_mfma_f32_16x16x32_bf16 v[176:179], v[56:59], a[144:147], v[176:179]
    ds_read_b64_tr_b16 a[140:141], v243 offset:36960
    v_mfma_f32_16x16x32_bf16 v[180:183], v[60:63], a[144:147], v[180:183]
    ds_read_b64_tr_b16 a[142:143], v243 offset:37728
    v_mfma_f32_16x16x32_bf16 v[184:187], v[56:59], a[148:151], v[184:187]
    ds_read_b64_tr_b16 a[144:145], v242 offset:36992
    v_mfma_f32_16x16x32_bf16 v[188:191], v[60:63], a[148:151], v[188:191]
    ds_read_b64_tr_b16 a[146:147], v242 offset:37760
    s_waitcnt lgkmcnt(6)
    v_mfma_f32_16x16x32_bf16 v[144:147], v[64:67], a[128:131], v[144:147]
    ds_read_b64_tr_b16 a[148:149], v243 offset:37024
    v_mfma_f32_16x16x32_bf16 v[148:151], v[68:71], a[128:131], v[148:151]
    ds_read_b64_tr_b16 a[150:151], v243 offset:37792
    v_mfma_f32_16x16x32_bf16 v[152:155], v[64:67], a[132:135], v[152:155]
    ds_read_b64_tr_b16 a[128:129], v242 offset:43008
    v_mfma_f32_16x16x32_bf16 v[156:159], v[68:71], a[132:135], v[156:159]
    ds_read_b64_tr_b16 a[130:131], v242 offset:43776
    s_waitcnt lgkmcnt(6)
    v_mfma_f32_16x16x32_bf16 v[160:163], v[64:67], a[136:139], v[160:163]
    ds_read_b64_tr_b16 a[132:133], v243 offset:43040
    v_mfma_f32_16x16x32_bf16 v[164:167], v[68:71], a[136:139], v[164:167]
    ds_read_b64_tr_b16 a[134:135], v243 offset:43808
    v_mfma_f32_16x16x32_bf16 v[168:171], v[64:67], a[140:143], v[168:171]
    ds_read_b64_tr_b16 a[136:137], v242 offset:43072
    v_mfma_f32_16x16x32_bf16 v[172:175], v[68:71], a[140:143], v[172:175]
    ds_read_b64_tr_b16 a[138:139], v242 offset:43840
    s_waitcnt lgkmcnt(6)
    v_mfma_f32_16x16x32_bf16 v[176:179], v[64:67], a[144:147], v[176:179]
    ds_read_b64_tr_b16 a[140:141], v243 offset:43104
    v_mfma_f32_16x16x32_bf16 v[180:183], v[68:71], a[144:147], v[180:183]
    ds_read_b64_tr_b16 a[142:143], v243 offset:43872
    v_mfma_f32_16x16x32_bf16 v[184:187], v[64:67], a[148:151], v[184:187]
    ds_read_b64_tr_b16 a[144:145], v242 offset:43136
    v_mfma_f32_16x16x32_bf16 v[188:191], v[68:71], a[148:151], v[188:191]
    ds_read_b64_tr_b16 a[146:147], v242 offset:43904
    s_waitcnt lgkmcnt(6)
    v_mfma_f32_16x16x32_bf16 v[144:147], v[72:75], a[128:131], v[144:147]
    ds_read_b64_tr_b16 a[148:149], v243 offset:43168
    v_mfma_f32_16x16x32_bf16 v[148:151], v[76:79], a[128:131], v[148:151]
    ds_read_b64_tr_b16 a[150:151], v243 offset:43936
    v_mfma_f32_16x16x32_bf16 v[152:155], v[72:75], a[132:135], v[152:155]
    s_waitcnt vmcnt(13)
    s_barrier
    ds_read_b64_tr_b16 a[128:129], v242 offset:49152
    v_mfma_f32_16x16x32_bf16 v[156:159], v[76:79], a[132:135], v[156:159]
    ds_read_b64_tr_b16 a[130:131], v242 offset:49920
    s_waitcnt lgkmcnt(6)
    v_mfma_f32_16x16x32_bf16 v[160:163], v[72:75], a[136:139], v[160:163]
    ds_read_b64_tr_b16 a[132:133], v243 offset:49184
    v_mfma_f32_16x16x32_bf16 v[164:167], v[76:79], a[136:139], v[164:167]
    ds_read_b64_tr_b16 a[134:135], v243 offset:49952
    s_mov_b32 s36, s16
    v_mfma_f32_16x16x32_bf16 v[168:171], v[72:75], a[140:143], v[168:171]
    ds_read_b64_tr_b16 a[136:137], v242 offset:49216
    v_mfma_f32_16x16x32_bf16 v[172:175], v[76:79], a[140:143], v[172:175]
    ds_read_b64_tr_b16 a[138:139], v242 offset:49984
    s_mov_b32 s37, s17
    s_waitcnt lgkmcnt(6)
    v_mfma_f32_16x16x32_bf16 v[176:179], v[72:75], a[144:147], v[176:179]
    ds_read_b64_tr_b16 a[140:141], v243 offset:49248
    v_mfma_f32_16x16x32_bf16 v[180:183], v[76:79], a[144:147], v[180:183]
    ds_read_b64_tr_b16 a[142:143], v243 offset:50016
    s_mov_b32 s38, 1409024
    v_mfma_f32_16x16x32_bf16 v[184:187], v[72:75], a[148:151], v[184:187]
    ds_read_b64_tr_b16 a[144:145], v242 offset:49280
    v_mfma_f32_16x16x32_bf16 v[188:191], v[76:79], a[148:151], v[188:191]
    ds_read_b64_tr_b16 a[146:147], v242 offset:50048
    s_mov_b32 s39, 0x20000
    s_waitcnt lgkmcnt(6)
    v_mfma_f32_16x16x32_bf16 v[144:147], v[80:83], a[128:131], v[144:147]
    ds_read_b64_tr_b16 a[148:149], v243 offset:49312
    v_mfma_f32_16x16x32_bf16 v[148:151], v[84:87], a[128:131], v[148:151]
    ds_read_b64_tr_b16 a[150:151], v243 offset:50080
    s_lshl2_add_u32 s67, s49, s52
    v_mfma_f32_16x16x32_bf16 v[152:155], v[80:83], a[132:135], v[152:155]
    ds_read_b64_tr_b16 a[128:129], v242 offset:55296
    v_mfma_f32_16x16x32_bf16 v[156:159], v[84:87], a[132:135], v[156:159]
    ds_read_b64_tr_b16 a[130:131], v242 offset:56064
    v_min_u32 v254, 42, v1
    s_waitcnt lgkmcnt(6)
    v_mfma_f32_16x16x32_bf16 v[160:163], v[80:83], a[136:139], v[160:163]
    ds_read_b64_tr_b16 a[132:133], v243 offset:55328
    v_mfma_f32_16x16x32_bf16 v[164:167], v[84:87], a[136:139], v[164:167]
    ds_read_b64_tr_b16 a[134:135], v243 offset:56096
    v_mov_b32 v15, 43
    v_mfma_f32_16x16x32_bf16 v[168:171], v[80:83], a[140:143], v[168:171]
    ds_read_b64_tr_b16 a[136:137], v242 offset:55360
    v_mfma_f32_16x16x32_bf16 v[172:175], v[84:87], a[140:143], v[172:175]
    ds_read_b64_tr_b16 a[138:139], v242 offset:56128
    v_mad_u32_u24 v254, v15, s67, v254
    s_waitcnt lgkmcnt(6)
    v_mfma_f32_16x16x32_bf16 v[176:179], v[80:83], a[144:147], v[176:179]
    ds_read_b64_tr_b16 a[140:141], v243 offset:55392
    v_mfma_f32_16x16x32_bf16 v[180:183], v[84:87], a[144:147], v[180:183]
    ds_read_b64_tr_b16 a[142:143], v243 offset:56160
    v_and_b32 v15, 3, v254
    v_mfma_f32_16x16x32_bf16 v[184:187], v[80:83], a[148:151], v[184:187]
    ds_read_b64_tr_b16 a[144:145], v242 offset:55424
    v_mfma_f32_16x16x32_bf16 v[188:191], v[84:87], a[148:151], v[188:191]
    ds_read_b64_tr_b16 a[146:147], v242 offset:56192
    v_lshrrev_b32 v254, 2, v254
    s_waitcnt lgkmcnt(6)
    v_mfma_f32_16x16x32_bf16 v[144:147], v[88:91], a[128:131], v[144:147]
    ds_read_b64_tr_b16 a[148:149], v243 offset:55456
    v_mfma_f32_16x16x32_bf16 v[148:151], v[92:95], a[128:131], v[148:151]
    ds_read_b64_tr_b16 a[150:151], v243 offset:56224
    v_lshlrev_b32 v15, 7, v15
    v_mfma_f32_16x16x32_bf16 v[152:155], v[88:91], a[132:135], v[152:155]
    ds_read_b64_tr_b16 a[128:129], v244 offset:0
    v_mfma_f32_16x16x32_bf16 v[156:159], v[92:95], a[132:135], v[156:159]
    ds_read_b64_tr_b16 a[130:131], v244 offset:768
    v_lshl_add_u32 v15, v254, 10, v15
    s_waitcnt lgkmcnt(6)
    v_mfma_f32_16x16x32_bf16 v[160:163], v[88:91], a[136:139], v[160:163]
    ds_read_b64_tr_b16 a[132:133], v245 offset:32
    v_mfma_f32_16x16x32_bf16 v[164:167], v[92:95], a[136:139], v[164:167]
    ds_read_b64_tr_b16 a[134:135], v245 offset:800
    s_add_u32 m0, s59, 24576
    s_and_b32 s64, s2, 1
    v_mfma_f32_16x16x32_bf16 v[168:171], v[88:91], a[140:143], v[168:171]
    ds_read_b64_tr_b16 a[136:137], v244 offset:64
    v_mfma_f32_16x16x32_bf16 v[172:175], v[92:95], a[140:143], v[172:175]
    ds_read_b64_tr_b16 a[138:139], v244 offset:832
    buffer_load_dwordx4 v8, s[28:31], s5 offen offset:0 lds
    s_lshl_b32 s64, s64, 9
    s_waitcnt lgkmcnt(6)
    v_mfma_f32_16x16x32_bf16 v[176:179], v[88:91], a[144:147], v[176:179]
    ds_read_b64_tr_b16 a[140:141], v245 offset:96
    v_mfma_f32_16x16x32_bf16 v[180:183], v[92:95], a[144:147], v[180:183]
    ds_read_b64_tr_b16 a[142:143], v245 offset:864
    v_add_f32 v216, v216, v217
    v_add_f32 v218, v218, v219
    v_mfma_f32_16x16x32_bf16 v[184:187], v[88:91], a[148:151], v[184:187]
    ds_read_b64_tr_b16 a[144:145], v244 offset:128
    v_mfma_f32_16x16x32_bf16 v[188:191], v[92:95], a[148:151], v[188:191]
    ds_read_b64_tr_b16 a[146:147], v244 offset:896
    buffer_load_dwordx4 v9, s[28:31], s5 offen offset:1024 lds
    v_mov_b32 v217, v216
    s_waitcnt lgkmcnt(6)
    v_mfma_f32_16x16x32_bf16 v[144:147], v[96:99], a[128:131], v[144:147]
    ds_read_b64_tr_b16 a[148:149], v245 offset:160
    v_mfma_f32_16x16x32_bf16 v[148:151], v[100:103], a[128:131], v[148:151]
    ds_read_b64_tr_b16 a[150:151], v245 offset:928
    v_mov_b32 v219, v218
    v_mfma_f32_16x16x32_bf16 v[152:155], v[96:99], a[132:135], v[152:155]
    ds_read_b64_tr_b16 a[128:129], v244 offset:6144
    v_mfma_f32_16x16x32_bf16 v[156:159], v[100:103], a[132:135], v[156:159]
    ds_read_b64_tr_b16 a[130:131], v244 offset:6912
    buffer_load_dwordx4 v10, s[28:31], s5 offen offset:2048 lds
    v_permlane16_swap_b32 v216, v217
    s_waitcnt lgkmcnt(6)
    v_mfma_f32_16x16x32_bf16 v[160:163], v[96:99], a[136:139], v[160:163]
    ds_read_b64_tr_b16 a[132:133], v245 offset:6176
    v_mfma_f32_16x16x32_bf16 v[164:167], v[100:103], a[136:139], v[164:167]
    ds_read_b64_tr_b16 a[134:135], v245 offset:6944
    v_permlane16_swap_b32 v218, v219
    v_mfma_f32_16x16x32_bf16 v[168:171], v[96:99], a[140:143], v[168:171]
    ds_read_b64_tr_b16 a[136:137], v244 offset:6208
    v_mfma_f32_16x16x32_bf16 v[172:175], v[100:103], a[140:143], v[172:175]
    ds_read_b64_tr_b16 a[138:139], v244 offset:6976
    s_add_u32 m0, s59, 36864
    v_add_f32 v216, v216, v217
    s_waitcnt lgkmcnt(6)
    v_mfma_f32_16x16x32_bf16 v[176:179], v[96:99], a[144:147], v[176:179]
    ds_read_b64_tr_b16 a[140:141], v245 offset:6240
    v_mfma_f32_16x16x32_bf16 v[180:183], v[100:103], a[144:147], v[180:183]
    ds_read_b64_tr_b16 a[142:143], v245 offset:7008
    buffer_load_dwordx4 v8, s[32:35], s5 offen offset:0 lds
    v_add_f32 v218, v218, v219
    v_mfma_f32_16x16x32_bf16 v[184:187], v[96:99], a[148:151], v[184:187]
    ds_read_b64_tr_b16 a[144:145], v244 offset:6272
    v_mfma_f32_16x16x32_bf16 v[188:191], v[100:103], a[148:151], v[188:191]
    ds_read_b64_tr_b16 a[146:147], v244 offset:7040
    v_mov_b32 v217, v216
    s_waitcnt lgkmcnt(6)
    v_mfma_f32_16x16x32_bf16 v[144:147], v[104:107], a[128:131], v[144:147]
    ds_read_b64_tr_b16 a[148:149], v245 offset:6304
    v_mfma_f32_16x16x32_bf16 v[148:151], v[108:111], a[128:131], v[148:151]
    ds_read_b64_tr_b16 a[150:151], v245 offset:7072
    buffer_load_dwordx4 v9, s[32:35], s5 offen offset:1024 lds
    v_mov_b32 v219, v218
    v_permlane32_swap_b32 v216, v217
    v_mfma_f32_16x16x32_bf16 v[152:155], v[104:107], a[132:135], v[152:155]
    s_waitcnt vmcnt(12)
    s_barrier
    ds_read_b64_tr_b16 a[128:129], v244 offset:12288
    v_mfma_f32_16x16x32_bf16 v[156:159], v[108:111], a[132:135], v[156:159]
    ds_read_b64_tr_b16 a[130:131], v244 offset:13056
    v_permlane32_swap_b32 v218, v219
    s_waitcnt lgkmcnt(6)
    v_mfma_f32_16x16x32_bf16 v[160:163], v[104:107], a[136:139], v[160:163]
    ds_read_b64_tr_b16 a[132:133], v245 offset:12320
    v_mfma_f32_16x16x32_bf16 v[164:167], v[108:111], a[136:139], v[164:167]
    ds_read_b64_tr_b16 a[134:135], v245 offset:13088
    buffer_load_dwordx4 v10, s[32:35], s5 offen offset:2048 lds
    v_add_f32 v216, v216, v217
    v_mfma_f32_16x16x32_bf16 v[168:171], v[104:107], a[140:143], v[168:171]
    ds_read_b64_tr_b16 a[136:137], v244 offset:12352
    v_mfma_f32_16x16x32_bf16 v[172:175], v[108:111], a[140:143], v[172:175]
    ds_read_b64_tr_b16 a[138:139], v244 offset:13120
    v_add_f32 v218, v218, v219
    s_waitcnt lgkmcnt(6)
    v_mfma_f32_16x16x32_bf16 v[176:179], v[104:107], a[144:147], v[176:179]
    ds_read_b64_tr_b16 a[140:141], v245 offset:12384
    v_mfma_f32_16x16x32_bf16 v[180:183], v[108:111], a[144:147], v[180:183]
    ds_read_b64_tr_b16 a[142:143], v245 offset:13152
    v_mul_f32 v216, 0x3b000000, v216
    v_mfma_f32_16x16x32_bf16 v[184:187], v[104:107], a[148:151], v[184:187]
    ds_read_b64_tr_b16 a[144:145], v244 offset:12416
    v_mfma_f32_16x16x32_bf16 v[188:191], v[108:111], a[148:151], v[188:191]
    ds_read_b64_tr_b16 a[146:147], v244 offset:13184
    v_fma_f32 v216, -v220, v220, v216
    s_waitcnt lgkmcnt(6)
    v_mfma_f32_16x16x32_bf16 v[144:147], v[112:115], a[128:131], v[144:147]
    ds_read_b64_tr_b16 a[148:149], v245 offset:12448
    v_mfma_f32_16x16x32_bf16 v[148:151], v[116:119], a[128:131], v[148:151]
    ds_read_b64_tr_b16 a[150:151], v245 offset:13216
    v_max_f32 v216, 0, v216
    v_mfma_f32_16x16x32_bf16 v[152:155], v[112:115], a[132:135], v[152:155]
    ds_read_b64_tr_b16 a[128:129], v244 offset:18432
    v_mfma_f32_16x16x32_bf16 v[156:159], v[116:119], a[132:135], v[156:159]
    ds_read_b64_tr_b16 a[130:131], v244 offset:19200
    v_add_f32 v216, 0x3727c5ac, v216
    s_waitcnt lgkmcnt(6)
    v_mfma_f32_16x16x32_bf16 v[160:163], v[112:115], a[136:139], v[160:163]
    ds_read_b64_tr_b16 a[132:133], v245 offset:18464
    v_mfma_f32_16x16x32_bf16 v[164:167], v[116:119], a[136:139], v[164:167]
    ds_read_b64_tr_b16 a[134:135], v245 offset:19232
    s_add_u32 m0, s59, 49152
    v_rsq_f32 v248, v216
    v_mfma_f32_16x16x32_bf16 v[168:171], v[112:115], a[140:143], v[168:171]
    ds_read_b64_tr_b16 a[136:137], v244 offset:18496
    v_mfma_f32_16x16x32_bf16 v[172:175], v[116:119], a[140:143], v[172:175]
    ds_read_b64_tr_b16 a[138:139], v244 offset:19264
    buffer_load_dwordx4 v8, s[28:31], s6 offen offset:0 lds
    v_mul_f32 v218, 0x3b000000, v218
    v_fma_f32 v218, -v224, v224, v218
    s_waitcnt lgkmcnt(6)
    v_mfma_f32_16x16x32_bf16 v[176:179], v[112:115], a[144:147], v[176:179]
    ds_read_b64_tr_b16 a[140:141], v245 offset:18528
    v_mfma_f32_16x16x32_bf16 v[180:183], v[116:119], a[144:147], v[180:183]
    ds_read_b64_tr_b16 a[142:143], v245 offset:19296
    v_max_f32 v218, 0, v218
    v_mfma_f32_16x16x32_bf16 v[184:187], v[112:115], a[148:151], v[184:187]
    ds_read_b64_tr_b16 a[144:145], v244 offset:18560
    v_mfma_f32_16x16x32_bf16 v[188:191], v[116:119], a[148:151], v[188:191]
    ds_read_b64_tr_b16 a[146:147], v244 offset:19328
    buffer_load_dwordx4 v9, s[28:31], s6 offen offset:1024 lds
    v_add_f32 v218, 0x3727c5ac, v218
    s_waitcnt lgkmcnt(6)
    v_mfma_f32_16x16x32_bf16 v[144:147], v[120:123], a[128:131], v[144:147]
    ds_read_b64_tr_b16 a[148:149], v245 offset:18592
    v_mfma_f32_16x16x32_bf16 v[148:151], v[124:127], a[128:131], v[148:151]
    ds_read_b64_tr_b16 a[150:151], v245 offset:19360
    v_rsq_f32 v249, v218
    v_mfma_f32_16x16x32_bf16 v[152:155], v[120:123], a[132:135], v[152:155]
    ds_read_b64_tr_b16 a[128:129], v244 offset:24576
    v_mfma_f32_16x16x32_bf16 v[156:159], v[124:127], a[132:135], v[156:159]
    ds_read_b64_tr_b16 a[130:131], v244 offset:25344
    buffer_load_dwordx4 v10, s[28:31], s6 offen offset:2048 lds
    v_lshrrev_b32 v250, 4, v1
    s_waitcnt lgkmcnt(6)
    v_mfma_f32_16x16x32_bf16 v[160:163], v[120:123], a[136:139], v[160:163]
    ds_read_b64_tr_b16 a[132:133], v245 offset:24608
    v_mfma_f32_16x16x32_bf16 v[164:167], v[124:127], a[136:139], v[164:167]
    ds_read_b64_tr_b16 a[134:135], v245 offset:25376
    v_lshlrev_b32 v250, 4, v250
    v_mfma_f32_16x16x32_bf16 v[168:171], v[120:123], a[140:143], v[168:171]
    ds_read_b64_tr_b16 a[136:137], v244 offset:24640
    v_mfma_f32_16x16x32_bf16 v[172:175], v[124:127], a[140:143], v[172:175]
    ds_read_b64_tr_b16 a[138:139], v244 offset:25408
    s_add_u32 m0, s59, 65536
    v_add_u32 v251, 0, v250
    s_waitcnt lgkmcnt(6)
    v_mfma_f32_16x16x32_bf16 v[176:179], v[120:123], a[144:147], v[176:179]
    ds_read_b64_tr_b16 a[140:141], v245 offset:24672
    v_mfma_f32_16x16x32_bf16 v[180:183], v[124:127], a[144:147], v[180:183]
    ds_read_b64_tr_b16 a[142:143], v245 offset:25440
    buffer_load_dwordx4 v8, s[32:35], s6 offen offset:0 lds
    ds_bpermute_b32 v192, v251, v248
    v_mfma_f32_16x16x32_bf16 v[184:187], v[120:123], a[148:151], v[184:187]
    ds_read_b64_tr_b16 a[144:145], v244 offset:24704
    v_mfma_f32_16x16x32_bf16 v[188:191], v[124:127], a[148:151], v[188:191]
    ds_read_b64_tr_b16 a[146:147], v244 offset:25472
    ds_bpermute_b32 v196, v251, v249
    v_add_u32 v251, 4, v250
    s_waitcnt lgkmcnt(8)
    v_mfma_f32_16x16x32_bf16 v[144:147], v[128:131], a[128:131], v[144:147]
    ds_read_b64_tr_b16 a[148:149], v245 offset:24736
    v_mfma_f32_16x16x32_bf16 v[148:151], v[132:135], a[128:131], v[148:151]
    ds_read_b64_tr_b16 a[150:151], v245 offset:25504
    buffer_load_dwordx4 v9, s[32:35], s6 offen offset:1024 lds
    ds_bpermute_b32 v193, v251, v248
    v_mfma_f32_16x16x32_bf16 v[152:155], v[128:131], a[132:135], v[152:155]
    ds_read_b64_tr_b16 a[128:129], v244 offset:30720
    v_mfma_f32_16x16x32_bf16 v[156:159], v[132:135], a[132:135], v[156:159]
    ds_read_b64_tr_b16 a[130:131], v244 offset:31488
    ds_bpermute_b32 v197, v251, v249
    s_waitcnt lgkmcnt(10)
    v_mfma_f32_16x16x32_bf16 v[160:163], v[128:131], a[136:139], v[160:163]
    ds_read_b64_tr_b16 a[132:133], v245 offset:30752
    v_mfma_f32_16x16x32_bf16 v[164:167], v[132:135], a[136:139], v[164:167]
    ds_read_b64_tr_b16 a[134:135], v245 offset:31520
    buffer_load_dwordx4 v10, s[32:35], s6 offen offset:2048 lds
    v_add_u32 v251, 8, v250
    v_mfma_f32_16x16x32_bf16 v[168:171], v[128:131], a[140:143], v[168:171]
    ds_read_b64_tr_b16 a[136:137], v244 offset:30784
    v_mfma_f32_16x16x32_bf16 v[172:175], v[132:135], a[140:143], v[172:175]
    ds_read_b64_tr_b16 a[138:139], v244 offset:31552
    ds_bpermute_b32 v194, v251, v248
    s_waitcnt lgkmcnt(9)
    v_mfma_f32_16x16x32_bf16 v[176:179], v[128:131], a[144:147], v[176:179]
    ds_read_b64_tr_b16 a[140:141], v245 offset:30816
    v_mfma_f32_16x16x32_bf16 v[180:183], v[132:135], a[144:147], v[180:183]
    ds_read_b64_tr_b16 a[142:143], v245 offset:31584
    ds_bpermute_b32 v198, v251, v249
    v_mfma_f32_16x16x32_bf16 v[184:187], v[128:131], a[148:151], v[184:187]
    ds_read_b64_tr_b16 a[144:145], v244 offset:30848
    v_mfma_f32_16x16x32_bf16 v[188:191], v[132:135], a[148:151], v[188:191]
    ds_read_b64_tr_b16 a[146:147], v244 offset:31616
    v_add_u32 v251, 12, v250
    s_waitcnt lgkmcnt(8)
    v_mfma_f32_16x16x32_bf16 v[144:147], v[136:139], a[128:131], v[144:147]
    ds_read_b64_tr_b16 a[148:149], v245 offset:30880
    v_mfma_f32_16x16x32_bf16 v[148:151], v[140:143], a[128:131], v[148:151]
    ds_read_b64_tr_b16 a[150:151], v245 offset:31648
    ds_bpermute_b32 v195, v251, v248
    v_mfma_f32_16x16x32_bf16 v[152:155], v[136:139], a[132:135], v[152:155]
    s_waitcnt vmcnt(13)
    s_barrier
    ds_read_b64_tr_b16 a[128:129], v240 offset:0
    v_mfma_f32_16x16x32_bf16 v[156:159], v[140:143], a[132:135], v[156:159]
    ds_read_b64_tr_b16 a[130:131], v240 offset:768
    ds_bpermute_b32 v199, v251, v249
    s_waitcnt lgkmcnt(9)
    v_mfma_f32_16x16x32_bf16 v[160:163], v[136:139], a[136:139], v[160:163]
    ds_read_b64_tr_b16 a[132:133], v240 offset:12288
    v_mfma_f32_16x16x32_bf16 v[164:167], v[140:143], a[136:139], v[164:167]
    ds_read_b64_tr_b16 a[134:135], v240 offset:13056
    v_mfma_f32_16x16x32_bf16 v[168:171], v[136:139], a[140:143], v[168:171]
    ds_read_b64_tr_b16 a[136:137], v241 offset:32
    v_mfma_f32_16x16x32_bf16 v[172:175], v[140:143], a[140:143], v[172:175]
    ds_read_b64_tr_b16 a[138:139], v241 offset:800
    s_waitcnt lgkmcnt(8)
    v_mfma_f32_16x16x32_bf16 v[176:179], v[136:139], a[144:147], v[176:179]
    ds_read_b64_tr_b16 a[140:141], v241 offset:12320
    v_mfma_f32_16x16x32_bf16 v[180:183], v[140:143], a[144:147], v[180:183]
    ds_read_b64_tr_b16 a[142:143], v241 offset:13088
    v_mfma_f32_16x16x32_bf16 v[184:187], v[136:139], a[148:151], v[184:187]
    ds_read_b64_tr_b16 a[144:145], v240 offset:64
    v_mfma_f32_16x16x32_bf16 v[188:191], v[140:143], a[148:151], v[188:191]
    ds_read_b64_tr_b16 a[146:147], v240 offset:832
    v_mul_f32 v208, 0x3f19be61, v248
    v_mul_f32 v210, 0x3f19be61, v249
    s_lshl2_add_u32 s62, s53, s52
    s_lshl4_add_u32 s62, s62, s54
    s_mul_i32 s62, s62, 6144
    s_add_u32 s62, s62, 0
    s_add_u32 s63, s62, 4096
    v_pk_mul_f32 v[144:145], v[144:145], v[192:193]
    s_waitcnt lgkmcnt(11)
    v_pk_mul_f32 v[146:147], v[146:147], v[194:195]
    v_pk_mul_f32 v[148:149], v[148:149], v[196:197]
    s_waitcnt lgkmcnt(8)
    v_pk_mul_f32 v[150:151], v[150:151], v[198:199]
    v_pk_mul_f32 v[152:153], v[152:153], v[192:193]
    v_pk_mul_f32 v[154:155], v[154:155], v[194:195]
    v_pk_mul_f32 v[156:157], v[156:157], v[196:197]
    v_pk_mul_f32 v[158:159], v[158:159], v[198:199]
    v_cvt_pk_bf16_f32 v144, v144, v145
    v_cvt_pk_bf16_f32 v145, v146, v147
    v_cvt_pk_bf16_f32 v146, v148, v149
    v_cvt_pk_bf16_f32 v147, v150, v151
    v_cvt_pk_bf16_f32 v152, v152, v153
    v_cvt_pk_bf16_f32 v153, v154, v155
    v_cvt_pk_bf16_f32 v154, v156, v157
    v_cvt_pk_bf16_f32 v155, v158, v159
    v_permlane32_swap_b32 v144, v146
    v_permlane32_swap_b32 v145, v147
    buffer_store_dwordx4 v[144:147], v14, s[40:43], s62 offen offset:0 sc1
    v_permlane32_swap_b32 v152, v154
    v_permlane32_swap_b32 v153, v155
    buffer_store_dwordx4 v[152:155], v14, s[40:43], s62 offen offset:1024 sc1
    v_pk_mul_f32 v[160:161], v[160:161], v[192:193]
    v_pk_mul_f32 v[162:163], v[162:163], v[194:195]
    v_pk_mul_f32 v[164:165], v[164:165], v[196:197]
    v_pk_mul_f32 v[166:167], v[166:167], v[198:199]
    v_pk_mul_f32 v[168:169], v[168:169], v[192:193]
    v_pk_mul_f32 v[170:171], v[170:171], v[194:195]
    v_pk_mul_f32 v[172:173], v[172:173], v[196:197]
    v_pk_mul_f32 v[174:175], v[174:175], v[198:199]
    v_cvt_pk_bf16_f32 v160, v160, v161
    v_cvt_pk_bf16_f32 v161, v162, v163
    v_cvt_pk_bf16_f32 v162, v164, v165
    v_cvt_pk_bf16_f32 v163, v166, v167
    v_cvt_pk_bf16_f32 v168, v168, v169
    v_cvt_pk_bf16_f32 v169, v170, v171
    v_cvt_pk_bf16_f32 v170, v172, v173
    v_cvt_pk_bf16_f32 v171, v174, v175
    v_permlane32_swap_b32 v160, v162
    v_permlane32_swap_b32 v161, v163
    buffer_store_dwordx4 v[160:163], v14, s[40:43], s62 offen offset:2048 sc1
    v_permlane32_swap_b32 v168, v170
    v_permlane32_swap_b32 v169, v171
    buffer_store_dwordx4 v[168:171], v14, s[40:43], s62 offen offset:3072 sc1
    v_pk_mul_f32 v[176:177], v[176:177], v[192:193]
    v_pk_mul_f32 v[178:179], v[178:179], v[194:195]
    v_pk_mul_f32 v[180:181], v[180:181], v[196:197]
    v_pk_mul_f32 v[182:183], v[182:183], v[198:199]
    v_pk_mul_f32 v[184:185], v[184:185], v[192:193]
    v_pk_mul_f32 v[186:187], v[186:187], v[194:195]
    v_pk_mul_f32 v[188:189], v[188:189], v[196:197]
    v_pk_mul_f32 v[190:191], v[190:191], v[198:199]
    v_cvt_pk_bf16_f32 v176, v176, v177
    v_cvt_pk_bf16_f32 v177, v178, v179
    v_cvt_pk_bf16_f32 v178, v180, v181
    v_cvt_pk_bf16_f32 v179, v182, v183
    v_cvt_pk_bf16_f32 v184, v184, v185
    v_cvt_pk_bf16_f32 v185, v186, v187
    v_cvt_pk_bf16_f32 v186, v188, v189
    v_cvt_pk_bf16_f32 v187, v190, v191
    v_permlane32_swap_b32 v176, v178
    v_permlane32_swap_b32 v177, v179
    buffer_store_dwordx4 v[176:179], v14, s[40:43], s63 offen offset:0 sc1
    v_permlane32_swap_b32 v184, v186
    v_permlane32_swap_b32 v185, v187
    buffer_store_dwordx4 v[184:187], v14, s[40:43], s63 offen offset:1024 sc1
    s_branch Lgu_5
Ledge:
    s_cmp_eq_u32 s0, 0
    s_cbranch_scc1 Lat8_13
    s_cmp_eq_u32 s0, 1
    s_cbranch_scc1 Lat6_14
    s_cmp_eq_u32 s0, 2
    s_cbranch_scc1 Lat4_15
Lat2_16:
    v_mfma_f32_32x32x16_bf16 v[32:47], a[40:43], a[0:3], 0
    v_mfma_f32_32x32x16_bf16 v[48:63], a[16:19], a[0:3], 0
    ds_read_b64_tr_b16 v[144:145], v92 offset:0
    s_nop 9
    v_cndmask_b32 v64, v8, v32, s[70:71]
    v_cndmask_b32 v65, v8, v33, s[72:73]
    ds_read_b64_tr_b16 v[146:147], v92 offset:2048
    v_cndmask_b32 v66, v8, v34, s[74:75]
    v_cndmask_b32 v67, v8, v35, s[76:77]
    ds_read_b64_tr_b16 v[148:149], v93 offset:0
    v_cndmask_b32 v68, v8, v36, s[78:79]
    v_cndmask_b32 v69, v8, v37, s[80:81]
    ds_read_b64_tr_b16 v[150:151], v93 offset:2048
    v_cndmask_b32 v70, v8, v38, s[82:83]
    v_cndmask_b32 v71, v8, v39, s[84:85]
    ds_read_b64_tr_b16 v[152:153], v94 offset:0
    v_cndmask_b32 v72, v8, v40, s[86:87]
    v_cndmask_b32 v73, v8, v41, s[88:89]
    ds_read_b64_tr_b16 v[154:155], v94 offset:2048
    v_cndmask_b32 v74, v8, v42, s[90:91]
    v_cndmask_b32 v75, v8, v43, s[92:93]
    ds_read_b64_tr_b16 v[156:157], v95 offset:0
    v_cndmask_b32 v76, v8, v44, s[94:95]
    v_cndmask_b32 v77, v8, v45, s[96:97]
    ds_read_b64_tr_b16 v[158:159], v95 offset:2048
    v_cndmask_b32 v78, v8, v46, s[98:99]
    v_cndmask_b32 v79, v8, v47, s[100:101]
    ds_read_b64_tr_b16 v[208:209], v92 offset:4096
    v_mfma_f32_32x32x16_bf16 v[16:31], a[20:23], a[0:3], 0
    ds_read_b64_tr_b16 v[210:211], v92 offset:6144
    v_exp_f32 v64, v64
    ds_read_b64_tr_b16 v[212:213], v93 offset:4096
    v_exp_f32 v65, v65
    ds_read_b64_tr_b16 v[214:215], v93 offset:6144
    v_exp_f32 v66, v66
    ds_read_b64_tr_b16 v[216:217], v94 offset:4096
    v_exp_f32 v67, v67
    ds_read_b64_tr_b16 v[218:219], v94 offset:6144
    v_exp_f32 v68, v68
    ds_read_b64_tr_b16 v[220:221], v95 offset:4096
    v_exp_f32 v69, v69
    ds_read_b64_tr_b16 v[222:223], v95 offset:6144
    v_exp_f32 v70, v70
    ds_read_b64_tr_b16 v[224:225], v92 offset:8192
    v_exp_f32 v71, v71
    ds_read_b64_tr_b16 v[226:227], v92 offset:10240
    v_exp_f32 v72, v72
    ds_read_b64_tr_b16 v[228:229], v93 offset:8192
    v_exp_f32 v73, v73
    ds_read_b64_tr_b16 v[230:231], v93 offset:10240
    v_exp_f32 v74, v74
    ds_read_b64_tr_b16 v[232:233], v94 offset:8192
    v_exp_f32 v75, v75
    ds_read_b64_tr_b16 v[234:235], v94 offset:10240
    v_exp_f32 v76, v76
    ds_read_b64_tr_b16 v[236:237], v95 offset:8192
    v_exp_f32 v77, v77
    ds_read_b64_tr_b16 v[238:239], v95 offset:10240
    v_exp_f32 v78, v78
    ds_read_b64_tr_b16 v[192:193], v92 offset:12288
    v_exp_f32 v79, v79
    ds_read_b64_tr_b16 v[194:195], v92 offset:14336
    v_cvt_pk_bf16_f32 v128, v64, v65
    ds_read_b64_tr_b16 v[196:197], v93 offset:12288
    v_cvt_pk_bf16_f32 v129, v66, v67
    v_cvt_pk_bf16_f32 v130, v68, v69
    ds_read_b64_tr_b16 v[198:199], v93 offset:14336
    v_cvt_pk_bf16_f32 v131, v70, v71
    v_cvt_pk_bf16_f32 v132, v72, v73
    ds_read_b64_tr_b16 v[200:201], v94 offset:12288
    v_cvt_pk_bf16_f32 v133, v74, v75
    v_cvt_pk_bf16_f32 v134, v76, v77
    ds_read_b64_tr_b16 v[202:203], v94 offset:14336
    v_cvt_pk_bf16_f32 v135, v78, v79
    v_mfma_f32_32x32x16_bf16 v[96:111], a[112:115], v[128:131], 0
    ds_read_b64_tr_b16 v[204:205], v95 offset:12288
    v_exp_f32 v48, v48
    ds_read_b64_tr_b16 v[206:207], v95 offset:14336
    v_exp_f32 v49, v49
    s_add_u32 m0, s21, 0
    s_add_u32 s66, s66, 32768
    buffer_load_dwordx4 v2, s[36:39], s66 offen offset:0 lds
    v_exp_f32 v50, v50
    v_exp_f32 v51, v51
    v_mfma_f32_32x32x16_bf16 v[96:111], a[116:119], v[132:135], v[96:111]
    v_exp_f32 v52, v52
    v_exp_f32 v53, v53
    buffer_load_dwordx4 v3, s[36:39], s66 offen offset:1024 lds
    v_exp_f32 v54, v54
    v_exp_f32 v55, v55
    v_mfma_f32_32x32x16_bf16 v[32:47], a[24:27], a[0:3], 0
    v_exp_f32 v56, v56
    v_exp_f32 v57, v57
    buffer_load_dwordx4 v4, s[36:39], s66 offen offset:2048 lds
    v_exp_f32 v58, v58
    v_exp_f32 v59, v59
    v_exp_f32 v60, v60
    v_exp_f32 v61, v61
    v_exp_f32 v62, v62
    buffer_load_dwordx4 v5, s[36:39], s66 offen offset:3072 lds
    v_exp_f32 v63, v63
    v_cvt_pk_bf16_f32 v128, v48, v49
    v_cvt_pk_bf16_f32 v129, v50, v51
    v_cvt_pk_bf16_f32 v130, v52, v53
    v_cvt_pk_bf16_f32 v131, v54, v55
    v_cvt_pk_bf16_f32 v132, v56, v57
    v_cvt_pk_bf16_f32 v133, v58, v59
    v_cvt_pk_bf16_f32 v134, v60, v61
    v_cvt_pk_bf16_f32 v135, v62, v63
    s_lshl2_add_u32 s3, s53, s52
    s_lshl4_add_u32 s3, s3, s54
    s_lshl_b32 s3, s3, 7
    s_add_u32 s3, s3, 15794176
    s_waitcnt vmcnt(4)
    v_mov_b32 v7, s48
    s_mov_b64 exec, 1
    buffer_store_dword v7, off, s[40:43], s3 sc1
    s_mov_b64 exec, -1
    s_add_u32 m0, s21, 4096
    s_add_u32 s66, s66, 32768
    buffer_load_dwordx4 v2, s[36:39], s66 offen offset:0 lds
    v_mfma_f32_32x32x16_bf16 v[96:111], a[64:67], v[128:131], v[96:111]
    v_exp_f32 v16, v16
    v_exp_f32 v17, v17
    v_exp_f32 v18, v18
    v_exp_f32 v19, v19
    v_mfma_f32_32x32x16_bf16 v[96:111], a[68:71], v[132:135], v[96:111]
    buffer_load_dwordx4 v3, s[36:39], s66 offen offset:1024 lds
    v_exp_f32 v20, v20
    v_exp_f32 v21, v21
    v_exp_f32 v22, v22
    v_exp_f32 v23, v23
    v_mfma_f32_32x32x16_bf16 v[48:63], a[28:31], a[0:3], 0
    v_exp_f32 v24, v24
    buffer_load_dwordx4 v4, s[36:39], s66 offen offset:2048 lds
    v_exp_f32 v25, v25
    v_exp_f32 v26, v26
    v_exp_f32 v27, v27
    v_exp_f32 v28, v28
    v_exp_f32 v29, v29
    v_exp_f32 v30, v30
    buffer_load_dwordx4 v5, s[36:39], s66 offen offset:3072 lds
    v_exp_f32 v31, v31
    v_cvt_pk_bf16_f32 v128, v16, v17
    v_cvt_pk_bf16_f32 v129, v18, v19
    v_cvt_pk_bf16_f32 v130, v20, v21
    v_cvt_pk_bf16_f32 v131, v22, v23
    v_cvt_pk_bf16_f32 v132, v24, v25
    v_cvt_pk_bf16_f32 v133, v26, v27
    v_cvt_pk_bf16_f32 v134, v28, v29
    v_cvt_pk_bf16_f32 v135, v30, v31
    s_add_u32 m0, s21, 8192
    s_add_u32 s66, s66, 32768
    buffer_load_dwordx4 v2, s[36:39], s66 offen offset:0 lds
    v_mfma_f32_32x32x16_bf16 v[96:111], a[72:75], v[128:131], v[96:111]
    v_exp_f32 v32, v32
    v_exp_f32 v33, v33
    v_exp_f32 v34, v34
    v_exp_f32 v35, v35
    v_mfma_f32_32x32x16_bf16 v[96:111], a[76:79], v[132:135], v[96:111]
    buffer_load_dwordx4 v3, s[36:39], s66 offen offset:1024 lds
    v_exp_f32 v36, v36
    v_exp_f32 v37, v37
    v_exp_f32 v38, v38
    v_exp_f32 v39, v39
    v_mfma_f32_32x32x16_bf16 v[16:31], a[32:35], a[0:3], 0
    v_exp_f32 v40, v40
    buffer_load_dwordx4 v4, s[36:39], s66 offen offset:2048 lds
    v_exp_f32 v41, v41
    v_exp_f32 v42, v42
    v_exp_f32 v43, v43
    v_exp_f32 v44, v44
    v_exp_f32 v45, v45
    v_exp_f32 v46, v46
    buffer_load_dwordx4 v5, s[36:39], s66 offen offset:3072 lds
    v_exp_f32 v47, v47
    v_cvt_pk_bf16_f32 v128, v32, v33
    v_cvt_pk_bf16_f32 v129, v34, v35
    v_cvt_pk_bf16_f32 v130, v36, v37
    v_cvt_pk_bf16_f32 v131, v38, v39
    v_cvt_pk_bf16_f32 v132, v40, v41
    v_cvt_pk_bf16_f32 v133, v42, v43
    v_cvt_pk_bf16_f32 v134, v44, v45
    v_cvt_pk_bf16_f32 v135, v46, v47
    s_waitcnt lgkmcnt(0)
    v_mfma_f32_32x32x16_bf16 v[96:111], a[80:83], v[128:131], v[96:111]
    v_exp_f32 v48, v48
    v_exp_f32 v49, v49
    v_exp_f32 v50, v50
    v_exp_f32 v51, v51
    v_mfma_f32_32x32x16_bf16 v[96:111], a[84:87], v[132:135], v[96:111]
    s_add_u32 m0, s20, 0
    s_add_u32 s66, s66, 32768
    buffer_load_dwordx4 v2, s[28:31], s66 offen offset:0 lds
    v_exp_f32 v52, v52
    v_exp_f32 v53, v53
    v_exp_f32 v54, v54
    v_exp_f32 v55, v55
    v_mfma_f32_32x32x16_bf16 v[32:47], a[36:39], a[0:3], 0
    buffer_load_dwordx4 v3, s[28:31], s66 offen offset:1024 lds
    v_exp_f32 v56, v56
    v_exp_f32 v57, v57
    v_exp_f32 v58, v58
    v_exp_f32 v59, v59
    v_exp_f32 v60, v60
    buffer_load_dwordx4 v4, s[28:31], s66 offen offset:2048 lds
    v_exp_f32 v61, v61
    v_exp_f32 v62, v62
    v_exp_f32 v63, v63
    v_cvt_pk_bf16_f32 v128, v48, v49
    v_cvt_pk_bf16_f32 v129, v50, v51
    v_cvt_pk_bf16_f32 v130, v52, v53
    v_cvt_pk_bf16_f32 v131, v54, v55
    v_cvt_pk_bf16_f32 v132, v56, v57
    buffer_load_dwordx4 v5, s[28:31], s66 offen offset:3072 lds
    v_cvt_pk_bf16_f32 v133, v58, v59
    v_cvt_pk_bf16_f32 v134, v60, v61
    v_cvt_pk_bf16_f32 v135, v62, v63
    v_mfma_f32_32x32x16_bf16 v[96:111], a[88:91], v[128:131], v[96:111]
    v_exp_f32 v16, v16
    v_exp_f32 v17, v17
    v_exp_f32 v18, v18
    s_add_u32 m0, s20, 4096
    s_lshl_b32 s66, s52, 17
    buffer_load_dwordx4 v2, s[32:35], s66 offen offset:0 lds
    v_exp_f32 v19, v19
    v_mfma_f32_32x32x16_bf16 v[96:111], a[92:95], v[132:135], v[96:111]
    v_exp_f32 v20, v20
    v_exp_f32 v21, v21
    v_exp_f32 v22, v22
    buffer_load_dwordx4 v3, s[32:35], s66 offen offset:1024 lds
    v_exp_f32 v23, v23
    v_exp_f32 v24, v24
    v_exp_f32 v25, v25
    v_exp_f32 v26, v26
    v_exp_f32 v27, v27
    v_exp_f32 v28, v28
    buffer_load_dwordx4 v4, s[32:35], s66 offen offset:2048 lds
    v_exp_f32 v29, v29
    v_exp_f32 v30, v30
    v_exp_f32 v31, v31
    v_cvt_pk_bf16_f32 v128, v16, v17
    v_cvt_pk_bf16_f32 v129, v18, v19
    v_cvt_pk_bf16_f32 v130, v20, v21
    buffer_load_dwordx4 v5, s[32:35], s66 offen offset:3072 lds
    v_cvt_pk_bf16_f32 v131, v22, v23
    v_cvt_pk_bf16_f32 v132, v24, v25
    v_cvt_pk_bf16_f32 v133, v26, v27
    v_cvt_pk_bf16_f32 v134, v28, v29
    v_cvt_pk_bf16_f32 v135, v30, v31
    v_mfma_f32_32x32x16_bf16 v[96:111], a[96:99], v[128:131], v[96:111]
    v_exp_f32 v32, v32
    v_exp_f32 v33, v33
    s_add_u32 m0, s20, 8192
    s_add_u32 s66, s66, 32768
    buffer_load_dwordx4 v2, s[32:35], s66 offen offset:0 lds
    v_exp_f32 v34, v34
    v_exp_f32 v35, v35
    v_mfma_f32_32x32x16_bf16 v[96:111], a[100:103], v[132:135], v[96:111]
    v_exp_f32 v36, v36
    v_exp_f32 v37, v37
    v_exp_f32 v38, v38
    buffer_load_dwordx4 v3, s[32:35], s66 offen offset:1024 lds
    v_exp_f32 v39, v39
    v_exp_f32 v40, v40
    v_exp_f32 v41, v41
    v_exp_f32 v42, v42
    v_exp_f32 v43, v43
    buffer_load_dwordx4 v4, s[32:35], s66 offen offset:2048 lds
    v_exp_f32 v44, v44
    v_exp_f32 v45, v45
    v_exp_f32 v46, v46
    v_exp_f32 v47, v47
    v_cvt_pk_bf16_f32 v128, v32, v33
    v_cvt_pk_bf16_f32 v129, v34, v35
    buffer_load_dwordx4 v5, s[32:35], s66 offen offset:3072 lds
    v_cvt_pk_bf16_f32 v130, v36, v37
    v_cvt_pk_bf16_f32 v131, v38, v39
    v_cvt_pk_bf16_f32 v132, v40, v41
    v_cvt_pk_bf16_f32 v133, v42, v43
    v_cvt_pk_bf16_f32 v134, v44, v45
    v_cvt_pk_bf16_f32 v135, v46, v47
    v_mfma_f32_32x32x16_bf16 v[96:111], a[104:107], v[128:131], v[96:111]
    s_nop 0
    v_mfma_f32_32x32x16_bf16 v[96:111], a[108:111], v[132:135], v[96:111]
    v_mfma_f32_32x32x16_bf16 v[32:47], a[44:47], a[4:7], 0
    v_mfma_f32_32x32x16_bf16 v[48:63], a[16:19], a[4:7], 0
    s_nop 9
    v_subrev_u32 v11, 0x2b800000, v104
    v_cmp_le_u32 vcc, 0x23000000, v11
    s_nop 0
    s_cbranch_vccnz Lfb_2_0
Lfr_2_0:
    v_rcp_f32 v11, v104
    s_nop 0
    v_mul_f32 v96, v96, v11
    v_mul_f32 v97, v97, v11
    v_and_b32 v96, v12, v96
    v_mul_f32 v98, v98, v11
    v_mul_f32 v99, v99, v11
    v_mul_f32 v100, v100, v11
    v_mul_f32 v101, v101, v11
    v_mul_f32 v102, v102, v11
    v_mul_f32 v103, v103, v11
    v_cvt_pk_bf16_f32 v104, v96, v97
    v_cvt_pk_bf16_f32 v105, v98, v99
    v_cvt_pk_bf16_f32 v106, v100, v101
    v_cvt_pk_bf16_f32 v107, v102, v103
    v_or_b32 v104, v9, v104
    buffer_store_dwordx4 v[104:107], v14, s[40:43], s60 offen sc1
    s_lshl_b32 s58, s56, 16
    s_lshl_b32 s59, s52, 14
    s_add_u32 s58, s58, s59
    s_lshl_b32 s59, s57, 7
    s_add_u32 s58, s58, s59
    v_lshrrev_b32 v250, 3, v1
    v_and_b32 v251, 7, v1
    v_lshlrev_b32 v252, 4, v251
    v_lshl_add_u32 v252, v250, 10, v252
    v_add_u32 v253, 8192, v252
    buffer_load_dwordx4 v[240:243], v252, s[24:27], s58 offen
    v_cndmask_b32 v64, v8, v32, s[70:71]
    v_cndmask_b32 v65, v8, v33, s[72:73]
    v_cndmask_b32 v66, v8, v34, s[74:75]
    v_cndmask_b32 v67, v8, v35, s[76:77]
    v_cndmask_b32 v68, v8, v36, s[78:79]
    v_cndmask_b32 v69, v8, v37, s[80:81]
    v_cndmask_b32 v70, v8, v38, s[82:83]
    v_cndmask_b32 v71, v8, v39, s[84:85]
    v_cndmask_b32 v72, v8, v40, s[86:87]
    v_cndmask_b32 v73, v8, v41, s[88:89]
    v_cndmask_b32 v74, v8, v42, s[90:91]
    v_cndmask_b32 v75, v8, v43, s[92:93]
    v_cndmask_b32 v76, v8, v44, s[94:95]
    v_cndmask_b32 v77, v8, v45, s[96:97]
    v_cndmask_b32 v78, v8, v46, s[98:99]
    v_cndmask_b32 v79, v8, v47, s[100:101]
    v_mfma_f32_32x32x16_bf16 v[16:31], a[20:23], a[4:7], 0
    v_exp_f32 v64, v64
    v_exp_f32 v65, v65
    v_exp_f32 v66, v66
    buffer_load_dwordx4 v[244:247], v253, s[24:27], s58 offen
    v_exp_f32 v67, v67
    v_exp_f32 v68, v68
    v_exp_f32 v69, v69
    v_exp_f32 v70, v70
    v_exp_f32 v71, v71
    v_exp_f32 v72, v72
    v_exp_f32 v73, v73
    v_exp_f32 v74, v74
    v_exp_f32 v75, v75
    v_exp_f32 v76, v76
    v_exp_f32 v77, v77
    s_add_u32 m0, s20, 12288
    s_add_u32 s66, s66, 32768
    buffer_load_dwordx4 v2, s[32:35], s66 offen offset:0 lds
    v_exp_f32 v78, v78
    v_exp_f32 v79, v79
    v_cvt_pk_bf16_f32 v128, v64, v65
    v_cvt_pk_bf16_f32 v129, v66, v67
    v_cvt_pk_bf16_f32 v130, v68, v69
    v_cvt_pk_bf16_f32 v131, v70, v71
    v_cvt_pk_bf16_f32 v132, v72, v73
    v_cvt_pk_bf16_f32 v133, v74, v75
    v_cvt_pk_bf16_f32 v134, v76, v77
    v_cvt_pk_bf16_f32 v135, v78, v79
    v_mfma_f32_32x32x16_bf16 v[112:127], a[120:123], v[128:131], 0
    v_exp_f32 v48, v48
    v_exp_f32 v49, v49
    v_exp_f32 v50, v50
    v_exp_f32 v51, v51
    v_mfma_f32_32x32x16_bf16 v[112:127], a[124:127], v[132:135], v[112:127]
    buffer_load_dwordx4 v3, s[32:35], s66 offen offset:1024 lds
    v_exp_f32 v52, v52
    v_exp_f32 v53, v53
    v_exp_f32 v54, v54
    v_exp_f32 v55, v55
    v_mfma_f32_32x32x16_bf16 v[32:47], a[24:27], a[4:7], 0
    v_exp_f32 v56, v56
    v_exp_f32 v57, v57
    v_exp_f32 v58, v58
    v_exp_f32 v59, v59
    v_exp_f32 v60, v60
    v_exp_f32 v61, v61
    buffer_load_dwordx4 v4, s[32:35], s66 offen offset:2048 lds
    v_exp_f32 v62, v62
    v_exp_f32 v63, v63
    v_cvt_pk_bf16_f32 v128, v48, v49
    v_cvt_pk_bf16_f32 v129, v50, v51
    v_cvt_pk_bf16_f32 v130, v52, v53
    v_cvt_pk_bf16_f32 v131, v54, v55
    v_cvt_pk_bf16_f32 v132, v56, v57
    v_cvt_pk_bf16_f32 v133, v58, v59
    v_cvt_pk_bf16_f32 v134, v60, v61
    v_cvt_pk_bf16_f32 v135, v62, v63
    v_mfma_f32_32x32x16_bf16 v[112:127], a[64:67], v[128:131], v[112:127]
    v_exp_f32 v16, v16
    v_exp_f32 v17, v17
    v_exp_f32 v18, v18
    v_exp_f32 v19, v19
    v_mfma_f32_32x32x16_bf16 v[112:127], a[68:71], v[132:135], v[112:127]
    buffer_load_dwordx4 v5, s[32:35], s66 offen offset:3072 lds
    v_exp_f32 v20, v20
    v_exp_f32 v21, v21
    v_exp_f32 v22, v22
    v_exp_f32 v23, v23
    v_mfma_f32_32x32x16_bf16 v[48:63], a[28:31], a[4:7], 0
    v_exp_f32 v24, v24
    v_exp_f32 v25, v25
    v_exp_f32 v26, v26
    v_exp_f32 v27, v27
    v_exp_f32 v28, v28
    v_exp_f32 v29, v29
    buffer_load_dword v254, v15, s[40:43], 0 offen sc1
    v_exp_f32 v30, v30
    v_exp_f32 v31, v31
    v_cvt_pk_bf16_f32 v128, v16, v17
    v_cvt_pk_bf16_f32 v129, v18, v19
    v_cvt_pk_bf16_f32 v130, v20, v21
    v_cvt_pk_bf16_f32 v131, v22, v23
    v_cvt_pk_bf16_f32 v132, v24, v25
    v_cvt_pk_bf16_f32 v133, v26, v27
    v_cvt_pk_bf16_f32 v134, v28, v29
    v_cvt_pk_bf16_f32 v135, v30, v31
    v_mfma_f32_32x32x16_bf16 v[112:127], a[72:75], v[128:131], v[112:127]
    v_exp_f32 v32, v32
    v_exp_f32 v33, v33
    v_exp_f32 v34, v34
    v_exp_f32 v35, v35
    v_mfma_f32_32x32x16_bf16 v[112:127], a[76:79], v[132:135], v[112:127]
    v_exp_f32 v36, v36
    v_exp_f32 v37, v37
    v_exp_f32 v38, v38
    v_exp_f32 v39, v39
    v_mfma_f32_32x32x16_bf16 v[16:31], a[32:35], a[4:7], 0
    v_exp_f32 v40, v40
    v_exp_f32 v41, v41
    v_exp_f32 v42, v42
    v_exp_f32 v43, v43
    v_exp_f32 v44, v44
    v_exp_f32 v45, v45
    v_exp_f32 v46, v46
    v_exp_f32 v47, v47
    v_cvt_pk_bf16_f32 v128, v32, v33
    v_cvt_pk_bf16_f32 v129, v34, v35
    v_cvt_pk_bf16_f32 v130, v36, v37
    v_cvt_pk_bf16_f32 v131, v38, v39
    v_cvt_pk_bf16_f32 v132, v40, v41
    v_cvt_pk_bf16_f32 v133, v42, v43
    v_cvt_pk_bf16_f32 v134, v44, v45
    v_cvt_pk_bf16_f32 v135, v46, v47
    s_waitcnt vmcnt(0)
    v_cmp_ne_u32 vcc, s48, v254
    s_nop 0
    s_cbranch_vccnz Lsp_11_2
Lok_12_2:
    buffer_load_dwordx4 a[128:131], v88, s[40:43], s65 offen offset:0 sc1
    v_mfma_f32_32x32x16_bf16 v[112:127], a[80:83], v[128:131], v[112:127]
    v_exp_f32 v48, v48
    v_exp_f32 v49, v49
    v_exp_f32 v50, v50
    v_exp_f32 v51, v51
    v_mfma_f32_32x32x16_bf16 v[112:127], a[84:87], v[132:135], v[112:127]
    v_exp_f32 v52, v52
    v_exp_f32 v53, v53
    buffer_load_dwordx4 a[132:135], v89, s[40:43], s65 offen offset:0 sc1
    v_exp_f32 v54, v54
    v_exp_f32 v55, v55
    v_mfma_f32_32x32x16_bf16 v[32:47], a[36:39], a[4:7], 0
    v_exp_f32 v56, v56
    v_exp_f32 v57, v57
    v_exp_f32 v58, v58
    v_exp_f32 v59, v59
    v_exp_f32 v60, v60
    buffer_load_dwordx4 a[136:139], v90, s[40:43], s65 offen offset:0 sc1
    v_exp_f32 v61, v61
    v_exp_f32 v62, v62
    v_exp_f32 v63, v63
    v_cvt_pk_bf16_f32 v128, v48, v49
    v_cvt_pk_bf16_f32 v129, v50, v51
    v_cvt_pk_bf16_f32 v130, v52, v53
    v_cvt_pk_bf16_f32 v131, v54, v55
    v_cvt_pk_bf16_f32 v132, v56, v57
    v_cvt_pk_bf16_f32 v133, v58, v59
    v_cvt_pk_bf16_f32 v134, v60, v61
    v_cvt_pk_bf16_f32 v135, v62, v63
    buffer_load_dwordx4 a[140:143], v91, s[40:43], s65 offen offset:0 sc1
    v_mfma_f32_32x32x16_bf16 v[112:127], a[88:91], v[128:131], v[112:127]
    v_exp_f32 v16, v16
    v_exp_f32 v17, v17
    v_exp_f32 v18, v18
    v_exp_f32 v19, v19
    v_mfma_f32_32x32x16_bf16 v[112:127], a[92:95], v[132:135], v[112:127]
    v_exp_f32 v20, v20
    v_exp_f32 v21, v21
    buffer_load_dwordx4 a[144:147], v88, s[40:43], s65 offen offset:1024 sc1
    v_exp_f32 v22, v22
    v_exp_f32 v23, v23
    v_mfma_f32_32x32x16_bf16 v[48:63], a[40:43], a[4:7], 0
    v_exp_f32 v24, v24
    v_exp_f32 v25, v25
    v_exp_f32 v26, v26
    v_exp_f32 v27, v27
    v_exp_f32 v28, v28
    buffer_load_dwordx4 a[148:151], v89, s[40:43], s65 offen offset:1024 sc1
    v_exp_f32 v29, v29
    v_exp_f32 v30, v30
    v_exp_f32 v31, v31
    v_cvt_pk_bf16_f32 v128, v16, v17
    v_cvt_pk_bf16_f32 v129, v18, v19
    v_cvt_pk_bf16_f32 v130, v20, v21
    v_cvt_pk_bf16_f32 v131, v22, v23
    v_cvt_pk_bf16_f32 v132, v24, v25
    v_cvt_pk_bf16_f32 v133, v26, v27
    v_cvt_pk_bf16_f32 v134, v28, v29
    v_cvt_pk_bf16_f32 v135, v30, v31
    buffer_load_dwordx4 a[152:155], v90, s[40:43], s65 offen offset:1024 sc1
    v_mfma_f32_32x32x16_bf16 v[112:127], a[96:99], v[128:131], v[112:127]
    v_exp_f32 v32, v32
    v_exp_f32 v33, v33
    v_exp_f32 v34, v34
    v_exp_f32 v35, v35
    v_mfma_f32_32x32x16_bf16 v[112:127], a[100:103], v[132:135], v[112:127]
    v_exp_f32 v36, v36
    v_exp_f32 v37, v37
    buffer_load_dwordx4 a[156:159], v91, s[40:43], s65 offen offset:1024 sc1
    v_exp_f32 v38, v38
    v_exp_f32 v39, v39
    v_exp_f32 v40, v40
    v_exp_f32 v41, v41
    v_exp_f32 v42, v42
    v_exp_f32 v43, v43
    v_exp_f32 v44, v44
    v_exp_f32 v45, v45
    buffer_load_dwordx4 a[160:163], v88, s[40:43], s65 offen offset:2048 sc1
    v_exp_f32 v46, v46
    v_exp_f32 v47, v47
    v_cvt_pk_bf16_f32 v128, v32, v33
    v_cvt_pk_bf16_f32 v129, v34, v35
    v_cvt_pk_bf16_f32 v130, v36, v37
    v_cvt_pk_bf16_f32 v131, v38, v39
    v_cvt_pk_bf16_f32 v132, v40, v41
    v_cvt_pk_bf16_f32 v133, v42, v43
    v_cvt_pk_bf16_f32 v134, v44, v45
    v_cvt_pk_bf16_f32 v135, v46, v47
    v_mfma_f32_32x32x16_bf16 v[112:127], a[104:107], v[128:131], v[112:127]
    buffer_load_dwordx4 a[164:167], v89, s[40:43], s65 offen offset:2048 sc1
    v_exp_f32 v48, v48
    v_exp_f32 v49, v49
    v_exp_f32 v50, v50
    v_exp_f32 v51, v51
    v_mfma_f32_32x32x16_bf16 v[112:127], a[108:111], v[132:135], v[112:127]
    v_exp_f32 v52, v52
    v_exp_f32 v53, v53
    v_exp_f32 v54, v54
    buffer_load_dwordx4 a[168:171], v90, s[40:43], s65 offen offset:2048 sc1
    v_exp_f32 v55, v55
    v_exp_f32 v56, v56
    v_exp_f32 v57, v57
    v_exp_f32 v58, v58
    v_exp_f32 v59, v59
    v_exp_f32 v60, v60
    v_exp_f32 v61, v61
    v_exp_f32 v62, v62
    buffer_load_dwordx4 a[172:175], v91, s[40:43], s65 offen offset:2048 sc1
    v_exp_f32 v63, v63
    v_cvt_pk_bf16_f32 v128, v48, v49
    v_cvt_pk_bf16_f32 v129, v50, v51
    v_cvt_pk_bf16_f32 v130, v52, v53
    v_cvt_pk_bf16_f32 v131, v54, v55
    v_cvt_pk_bf16_f32 v132, v56, v57
    v_cvt_pk_bf16_f32 v133, v58, v59
    v_cvt_pk_bf16_f32 v134, v60, v61
    v_cvt_pk_bf16_f32 v135, v62, v63
    v_mfma_f32_32x32x16_bf16 v[112:127], a[112:115], v[128:131], v[112:127]
    s_nop 0
    v_mfma_f32_32x32x16_bf16 v[112:127], a[116:119], v[132:135], v[112:127]
    s_nop 11
    v_subrev_u32 v11, 0x2b800000, v120
    v_cmp_le_u32 vcc, 0x23000000, v11
    s_nop 0
    s_cbranch_vccnz Lfb_2_1
Lfr_2_1:
    s_add_u32 s60, s60, 98304
    v_rcp_f32 v11, v120
    s_nop 0
    v_mul_f32 v112, v112, v11
    v_mul_f32 v113, v113, v11
    v_and_b32 v112, v12, v112
    v_mul_f32 v114, v114, v11
    v_mul_f32 v115, v115, v11
    v_mul_f32 v116, v116, v11
    v_mul_f32 v117, v117, v11
    v_mul_f32 v118, v118, v11
    v_mul_f32 v119, v119, v11
    v_cvt_pk_bf16_f32 v120, v112, v113
    v_cvt_pk_bf16_f32 v121, v114, v115
    v_cvt_pk_bf16_f32 v122, v116, v117
    v_cvt_pk_bf16_f32 v123, v118, v119
    v_or_b32 v120, v9, v120
    buffer_store_dwordx4 v[120:123], v14, s[40:43], s60 offen sc1
    s_branch Lp3_17
Lat4_15:
    v_mfma_f32_32x32x16_bf16 v[32:47], a[40:43], a[0:3], 0
    v_mfma_f32_32x32x16_bf16 v[48:63], a[24:27], a[0:3], 0
    ds_read_b64_tr_b16 v[144:145], v92 offset:0
    s_nop 9
    v_cndmask_b32 v64, v8, v32, s[70:71]
    v_cndmask_b32 v65, v8, v33, s[72:73]
    ds_read_b64_tr_b16 v[146:147], v92 offset:2048
    v_cndmask_b32 v66, v8, v34, s[74:75]
    v_cndmask_b32 v67, v8, v35, s[76:77]
    ds_read_b64_tr_b16 v[148:149], v93 offset:0
    v_cndmask_b32 v68, v8, v36, s[78:79]
    v_cndmask_b32 v69, v8, v37, s[80:81]
    ds_read_b64_tr_b16 v[150:151], v93 offset:2048
    v_cndmask_b32 v70, v8, v38, s[82:83]
    v_cndmask_b32 v71, v8, v39, s[84:85]
    ds_read_b64_tr_b16 v[152:153], v94 offset:0
    v_cndmask_b32 v72, v8, v40, s[86:87]
    v_cndmask_b32 v73, v8, v41, s[88:89]
    ds_read_b64_tr_b16 v[154:155], v94 offset:2048
    v_cndmask_b32 v74, v8, v42, s[90:91]
    v_cndmask_b32 v75, v8, v43, s[92:93]
    ds_read_b64_tr_b16 v[156:157], v95 offset:0
    v_cndmask_b32 v76, v8, v44, s[94:95]
    v_cndmask_b32 v77, v8, v45, s[96:97]
    ds_read_b64_tr_b16 v[158:159], v95 offset:2048
    v_cndmask_b32 v78, v8, v46, s[98:99]
    v_cndmask_b32 v79, v8, v47, s[100:101]
    ds_read_b64_tr_b16 v[208:209], v92 offset:4096
    v_mfma_f32_32x32x16_bf16 v[16:31], a[28:31], a[0:3], 0
    ds_read_b64_tr_b16 v[210:211], v92 offset:6144
    v_exp_f32 v64, v64
    ds_read_b64_tr_b16 v[212:213], v93 offset:4096
    v_exp_f32 v65, v65
    ds_read_b64_tr_b16 v[214:215], v93 offset:6144
    v_exp_f32 v66, v66
    ds_read_b64_tr_b16 v[216:217], v94 offset:4096
    v_exp_f32 v67, v67
    ds_read_b64_tr_b16 v[218:219], v94 offset:6144
    v_exp_f32 v68, v68
    ds_read_b64_tr_b16 v[220:221], v95 offset:4096
    v_exp_f32 v69, v69
    ds_read_b64_tr_b16 v[222:223], v95 offset:6144
    v_exp_f32 v70, v70
    ds_read_b64_tr_b16 v[224:225], v92 offset:8192
    v_exp_f32 v71, v71
    ds_read_b64_tr_b16 v[226:227], v92 offset:10240
    v_exp_f32 v72, v72
    ds_read_b64_tr_b16 v[228:229], v93 offset:8192
    v_exp_f32 v73, v73
    ds_read_b64_tr_b16 v[230:231], v93 offset:10240
    v_exp_f32 v74, v74
    ds_read_b64_tr_b16 v[232:233], v94 offset:8192
    v_exp_f32 v75, v75
    ds_read_b64_tr_b16 v[234:235], v94 offset:10240
    v_exp_f32 v76, v76
    ds_read_b64_tr_b16 v[236:237], v95 offset:8192
    v_exp_f32 v77, v77
    ds_read_b64_tr_b16 v[238:239], v95 offset:10240
    v_exp_f32 v78, v78
    ds_read_b64_tr_b16 v[192:193], v92 offset:12288
    v_exp_f32 v79, v79
    ds_read_b64_tr_b16 v[194:195], v92 offset:14336
    v_cvt_pk_bf16_f32 v128, v64, v65
    ds_read_b64_tr_b16 v[196:197], v93 offset:12288
    v_cvt_pk_bf16_f32 v129, v66, v67
    v_cvt_pk_bf16_f32 v130, v68, v69
    ds_read_b64_tr_b16 v[198:199], v93 offset:14336
    v_cvt_pk_bf16_f32 v131, v70, v71
    v_cvt_pk_bf16_f32 v132, v72, v73
    ds_read_b64_tr_b16 v[200:201], v94 offset:12288
    v_cvt_pk_bf16_f32 v133, v74, v75
    v_cvt_pk_bf16_f32 v134, v76, v77
    ds_read_b64_tr_b16 v[202:203], v94 offset:14336
    v_cvt_pk_bf16_f32 v135, v78, v79
    v_mfma_f32_32x32x16_bf16 v[96:111], a[112:115], v[128:131], 0
    ds_read_b64_tr_b16 v[204:205], v95 offset:12288
    v_exp_f32 v48, v48
    ds_read_b64_tr_b16 v[206:207], v95 offset:14336
    v_exp_f32 v49, v49
    s_add_u32 m0, s21, 0
    s_add_u32 s66, s66, 32768
    buffer_load_dwordx4 v2, s[36:39], s66 offen offset:0 lds
    v_exp_f32 v50, v50
    v_exp_f32 v51, v51
    v_mfma_f32_32x32x16_bf16 v[96:111], a[116:119], v[132:135], v[96:111]
    v_exp_f32 v52, v52
    v_exp_f32 v53, v53
    buffer_load_dwordx4 v3, s[36:39], s66 offen offset:1024 lds
    v_exp_f32 v54, v54
    v_exp_f32 v55, v55
    v_mfma_f32_32x32x16_bf16 v[32:47], a[32:35], a[0:3], 0
    v_exp_f32 v56, v56
    v_exp_f32 v57, v57
    buffer_load_dwordx4 v4, s[36:39], s66 offen offset:2048 lds
    v_exp_f32 v58, v58
    v_exp_f32 v59, v59
    v_exp_f32 v60, v60
    v_exp_f32 v61, v61
    v_exp_f32 v62, v62
    buffer_load_dwordx4 v5, s[36:39], s66 offen offset:3072 lds
    v_exp_f32 v63, v63
    v_cvt_pk_bf16_f32 v128, v48, v49
    v_cvt_pk_bf16_f32 v129, v50, v51
    v_cvt_pk_bf16_f32 v130, v52, v53
    v_cvt_pk_bf16_f32 v131, v54, v55
    v_cvt_pk_bf16_f32 v132, v56, v57
    v_cvt_pk_bf16_f32 v133, v58, v59
    v_cvt_pk_bf16_f32 v134, v60, v61
    v_cvt_pk_bf16_f32 v135, v62, v63
    s_lshl2_add_u32 s3, s53, s52
    s_lshl4_add_u32 s3, s3, s54
    s_lshl_b32 s3, s3, 7
    s_add_u32 s3, s3, 15794176
    s_waitcnt vmcnt(4)
    v_mov_b32 v7, s48
    s_mov_b64 exec, 1
    buffer_store_dword v7, off, s[40:43], s3 sc1
    s_mov_b64 exec, -1
    s_add_u32 m0, s21, 4096
    s_add_u32 s66, s66, 32768
    buffer_load_dwordx4 v2, s[36:39], s66 offen offset:0 lds
    v_mfma_f32_32x32x16_bf16 v[96:111], a[80:83], v[128:131], v[96:111]
    v_exp_f32 v16, v16
    v_exp_f32 v17, v17
    v_exp_f32 v18, v18
    buffer_load_dwordx4 v3, s[36:39], s66 offen offset:1024 lds
    v_exp_f32 v19, v19
    v_mfma_f32_32x32x16_bf16 v[96:111], a[84:87], v[132:135], v[96:111]
    v_exp_f32 v20, v20
    buffer_load_dwordx4 v4, s[36:39], s66 offen offset:2048 lds
    v_exp_f32 v21, v21
    v_exp_f32 v22, v22
    v_exp_f32 v23, v23
    v_mfma_f32_32x32x16_bf16 v[48:63], a[36:39], a[0:3], 0
    buffer_load_dwordx4 v5, s[36:39], s66 offen offset:3072 lds
    v_exp_f32 v24, v24
    v_exp_f32 v25, v25
    v_exp_f32 v26, v26
    s_add_u32 m0, s21, 8192
    s_add_u32 s66, s66, 32768
    buffer_load_dwordx4 v2, s[36:39], s66 offen offset:0 lds
    v_exp_f32 v27, v27
    v_exp_f32 v28, v28
    v_exp_f32 v29, v29
    v_exp_f32 v30, v30
    buffer_load_dwordx4 v3, s[36:39], s66 offen offset:1024 lds
    v_exp_f32 v31, v31
    v_cvt_pk_bf16_f32 v128, v16, v17
    v_cvt_pk_bf16_f32 v129, v18, v19
    v_cvt_pk_bf16_f32 v130, v20, v21
    v_cvt_pk_bf16_f32 v131, v22, v23
    buffer_load_dwordx4 v4, s[36:39], s66 offen offset:2048 lds
    v_cvt_pk_bf16_f32 v132, v24, v25
    v_cvt_pk_bf16_f32 v133, v26, v27
    v_cvt_pk_bf16_f32 v134, v28, v29
    v_cvt_pk_bf16_f32 v135, v30, v31
    v_mfma_f32_32x32x16_bf16 v[96:111], a[88:91], v[128:131], v[96:111]
    v_exp_f32 v32, v32
    buffer_load_dwordx4 v5, s[36:39], s66 offen offset:3072 lds
    v_exp_f32 v33, v33
    v_exp_f32 v34, v34
    v_exp_f32 v35, v35
    s_waitcnt lgkmcnt(0)
    v_mfma_f32_32x32x16_bf16 v[96:111], a[92:95], v[132:135], v[96:111]
    v_exp_f32 v36, v36
    v_exp_f32 v37, v37
    s_add_u32 m0, s20, 0
    s_add_u32 s66, s66, 32768
    buffer_load_dwordx4 v2, s[28:31], s66 offen offset:0 lds
    v_exp_f32 v38, v38
    v_exp_f32 v39, v39
    v_exp_f32 v40, v40
    buffer_load_dwordx4 v3, s[28:31], s66 offen offset:1024 lds
    v_exp_f32 v41, v41
    v_exp_f32 v42, v42
    v_exp_f32 v43, v43
    v_exp_f32 v44, v44
    buffer_load_dwordx4 v4, s[28:31], s66 offen offset:2048 lds
    v_exp_f32 v45, v45
    v_exp_f32 v46, v46
    v_exp_f32 v47, v47
    buffer_load_dwordx4 v5, s[28:31], s66 offen offset:3072 lds
    v_cvt_pk_bf16_f32 v128, v32, v33
    v_cvt_pk_bf16_f32 v129, v34, v35
    v_cvt_pk_bf16_f32 v130, v36, v37
    v_cvt_pk_bf16_f32 v131, v38, v39
    v_cvt_pk_bf16_f32 v132, v40, v41
    v_cvt_pk_bf16_f32 v133, v42, v43
    s_add_u32 m0, s20, 4096
    s_lshl_b32 s66, s52, 17
    buffer_load_dwordx4 v2, s[32:35], s66 offen offset:0 lds
    v_cvt_pk_bf16_f32 v134, v44, v45
    v_cvt_pk_bf16_f32 v135, v46, v47
    v_mfma_f32_32x32x16_bf16 v[96:111], a[96:99], v[128:131], v[96:111]
    v_exp_f32 v48, v48
    buffer_load_dwordx4 v3, s[32:35], s66 offen offset:1024 lds
    v_exp_f32 v49, v49
    v_exp_f32 v50, v50
    v_exp_f32 v51, v51
    buffer_load_dwordx4 v4, s[32:35], s66 offen offset:2048 lds
    v_mfma_f32_32x32x16_bf16 v[96:111], a[100:103], v[132:135], v[96:111]
    v_exp_f32 v52, v52
    v_exp_f32 v53, v53
    v_exp_f32 v54, v54
    buffer_load_dwordx4 v5, s[32:35], s66 offen offset:3072 lds
    v_exp_f32 v55, v55
    v_exp_f32 v56, v56
    v_exp_f32 v57, v57
    s_add_u32 m0, s20, 8192
    s_add_u32 s66, s66, 32768
    buffer_load_dwordx4 v2, s[32:35], s66 offen offset:0 lds
    v_exp_f32 v58, v58
    v_exp_f32 v59, v59
    v_exp_f32 v60, v60
    buffer_load_dwordx4 v3, s[32:35], s66 offen offset:1024 lds
    v_exp_f32 v61, v61
    v_exp_f32 v62, v62
    v_exp_f32 v63, v63
    buffer_load_dwordx4 v4, s[32:35], s66 offen offset:2048 lds
    v_cvt_pk_bf16_f32 v128, v48, v49
    v_cvt_pk_bf16_f32 v129, v50, v51
    v_cvt_pk_bf16_f32 v130, v52, v53
    v_cvt_pk_bf16_f32 v131, v54, v55
    v_cvt_pk_bf16_f32 v132, v56, v57
    v_cvt_pk_bf16_f32 v133, v58, v59
    buffer_load_dwordx4 v5, s[32:35], s66 offen offset:3072 lds
    v_cvt_pk_bf16_f32 v134, v60, v61
    v_cvt_pk_bf16_f32 v135, v62, v63
    v_mfma_f32_32x32x16_bf16 v[96:111], a[104:107], v[128:131], v[96:111]
    s_nop 0
    v_mfma_f32_32x32x16_bf16 v[96:111], a[108:111], v[132:135], v[96:111]
    v_mfma_f32_32x32x16_bf16 v[32:47], a[44:47], a[4:7], 0
    v_mfma_f32_32x32x16_bf16 v[48:63], a[24:27], a[4:7], 0
    s_nop 9
    v_subrev_u32 v11, 0x2b800000, v104
    v_cmp_le_u32 vcc, 0x23000000, v11
    s_nop 0
    s_cbranch_vccnz Lfb_4_0
Lfr_4_0:
    v_rcp_f32 v11, v104
    s_nop 0
    v_mul_f32 v96, v96, v11
    v_mul_f32 v97, v97, v11
    v_and_b32 v96, v12, v96
    v_mul_f32 v98, v98, v11
    v_mul_f32 v99, v99, v11
    v_mul_f32 v100, v100, v11
    v_mul_f32 v101, v101, v11
    v_mul_f32 v102, v102, v11
    v_mul_f32 v103, v103, v11
    v_cvt_pk_bf16_f32 v104, v96, v97
    v_cvt_pk_bf16_f32 v105, v98, v99
    v_cvt_pk_bf16_f32 v106, v100, v101
    v_cvt_pk_bf16_f32 v107, v102, v103
    v_or_b32 v104, v9, v104
    buffer_store_dwordx4 v[104:107], v14, s[40:43], s60 offen sc1
    s_lshl_b32 s58, s56, 16
    s_lshl_b32 s59, s52, 14
    s_add_u32 s58, s58, s59
    s_lshl_b32 s59, s57, 7
    s_add_u32 s58, s58, s59
    v_lshrrev_b32 v250, 3, v1
    v_and_b32 v251, 7, v1
    v_lshlrev_b32 v252, 4, v251
    v_lshl_add_u32 v252, v250, 10, v252
    v_add_u32 v253, 8192, v252
    buffer_load_dwordx4 v[240:243], v252, s[24:27], s58 offen
    v_cndmask_b32 v64, v8, v32, s[70:71]
    v_cndmask_b32 v65, v8, v33, s[72:73]
    v_cndmask_b32 v66, v8, v34, s[74:75]
    v_cndmask_b32 v67, v8, v35, s[76:77]
    v_cndmask_b32 v68, v8, v36, s[78:79]
    v_cndmask_b32 v69, v8, v37, s[80:81]
    v_cndmask_b32 v70, v8, v38, s[82:83]
    v_cndmask_b32 v71, v8, v39, s[84:85]
    v_cndmask_b32 v72, v8, v40, s[86:87]
    v_cndmask_b32 v73, v8, v41, s[88:89]
    v_cndmask_b32 v74, v8, v42, s[90:91]
    v_cndmask_b32 v75, v8, v43, s[92:93]
    v_cndmask_b32 v76, v8, v44, s[94:95]
    v_cndmask_b32 v77, v8, v45, s[96:97]
    v_cndmask_b32 v78, v8, v46, s[98:99]
    v_cndmask_b32 v79, v8, v47, s[100:101]
    v_mfma_f32_32x32x16_bf16 v[16:31], a[28:31], a[4:7], 0
    v_exp_f32 v64, v64
    v_exp_f32 v65, v65
    v_exp_f32 v66, v66
    buffer_load_dwordx4 v[244:247], v253, s[24:27], s58 offen
    v_exp_f32 v67, v67
    v_exp_f32 v68, v68
    v_exp_f32 v69, v69
    v_exp_f32 v70, v70
    v_exp_f32 v71, v71
    v_exp_f32 v72, v72
    v_exp_f32 v73, v73
    v_exp_f32 v74, v74
    v_exp_f32 v75, v75
    v_exp_f32 v76, v76
    v_exp_f32 v77, v77
    s_add_u32 m0, s20, 12288
    s_add_u32 s66, s66, 32768
    buffer_load_dwordx4 v2, s[32:35], s66 offen offset:0 lds
    v_exp_f32 v78, v78
    v_exp_f32 v79, v79
    v_cvt_pk_bf16_f32 v128, v64, v65
    v_cvt_pk_bf16_f32 v129, v66, v67
    v_cvt_pk_bf16_f32 v130, v68, v69
    v_cvt_pk_bf16_f32 v131, v70, v71
    v_cvt_pk_bf16_f32 v132, v72, v73
    v_cvt_pk_bf16_f32 v133, v74, v75
    v_cvt_pk_bf16_f32 v134, v76, v77
    v_cvt_pk_bf16_f32 v135, v78, v79
    v_mfma_f32_32x32x16_bf16 v[112:127], a[120:123], v[128:131], 0
    v_exp_f32 v48, v48
    v_exp_f32 v49, v49
    v_exp_f32 v50, v50
    v_exp_f32 v51, v51
    v_mfma_f32_32x32x16_bf16 v[112:127], a[124:127], v[132:135], v[112:127]
    buffer_load_dwordx4 v3, s[32:35], s66 offen offset:1024 lds
    v_exp_f32 v52, v52
    v_exp_f32 v53, v53
    v_exp_f32 v54, v54
    v_exp_f32 v55, v55
    v_mfma_f32_32x32x16_bf16 v[32:47], a[32:35], a[4:7], 0
    v_exp_f32 v56, v56
    v_exp_f32 v57, v57
    v_exp_f32 v58, v58
    v_exp_f32 v59, v59
    v_exp_f32 v60, v60
    v_exp_f32 v61, v61
    buffer_load_dwordx4 v4, s[32:35], s66 offen offset:2048 lds
    v_exp_f32 v62, v62
    v_exp_f32 v63, v63
    v_cvt_pk_bf16_f32 v128, v48, v49
    v_cvt_pk_bf16_f32 v129, v50, v51
    v_cvt_pk_bf16_f32 v130, v52, v53
    v_cvt_pk_bf16_f32 v131, v54, v55
    v_cvt_pk_bf16_f32 v132, v56, v57
    v_cvt_pk_bf16_f32 v133, v58, v59
    v_cvt_pk_bf16_f32 v134, v60, v61
    v_cvt_pk_bf16_f32 v135, v62, v63
    v_mfma_f32_32x32x16_bf16 v[112:127], a[80:83], v[128:131], v[112:127]
    v_exp_f32 v16, v16
    v_exp_f32 v17, v17
    v_exp_f32 v18, v18
    v_exp_f32 v19, v19
    v_mfma_f32_32x32x16_bf16 v[112:127], a[84:87], v[132:135], v[112:127]
    buffer_load_dwordx4 v5, s[32:35], s66 offen offset:3072 lds
    v_exp_f32 v20, v20
    v_exp_f32 v21, v21
    v_exp_f32 v22, v22
    v_exp_f32 v23, v23
    v_mfma_f32_32x32x16_bf16 v[48:63], a[36:39], a[4:7], 0
    v_exp_f32 v24, v24
    v_exp_f32 v25, v25
    v_exp_f32 v26, v26
    v_exp_f32 v27, v27
    v_exp_f32 v28, v28
    v_exp_f32 v29, v29
    buffer_load_dword v254, v15, s[40:43], 0 offen sc1
    v_exp_f32 v30, v30
    v_exp_f32 v31, v31
    v_cvt_pk_bf16_f32 v128, v16, v17
    v_cvt_pk_bf16_f32 v129, v18, v19
    v_cvt_pk_bf16_f32 v130, v20, v21
    v_cvt_pk_bf16_f32 v131, v22, v23
    v_cvt_pk_bf16_f32 v132, v24, v25
    v_cvt_pk_bf16_f32 v133, v26, v27
    v_cvt_pk_bf16_f32 v134, v28, v29
    v_cvt_pk_bf16_f32 v135, v30, v31
    v_mfma_f32_32x32x16_bf16 v[112:127], a[88:91], v[128:131], v[112:127]
    v_exp_f32 v32, v32
    v_exp_f32 v33, v33
    v_exp_f32 v34, v34
    v_exp_f32 v35, v35
    v_mfma_f32_32x32x16_bf16 v[112:127], a[92:95], v[132:135], v[112:127]
    v_exp_f32 v36, v36
    v_exp_f32 v37, v37
    v_exp_f32 v38, v38
    v_exp_f32 v39, v39
    v_mfma_f32_32x32x16_bf16 v[16:31], a[40:43], a[4:7], 0
    v_exp_f32 v40, v40
    v_exp_f32 v41, v41
    v_exp_f32 v42, v42
    v_exp_f32 v43, v43
    v_exp_f32 v44, v44
    v_exp_f32 v45, v45
    v_exp_f32 v46, v46
    v_exp_f32 v47, v47
    v_cvt_pk_bf16_f32 v128, v32, v33
    v_cvt_pk_bf16_f32 v129, v34, v35
    v_cvt_pk_bf16_f32 v130, v36, v37
    v_cvt_pk_bf16_f32 v131, v38, v39
    v_cvt_pk_bf16_f32 v132, v40, v41
    v_cvt_pk_bf16_f32 v133, v42, v43
    v_cvt_pk_bf16_f32 v134, v44, v45
    v_cvt_pk_bf16_f32 v135, v46, v47
    s_waitcnt vmcnt(0)
    v_cmp_ne_u32 vcc, s48, v254
    s_nop 0
    s_cbranch_vccnz Lsp_11_4
Lok_12_4:
    buffer_load_dwordx4 a[128:131], v88, s[40:43], s65 offen offset:0 sc1
    v_mfma_f32_32x32x16_bf16 v[112:127], a[96:99], v[128:131], v[112:127]
    v_exp_f32 v48, v48
    v_exp_f32 v49, v49
    v_exp_f32 v50, v50
    buffer_load_dwordx4 a[132:135], v89, s[40:43], s65 offen offset:0 sc1
    v_exp_f32 v51, v51
    v_mfma_f32_32x32x16_bf16 v[112:127], a[100:103], v[132:135], v[112:127]
    v_exp_f32 v52, v52
    v_exp_f32 v53, v53
    buffer_load_dwordx4 a[136:139], v90, s[40:43], s65 offen offset:0 sc1
    v_exp_f32 v54, v54
    v_exp_f32 v55, v55
    v_exp_f32 v56, v56
    v_exp_f32 v57, v57
    buffer_load_dwordx4 a[140:143], v91, s[40:43], s65 offen offset:0 sc1
    v_exp_f32 v58, v58
    v_exp_f32 v59, v59
    v_exp_f32 v60, v60
    v_exp_f32 v61, v61
    buffer_load_dwordx4 a[144:147], v88, s[40:43], s65 offen offset:1024 sc1
    v_exp_f32 v62, v62
    v_exp_f32 v63, v63
    v_cvt_pk_bf16_f32 v128, v48, v49
    v_cvt_pk_bf16_f32 v129, v50, v51
    v_cvt_pk_bf16_f32 v130, v52, v53
    buffer_load_dwordx4 a[148:151], v89, s[40:43], s65 offen offset:1024 sc1
    v_cvt_pk_bf16_f32 v131, v54, v55
    v_cvt_pk_bf16_f32 v132, v56, v57
    v_cvt_pk_bf16_f32 v133, v58, v59
    v_cvt_pk_bf16_f32 v134, v60, v61
    v_cvt_pk_bf16_f32 v135, v62, v63
    v_mfma_f32_32x32x16_bf16 v[112:127], a[104:107], v[128:131], v[112:127]
    buffer_load_dwordx4 a[152:155], v90, s[40:43], s65 offen offset:1024 sc1
    v_exp_f32 v16, v16
    v_exp_f32 v17, v17
    v_exp_f32 v18, v18
    v_exp_f32 v19, v19
    buffer_load_dwordx4 a[156:159], v91, s[40:43], s65 offen offset:1024 sc1
    v_mfma_f32_32x32x16_bf16 v[112:127], a[108:111], v[132:135], v[112:127]
    v_exp_f32 v20, v20
    v_exp_f32 v21, v21
    v_exp_f32 v22, v22
    buffer_load_dwordx4 a[160:163], v88, s[40:43], s65 offen offset:2048 sc1
    v_exp_f32 v23, v23
    v_exp_f32 v24, v24
    v_exp_f32 v25, v25
    v_exp_f32 v26, v26
    buffer_load_dwordx4 a[164:167], v89, s[40:43], s65 offen offset:2048 sc1
    v_exp_f32 v27, v27
    v_exp_f32 v28, v28
    v_exp_f32 v29, v29
    v_exp_f32 v30, v30
    buffer_load_dwordx4 a[168:171], v90, s[40:43], s65 offen offset:2048 sc1
    v_exp_f32 v31, v31
    v_cvt_pk_bf16_f32 v128, v16, v17
    v_cvt_pk_bf16_f32 v129, v18, v19
    v_cvt_pk_bf16_f32 v130, v20, v21
    v_cvt_pk_bf16_f32 v131, v22, v23
    v_cvt_pk_bf16_f32 v132, v24, v25
    buffer_load_dwordx4 a[172:175], v91, s[40:43], s65 offen offset:2048 sc1
    v_cvt_pk_bf16_f32 v133, v26, v27
    v_cvt_pk_bf16_f32 v134, v28, v29
    v_cvt_pk_bf16_f32 v135, v30, v31
    v_mfma_f32_32x32x16_bf16 v[112:127], a[112:115], v[128:131], v[112:127]
    s_nop 0
    v_mfma_f32_32x32x16_bf16 v[112:127], a[116:119], v[132:135], v[112:127]
    s_nop 11
    v_subrev_u32 v11, 0x2b800000, v120
    v_cmp_le_u32 vcc, 0x23000000, v11
    s_nop 0
    s_cbranch_vccnz Lfb_4_1
Lfr_4_1:
    s_add_u32 s60, s60, 98304
    v_rcp_f32 v11, v120
    s_nop 0
    v_mul_f32 v112, v112, v11
    v_mul_f32 v113, v113, v11
    v_and_b32 v112, v12, v112
    v_mul_f32 v114, v114, v11
    v_mul_f32 v115, v115, v11
    v_mul_f32 v116, v116, v11
    v_mul_f32 v117, v117, v11
    v_mul_f32 v118, v118, v11
    v_mul_f32 v119, v119, v11
    v_cvt_pk_bf16_f32 v120, v112, v113
    v_cvt_pk_bf16_f32 v121, v114, v115
    v_cvt_pk_bf16_f32 v122, v116, v117
    v_cvt_pk_bf16_f32 v123, v118, v119
    v_or_b32 v120, v9, v120
    buffer_store_dwordx4 v[120:123], v14, s[40:43], s60 offen sc1
    s_branch Lp3_17
Lat6_14:
    v_mfma_f32_32x32x16_bf16 v[32:47], a[40:43], a[0:3], 0
    v_mfma_f32_32x32x16_bf16 v[48:63], a[32:35], a[0:3], 0
    ds_read_b64_tr_b16 v[144:145], v92 offset:0
    s_nop 9
    v_cndmask_b32 v64, v8, v32, s[70:71]
    v_cndmask_b32 v65, v8, v33, s[72:73]
    ds_read_b64_tr_b16 v[146:147], v92 offset:2048
    v_cndmask_b32 v66, v8, v34, s[74:75]
    v_cndmask_b32 v67, v8, v35, s[76:77]
    ds_read_b64_tr_b16 v[148:149], v93 offset:0
    v_cndmask_b32 v68, v8, v36, s[78:79]
    v_cndmask_b32 v69, v8, v37, s[80:81]
    ds_read_b64_tr_b16 v[150:151], v93 offset:2048
    v_cndmask_b32 v70, v8, v38, s[82:83]
    v_cndmask_b32 v71, v8, v39, s[84:85]
    ds_read_b64_tr_b16 v[152:153], v94 offset:0
    v_cndmask_b32 v72, v8, v40, s[86:87]
    v_cndmask_b32 v73, v8, v41, s[88:89]
    ds_read_b64_tr_b16 v[154:155], v94 offset:2048
    v_cndmask_b32 v74, v8, v42, s[90:91]
    v_cndmask_b32 v75, v8, v43, s[92:93]
    ds_read_b64_tr_b16 v[156:157], v95 offset:0
    v_cndmask_b32 v76, v8, v44, s[94:95]
    v_cndmask_b32 v77, v8, v45, s[96:97]
    ds_read_b64_tr_b16 v[158:159], v95 offset:2048
    v_cndmask_b32 v78, v8, v46, s[98:99]
    v_cndmask_b32 v79, v8, v47, s[100:101]
    ds_read_b64_tr_b16 v[208:209], v92 offset:4096
    v_mfma_f32_32x32x16_bf16 v[16:31], a[36:39], a[0:3], 0
    ds_read_b64_tr_b16 v[210:211], v92 offset:6144
    v_exp_f32 v64, v64
    ds_read_b64_tr_b16 v[212:213], v93 offset:4096
    v_exp_f32 v65, v65
    ds_read_b64_tr_b16 v[214:215], v93 offset:6144
    v_exp_f32 v66, v66
    ds_read_b64_tr_b16 v[216:217], v94 offset:4096
    v_exp_f32 v67, v67
    ds_read_b64_tr_b16 v[218:219], v94 offset:6144
    v_exp_f32 v68, v68
    ds_read_b64_tr_b16 v[220:221], v95 offset:4096
    v_exp_f32 v69, v69
    ds_read_b64_tr_b16 v[222:223], v95 offset:6144
    v_exp_f32 v70, v70
    ds_read_b64_tr_b16 v[224:225], v92 offset:8192
    v_exp_f32 v71, v71
    ds_read_b64_tr_b16 v[226:227], v92 offset:10240
    v_exp_f32 v72, v72
    ds_read_b64_tr_b16 v[228:229], v93 offset:8192
    v_exp_f32 v73, v73
    ds_read_b64_tr_b16 v[230:231], v93 offset:10240
    v_exp_f32 v74, v74
    ds_read_b64_tr_b16 v[232:233], v94 offset:8192
    v_exp_f32 v75, v75
    ds_read_b64_tr_b16 v[234:235], v94 offset:10240
    v_exp_f32 v76, v76
    ds_read_b64_tr_b16 v[236:237], v95 offset:8192
    ds_read_b64_tr_b16 v[238:239], v95 offset:10240
    v_exp_f32 v77, v77
    ds_read_b64_tr_b16 v[192:193], v92 offset:12288
    v_exp_f32 v78, v78
    ds_read_b64_tr_b16 v[194:195], v92 offset:14336
    v_exp_f32 v79, v79
    ds_read_b64_tr_b16 v[196:197], v93 offset:12288
    v_cvt_pk_bf16_f32 v128, v64, v65
    v_cvt_pk_bf16_f32 v129, v66, v67
    ds_read_b64_tr_b16 v[198:199], v93 offset:14336
    v_cvt_pk_bf16_f32 v130, v68, v69
    v_cvt_pk_bf16_f32 v131, v70, v71
    ds_read_b64_tr_b16 v[200:201], v94 offset:12288
    v_cvt_pk_bf16_f32 v132, v72, v73
    v_cvt_pk_bf16_f32 v133, v74, v75
    ds_read_b64_tr_b16 v[202:203], v94 offset:14336
    v_cvt_pk_bf16_f32 v134, v76, v77
    v_cvt_pk_bf16_f32 v135, v78, v79
    ds_read_b64_tr_b16 v[204:205], v95 offset:12288
    v_mfma_f32_32x32x16_bf16 v[96:111], a[112:115], v[128:131], 0
    ds_read_b64_tr_b16 v[206:207], v95 offset:14336
    v_exp_f32 v48, v48
    s_add_u32 m0, s21, 0
    s_add_u32 s66, s66, 32768
    buffer_load_dwordx4 v2, s[36:39], s66 offen offset:0 lds
    v_exp_f32 v49, v49
    v_exp_f32 v50, v50
    v_exp_f32 v51, v51
    v_mfma_f32_32x32x16_bf16 v[96:111], a[116:119], v[132:135], v[96:111]
    v_exp_f32 v52, v52
    buffer_load_dwordx4 v3, s[36:39], s66 offen offset:1024 lds
    v_exp_f32 v53, v53
    v_exp_f32 v54, v54
    v_exp_f32 v55, v55
    v_exp_f32 v56, v56
    v_exp_f32 v57, v57
    buffer_load_dwordx4 v4, s[36:39], s66 offen offset:2048 lds
    v_exp_f32 v58, v58
    v_exp_f32 v59, v59
    v_exp_f32 v60, v60
    v_exp_f32 v61, v61
    v_exp_f32 v62, v62
    buffer_load_dwordx4 v5, s[36:39], s66 offen offset:3072 lds
    v_exp_f32 v63, v63
    v_cvt_pk_bf16_f32 v128, v48, v49
    v_cvt_pk_bf16_f32 v129, v50, v51
    v_cvt_pk_bf16_f32 v130, v52, v53
    v_cvt_pk_bf16_f32 v131, v54, v55
    v_cvt_pk_bf16_f32 v132, v56, v57
    v_cvt_pk_bf16_f32 v133, v58, v59
    v_cvt_pk_bf16_f32 v134, v60, v61
    v_cvt_pk_bf16_f32 v135, v62, v63
    s_lshl2_add_u32 s3, s53, s52
    s_lshl4_add_u32 s3, s3, s54
    s_lshl_b32 s3, s3, 7
    s_add_u32 s3, s3, 15794176
    s_waitcnt vmcnt(4)
    v_mov_b32 v7, s48
    s_mov_b64 exec, 1
    buffer_store_dword v7, off, s[40:43], s3 sc1
    s_mov_b64 exec, -1
    s_add_u32 m0, s21, 4096
    s_add_u32 s66, s66, 32768
    buffer_load_dwordx4 v2, s[36:39], s66 offen offset:0 lds
    v_mfma_f32_32x32x16_bf16 v[96:111], a[96:99], v[128:131], v[96:111]
    v_exp_f32 v16, v16
    buffer_load_dwordx4 v3, s[36:39], s66 offen offset:1024 lds
    v_exp_f32 v17, v17
    buffer_load_dwordx4 v4, s[36:39], s66 offen offset:2048 lds
    v_exp_f32 v18, v18
    buffer_load_dwordx4 v5, s[36:39], s66 offen offset:3072 lds
    v_exp_f32 v19, v19
    s_add_u32 m0, s21, 8192
    s_add_u32 s66, s66, 32768
    buffer_load_dwordx4 v2, s[36:39], s66 offen offset:0 lds
    v_mfma_f32_32x32x16_bf16 v[96:111], a[100:103], v[132:135], v[96:111]
    buffer_load_dwordx4 v3, s[36:39], s66 offen offset:1024 lds
    v_exp_f32 v20, v20
    v_exp_f32 v21, v21
    buffer_load_dwordx4 v4, s[36:39], s66 offen offset:2048 lds
    v_exp_f32 v22, v22
    buffer_load_dwordx4 v5, s[36:39], s66 offen offset:3072 lds
    v_exp_f32 v23, v23
    s_waitcnt lgkmcnt(0)
    v_exp_f32 v24, v24
    s_add_u32 m0, s20, 0
    s_add_u32 s66, s66, 32768
    buffer_load_dwordx4 v2, s[28:31], s66 offen offset:0 lds
    v_exp_f32 v25, v25
    buffer_load_dwordx4 v3, s[28:31], s66 offen offset:1024 lds
    v_exp_f32 v26, v26
    buffer_load_dwordx4 v4, s[28:31], s66 offen offset:2048 lds
    v_exp_f32 v27, v27
    v_exp_f32 v28, v28
    buffer_load_dwordx4 v5, s[28:31], s66 offen offset:3072 lds
    v_exp_f32 v29, v29
    s_add_u32 m0, s20, 4096
    s_lshl_b32 s66, s52, 17
    buffer_load_dwordx4 v2, s[32:35], s66 offen offset:0 lds
    v_exp_f32 v30, v30
    buffer_load_dwordx4 v3, s[32:35], s66 offen offset:1024 lds
    v_exp_f32 v31, v31
    buffer_load_dwordx4 v4, s[32:35], s66 offen offset:2048 lds
    v_cvt_pk_bf16_f32 v128, v16, v17
    buffer_load_dwordx4 v5, s[32:35], s66 offen offset:3072 lds
    v_cvt_pk_bf16_f32 v129, v18, v19
    v_cvt_pk_bf16_f32 v130, v20, v21
    v_cvt_pk_bf16_f32 v131, v22, v23
    s_add_u32 m0, s20, 8192
    s_add_u32 s66, s66, 32768
    buffer_load_dwordx4 v2, s[32:35], s66 offen offset:0 lds
    v_cvt_pk_bf16_f32 v132, v24, v25
    v_cvt_pk_bf16_f32 v133, v26, v27
    buffer_load_dwordx4 v3, s[32:35], s66 offen offset:1024 lds
    v_cvt_pk_bf16_f32 v134, v28, v29
    v_cvt_pk_bf16_f32 v135, v30, v31
    buffer_load_dwordx4 v4, s[32:35], s66 offen offset:2048 lds
    v_mfma_f32_32x32x16_bf16 v[96:111], a[104:107], v[128:131], v[96:111]
    buffer_load_dwordx4 v5, s[32:35], s66 offen offset:3072 lds
    v_mfma_f32_32x32x16_bf16 v[96:111], a[108:111], v[132:135], v[96:111]
    v_mfma_f32_32x32x16_bf16 v[32:47], a[44:47], a[4:7], 0
    v_mfma_f32_32x32x16_bf16 v[48:63], a[32:35], a[4:7], 0
    s_nop 9
    v_subrev_u32 v11, 0x2b800000, v104
    v_cmp_le_u32 vcc, 0x23000000, v11
    s_nop 0
    s_cbranch_vccnz Lfb_6_0
Lfr_6_0:
    v_rcp_f32 v11, v104
    s_nop 0
    v_mul_f32 v96, v96, v11
    v_mul_f32 v97, v97, v11
    v_and_b32 v96, v12, v96
    v_mul_f32 v98, v98, v11
    v_mul_f32 v99, v99, v11
    v_mul_f32 v100, v100, v11
    v_mul_f32 v101, v101, v11
    v_mul_f32 v102, v102, v11
    v_mul_f32 v103, v103, v11
    v_cvt_pk_bf16_f32 v104, v96, v97
    v_cvt_pk_bf16_f32 v105, v98, v99
    v_cvt_pk_bf16_f32 v106, v100, v101
    v_cvt_pk_bf16_f32 v107, v102, v103
    v_or_b32 v104, v9, v104
    buffer_store_dwordx4 v[104:107], v14, s[40:43], s60 offen sc1
    s_lshl_b32 s58, s56, 16
    s_lshl_b32 s59, s52, 14
    s_add_u32 s58, s58, s59
    s_lshl_b32 s59, s57, 7
    s_add_u32 s58, s58, s59
    v_lshrrev_b32 v250, 3, v1
    v_and_b32 v251, 7, v1
    v_lshlrev_b32 v252, 4, v251
    v_lshl_add_u32 v252, v250, 10, v252
    v_add_u32 v253, 8192, v252
    buffer_load_dwordx4 v[240:243], v252, s[24:27], s58 offen
    v_cndmask_b32 v64, v8, v32, s[70:71]
    v_cndmask_b32 v65, v8, v33, s[72:73]
    v_cndmask_b32 v66, v8, v34, s[74:75]
    v_cndmask_b32 v67, v8, v35, s[76:77]
    v_cndmask_b32 v68, v8, v36, s[78:79]
    v_cndmask_b32 v69, v8, v37, s[80:81]
    v_cndmask_b32 v70, v8, v38, s[82:83]
    v_cndmask_b32 v71, v8, v39, s[84:85]
    v_cndmask_b32 v72, v8, v40, s[86:87]
    v_cndmask_b32 v73, v8, v41, s[88:89]
    v_cndmask_b32 v74, v8, v42, s[90:91]
    v_cndmask_b32 v75, v8, v43, s[92:93]
    v_cndmask_b32 v76, v8, v44, s[94:95]
    v_cndmask_b32 v77, v8, v45, s[96:97]
    v_cndmask_b32 v78, v8, v46, s[98:99]
    v_cndmask_b32 v79, v8, v47, s[100:101]
    v_mfma_f32_32x32x16_bf16 v[16:31], a[36:39], a[4:7], 0
    v_exp_f32 v64, v64
    v_exp_f32 v65, v65
    v_exp_f32 v66, v66
    buffer_load_dwordx4 v[244:247], v253, s[24:27], s58 offen
    v_exp_f32 v67, v67
    v_exp_f32 v68, v68
    v_exp_f32 v69, v69
    v_exp_f32 v70, v70
    v_exp_f32 v71, v71
    v_exp_f32 v72, v72
    v_exp_f32 v73, v73
    v_exp_f32 v74, v74
    v_exp_f32 v75, v75
    v_exp_f32 v76, v76
    v_exp_f32 v77, v77
    s_add_u32 m0, s20, 12288
    s_add_u32 s66, s66, 32768
    buffer_load_dwordx4 v2, s[32:35], s66 offen offset:0 lds
    v_exp_f32 v78, v78
    v_exp_f32 v79, v79
    v_cvt_pk_bf16_f32 v128, v64, v65
    v_cvt_pk_bf16_f32 v129, v66, v67
    v_cvt_pk_bf16_f32 v130, v68, v69
    v_cvt_pk_bf16_f32 v131, v70, v71
    v_cvt_pk_bf16_f32 v132, v72, v73
    v_cvt_pk_bf16_f32 v133, v74, v75
    v_cvt_pk_bf16_f32 v134, v76, v77
    v_cvt_pk_bf16_f32 v135, v78, v79
    v_mfma_f32_32x32x16_bf16 v[112:127], a[120:123], v[128:131], 0
    v_exp_f32 v48, v48
    v_exp_f32 v49, v49
    v_exp_f32 v50, v50
    v_exp_f32 v51, v51
    buffer_load_dwordx4 v3, s[32:35], s66 offen offset:1024 lds
    v_mfma_f32_32x32x16_bf16 v[112:127], a[124:127], v[132:135], v[112:127]
    v_exp_f32 v52, v52
    v_exp_f32 v53, v53
    v_exp_f32 v54, v54
    v_exp_f32 v55, v55
    v_mfma_f32_32x32x16_bf16 v[32:47], a[40:43], a[4:7], 0
    v_exp_f32 v56, v56
    v_exp_f32 v57, v57
    v_exp_f32 v58, v58
    v_exp_f32 v59, v59
    v_exp_f32 v60, v60
    buffer_load_dwordx4 v4, s[32:35], s66 offen offset:2048 lds
    v_exp_f32 v61, v61
    v_exp_f32 v62, v62
    v_exp_f32 v63, v63
    v_cvt_pk_bf16_f32 v128, v48, v49
    v_cvt_pk_bf16_f32 v129, v50, v51
    v_cvt_pk_bf16_f32 v130, v52, v53
    v_cvt_pk_bf16_f32 v131, v54, v55
    v_cvt_pk_bf16_f32 v132, v56, v57
    v_cvt_pk_bf16_f32 v133, v58, v59
    v_cvt_pk_bf16_f32 v134, v60, v61
    v_cvt_pk_bf16_f32 v135, v62, v63
    v_mfma_f32_32x32x16_bf16 v[112:127], a[96:99], v[128:131], v[112:127]
    v_exp_f32 v16, v16
    v_exp_f32 v17, v17
    v_exp_f32 v18, v18
    buffer_load_dwordx4 v5, s[32:35], s66 offen offset:3072 lds
    v_exp_f32 v19, v19
    v_mfma_f32_32x32x16_bf16 v[112:127], a[100:103], v[132:135], v[112:127]
    v_exp_f32 v20, v20
    v_exp_f32 v21, v21
    v_exp_f32 v22, v22
    v_exp_f32 v23, v23
    v_exp_f32 v24, v24
    v_exp_f32 v25, v25
    v_exp_f32 v26, v26
    v_exp_f32 v27, v27
    v_exp_f32 v28, v28
    v_exp_f32 v29, v29
    buffer_load_dword v254, v15, s[40:43], 0 offen sc1
    v_exp_f32 v30, v30
    v_exp_f32 v31, v31
    v_cvt_pk_bf16_f32 v128, v16, v17
    v_cvt_pk_bf16_f32 v129, v18, v19
    v_cvt_pk_bf16_f32 v130, v20, v21
    v_cvt_pk_bf16_f32 v131, v22, v23
    v_cvt_pk_bf16_f32 v132, v24, v25
    v_cvt_pk_bf16_f32 v133, v26, v27
    v_cvt_pk_bf16_f32 v134, v28, v29
    v_cvt_pk_bf16_f32 v135, v30, v31
    v_mfma_f32_32x32x16_bf16 v[112:127], a[104:107], v[128:131], v[112:127]
    v_exp_f32 v32, v32
    v_exp_f32 v33, v33
    v_exp_f32 v34, v34
    v_exp_f32 v35, v35
    v_mfma_f32_32x32x16_bf16 v[112:127], a[108:111], v[132:135], v[112:127]
    v_exp_f32 v36, v36
    v_exp_f32 v37, v37
    v_exp_f32 v38, v38
    v_exp_f32 v39, v39
    v_exp_f32 v40, v40
    v_exp_f32 v41, v41
    v_exp_f32 v42, v42
    v_exp_f32 v43, v43
    v_exp_f32 v44, v44
    v_exp_f32 v45, v45
    v_exp_f32 v46, v46
    v_exp_f32 v47, v47
    v_cvt_pk_bf16_f32 v128, v32, v33
    v_cvt_pk_bf16_f32 v129, v34, v35
    v_cvt_pk_bf16_f32 v130, v36, v37
    v_cvt_pk_bf16_f32 v131, v38, v39
    v_cvt_pk_bf16_f32 v132, v40, v41
    v_cvt_pk_bf16_f32 v133, v42, v43
    v_cvt_pk_bf16_f32 v134, v44, v45
    v_cvt_pk_bf16_f32 v135, v46, v47
    s_waitcnt vmcnt(0)
    v_cmp_ne_u32 vcc, s48, v254
    s_nop 0
    s_cbranch_vccnz Lsp_11_6
Lok_12_6:
    buffer_load_dwordx4 a[128:131], v88, s[40:43], s65 offen offset:0 sc1
    v_mfma_f32_32x32x16_bf16 v[112:127], a[112:115], v[128:131], v[112:127]
    buffer_load_dwordx4 a[132:135], v89, s[40:43], s65 offen offset:0 sc1
    buffer_load_dwordx4 a[136:139], v90, s[40:43], s65 offen offset:0 sc1
    buffer_load_dwordx4 a[140:143], v91, s[40:43], s65 offen offset:0 sc1
    buffer_load_dwordx4 a[144:147], v88, s[40:43], s65 offen offset:1024 sc1
    buffer_load_dwordx4 a[148:151], v89, s[40:43], s65 offen offset:1024 sc1
    buffer_load_dwordx4 a[152:155], v90, s[40:43], s65 offen offset:1024 sc1
    v_mfma_f32_32x32x16_bf16 v[112:127], a[116:119], v[132:135], v[112:127]
    buffer_load_dwordx4 a[156:159], v91, s[40:43], s65 offen offset:1024 sc1
    buffer_load_dwordx4 a[160:163], v88, s[40:43], s65 offen offset:2048 sc1
    buffer_load_dwordx4 a[164:167], v89, s[40:43], s65 offen offset:2048 sc1
    buffer_load_dwordx4 a[168:171], v90, s[40:43], s65 offen offset:2048 sc1
    buffer_load_dwordx4 a[172:175], v91, s[40:43], s65 offen offset:2048 sc1
    s_nop 6
    v_subrev_u32 v11, 0x2b800000, v120
    v_cmp_le_u32 vcc, 0x23000000, v11
    s_nop 0
    s_cbranch_vccnz Lfb_6_1
Lfr_6_1:
    s_add_u32 s60, s60, 98304
    v_rcp_f32 v11, v120
    s_nop 0
    v_mul_f32 v112, v112, v11
    v_mul_f32 v113, v113, v11
    v_and_b32 v112, v12, v112
    v_mul_f32 v114, v114, v11
    v_mul_f32 v115, v115, v11
    v_mul_f32 v116, v116, v11
    v_mul_f32 v117, v117, v11
    v_mul_f32 v118, v118, v11
    v_mul_f32 v119, v119, v11
    v_cvt_pk_bf16_f32 v120, v112, v113
    v_cvt_pk_bf16_f32 v121, v114, v115
    v_cvt_pk_bf16_f32 v122, v116, v117
    v_cvt_pk_bf16_f32 v123, v118, v119
    v_or_b32 v120, v9, v120
    buffer_store_dwordx4 v[120:123], v14, s[40:43], s60 offen sc1
    s_branch Lp3_17
Lat8_13:
    v_mfma_f32_32x32x16_bf16 v[32:47], a[40:43], a[0:3], 0
    ds_read_b64_tr_b16 v[144:145], v92 offset:0
    s_nop 10
    v_cndmask_b32 v64, v8, v32, s[70:71]
    v_cndmask_b32 v65, v8, v33, s[72:73]
    ds_read_b64_tr_b16 v[146:147], v92 offset:2048
    v_cndmask_b32 v66, v8, v34, s[74:75]
    ds_read_b64_tr_b16 v[148:149], v93 offset:0
    v_cndmask_b32 v67, v8, v35, s[76:77]
    ds_read_b64_tr_b16 v[150:151], v93 offset:2048
    v_cndmask_b32 v68, v8, v36, s[78:79]
    ds_read_b64_tr_b16 v[152:153], v94 offset:0
    v_cndmask_b32 v69, v8, v37, s[80:81]
    ds_read_b64_tr_b16 v[154:155], v94 offset:2048
    v_cndmask_b32 v70, v8, v38, s[82:83]
    ds_read_b64_tr_b16 v[156:157], v95 offset:0
    v_cndmask_b32 v71, v8, v39, s[84:85]
    ds_read_b64_tr_b16 v[158:159], v95 offset:2048
    v_cndmask_b32 v72, v8, v40, s[86:87]
    ds_read_b64_tr_b16 v[208:209], v92 offset:4096
    v_cndmask_b32 v73, v8, v41, s[88:89]
    ds_read_b64_tr_b16 v[210:211], v92 offset:6144
    v_cndmask_b32 v74, v8, v42, s[90:91]
    ds_read_b64_tr_b16 v[212:213], v93 offset:4096
    v_cndmask_b32 v75, v8, v43, s[92:93]
    ds_read_b64_tr_b16 v[214:215], v93 offset:6144
    v_cndmask_b32 v76, v8, v44, s[94:95]
    ds_read_b64_tr_b16 v[216:217], v94 offset:4096
    v_cndmask_b32 v77, v8, v45, s[96:97]
    ds_read_b64_tr_b16 v[218:219], v94 offset:6144
    v_cndmask_b32 v78, v8, v46, s[98:99]
    ds_read_b64_tr_b16 v[220:221], v95 offset:4096
    v_cndmask_b32 v79, v8, v47, s[100:101]
    ds_read_b64_tr_b16 v[222:223], v95 offset:6144
    v_exp_f32 v64, v64
    ds_read_b64_tr_b16 v[224:225], v92 offset:8192
    ds_read_b64_tr_b16 v[226:227], v92 offset:10240
    v_exp_f32 v65, v65
    ds_read_b64_tr_b16 v[228:229], v93 offset:8192
    ds_read_b64_tr_b16 v[230:231], v93 offset:10240
    v_exp_f32 v66, v66
    ds_read_b64_tr_b16 v[232:233], v94 offset:8192
    v_exp_f32 v67, v67
    ds_read_b64_tr_b16 v[234:235], v94 offset:10240
    ds_read_b64_tr_b16 v[236:237], v95 offset:8192
    v_exp_f32 v68, v68
    ds_read_b64_tr_b16 v[238:239], v95 offset:10240
    ds_read_b64_tr_b16 v[192:193], v92 offset:12288
    v_exp_f32 v69, v69
    ds_read_b64_tr_b16 v[194:195], v92 offset:14336
    ds_read_b64_tr_b16 v[196:197], v93 offset:12288
    v_exp_f32 v70, v70
    ds_read_b64_tr_b16 v[198:199], v93 offset:14336
    ds_read_b64_tr_b16 v[200:201], v94 offset:12288
    v_exp_f32 v71, v71
    ds_read_b64_tr_b16 v[202:203], v94 offset:14336
    ds_read_b64_tr_b16 v[204:205], v95 offset:12288
    v_exp_f32 v72, v72
    ds_read_b64_tr_b16 v[206:207], v95 offset:14336
    s_add_u32 m0, s21, 0
    s_add_u32 s66, s66, 32768
    buffer_load_dwordx4 v2, s[36:39], s66 offen offset:0 lds
    v_exp_f32 v73, v73
    v_exp_f32 v74, v74
    v_exp_f32 v75, v75
    buffer_load_dwordx4 v3, s[36:39], s66 offen offset:1024 lds
    v_exp_f32 v76, v76
    v_exp_f32 v77, v77
    v_exp_f32 v78, v78
    buffer_load_dwordx4 v4, s[36:39], s66 offen offset:2048 lds
    v_exp_f32 v79, v79
    v_cvt_pk_bf16_f32 v128, v64, v65
    v_cvt_pk_bf16_f32 v129, v66, v67
    v_cvt_pk_bf16_f32 v130, v68, v69
    buffer_load_dwordx4 v5, s[36:39], s66 offen offset:3072 lds
    v_cvt_pk_bf16_f32 v131, v70, v71
    v_cvt_pk_bf16_f32 v132, v72, v73
    v_cvt_pk_bf16_f32 v133, v74, v75
    v_cvt_pk_bf16_f32 v134, v76, v77
    v_cvt_pk_bf16_f32 v135, v78, v79
    s_lshl2_add_u32 s3, s53, s52
    s_lshl4_add_u32 s3, s3, s54
    s_lshl_b32 s3, s3, 7
    s_add_u32 s3, s3, 15794176
    s_waitcnt vmcnt(4)
    v_mov_b32 v7, s48
    s_mov_b64 exec, 1
    buffer_store_dword v7, off, s[40:43], s3 sc1
    s_mov_b64 exec, -1
    s_add_u32 m0, s21, 4096
    s_add_u32 s66, s66, 32768
    buffer_load_dwordx4 v2, s[36:39], s66 offen offset:0 lds
    v_mfma_f32_32x32x16_bf16 v[96:111], a[112:115], v[128:131], 0
    buffer_load_dwordx4 v3, s[36:39], s66 offen offset:1024 lds
    buffer_load_dwordx4 v4, s[36:39], s66 offen offset:2048 lds
    buffer_load_dwordx4 v5, s[36:39], s66 offen offset:3072 lds
    s_add_u32 m0, s21, 8192
    s_add_u32 s66, s66, 32768
    buffer_load_dwordx4 v2, s[36:39], s66 offen offset:0 lds
    buffer_load_dwordx4 v3, s[36:39], s66 offen offset:1024 lds
    buffer_load_dwordx4 v4, s[36:39], s66 offen offset:2048 lds
    buffer_load_dwordx4 v5, s[36:39], s66 offen offset:3072 lds
    s_waitcnt lgkmcnt(0)
    s_add_u32 m0, s20, 0
    s_add_u32 s66, s66, 32768
    buffer_load_dwordx4 v2, s[28:31], s66 offen offset:0 lds
    buffer_load_dwordx4 v3, s[28:31], s66 offen offset:1024 lds
    v_mfma_f32_32x32x16_bf16 v[96:111], a[116:119], v[132:135], v[96:111]
    buffer_load_dwordx4 v4, s[28:31], s66 offen offset:2048 lds
    buffer_load_dwordx4 v5, s[28:31], s66 offen offset:3072 lds
    s_add_u32 m0, s20, 4096
    s_lshl_b32 s66, s52, 17
    buffer_load_dwordx4 v2, s[32:35], s66 offen offset:0 lds
    buffer_load_dwordx4 v3, s[32:35], s66 offen offset:1024 lds
    buffer_load_dwordx4 v4, s[32:35], s66 offen offset:2048 lds
    buffer_load_dwordx4 v5, s[32:35], s66 offen offset:3072 lds
    s_add_u32 m0, s20, 8192
    s_add_u32 s66, s66, 32768
    buffer_load_dwordx4 v2, s[32:35], s66 offen offset:0 lds
    buffer_load_dwordx4 v3, s[32:35], s66 offen offset:1024 lds
    buffer_load_dwordx4 v4, s[32:35], s66 offen offset:2048 lds
    buffer_load_dwordx4 v5, s[32:35], s66 offen offset:3072 lds
    v_mfma_f32_32x32x16_bf16 v[32:47], a[44:47], a[4:7], 0
    v_mfma_f32_32x32x16_bf16 v[48:63], a[40:43], a[4:7], 0
    v_subrev_u32 v11, 0x2b800000, v104
    v_cmp_le_u32 vcc, 0x23000000, v11
    s_nop 0
    s_cbranch_vccnz Lfb_8_0
Lfr_8_0:
    v_rcp_f32 v11, v104
    s_nop 0
    v_mul_f32 v96, v96, v11
    v_mul_f32 v97, v97, v11
    v_and_b32 v96, v12, v96
    v_mul_f32 v98, v98, v11
    v_mul_f32 v99, v99, v11
    v_mul_f32 v100, v100, v11
    v_mul_f32 v101, v101, v11
    v_mul_f32 v102, v102, v11
    v_mul_f32 v103, v103, v11
    v_cvt_pk_bf16_f32 v104, v96, v97
    v_cvt_pk_bf16_f32 v105, v98, v99
    v_cvt_pk_bf16_f32 v106, v100, v101
    v_cvt_pk_bf16_f32 v107, v102, v103
    v_or_b32 v104, v9, v104
    buffer_store_dwordx4 v[104:107], v14, s[40:43], s60 offen sc1
    s_lshl_b32 s58, s56, 16
    s_lshl_b32 s59, s52, 14
    s_add_u32 s58, s58, s59
    s_lshl_b32 s59, s57, 7
    s_add_u32 s58, s58, s59
    v_lshrrev_b32 v250, 3, v1
    v_and_b32 v251, 7, v1
    v_lshlrev_b32 v252, 4, v251
    v_lshl_add_u32 v252, v250, 10, v252
    v_add_u32 v253, 8192, v252
    buffer_load_dwordx4 v[240:243], v252, s[24:27], s58 offen
    v_cndmask_b32 v64, v8, v32, s[70:71]
    v_cndmask_b32 v65, v8, v33, s[72:73]
    v_cndmask_b32 v66, v8, v34, s[74:75]
    v_cndmask_b32 v67, v8, v35, s[76:77]
    v_cndmask_b32 v68, v8, v36, s[78:79]
    v_cndmask_b32 v69, v8, v37, s[80:81]
    v_cndmask_b32 v70, v8, v38, s[82:83]
    v_cndmask_b32 v71, v8, v39, s[84:85]
    v_cndmask_b32 v72, v8, v40, s[86:87]
    v_cndmask_b32 v73, v8, v41, s[88:89]
    v_cndmask_b32 v74, v8, v42, s[90:91]
    v_cndmask_b32 v75, v8, v43, s[92:93]
    buffer_load_dwordx4 v[244:247], v253, s[24:27], s58 offen
    v_cndmask_b32 v76, v8, v44, s[94:95]
    v_cndmask_b32 v77, v8, v45, s[96:97]
    v_cndmask_b32 v78, v8, v46, s[98:99]
    v_cndmask_b32 v79, v8, v47, s[100:101]
    v_exp_f32 v64, v64
    v_exp_f32 v65, v65
    v_exp_f32 v66, v66
    v_exp_f32 v67, v67
    s_add_u32 m0, s20, 12288
    s_add_u32 s66, s66, 32768
    buffer_load_dwordx4 v2, s[32:35], s66 offen offset:0 lds
    v_exp_f32 v68, v68
    v_exp_f32 v69, v69
    v_exp_f32 v70, v70
    v_exp_f32 v71, v71
    v_exp_f32 v72, v72
    v_exp_f32 v73, v73
    buffer_load_dwordx4 v3, s[32:35], s66 offen offset:1024 lds
    v_exp_f32 v74, v74
    v_exp_f32 v75, v75
    v_exp_f32 v76, v76
    v_exp_f32 v77, v77
    v_exp_f32 v78, v78
    v_exp_f32 v79, v79
    buffer_load_dwordx4 v4, s[32:35], s66 offen offset:2048 lds
    v_cvt_pk_bf16_f32 v128, v64, v65
    v_cvt_pk_bf16_f32 v129, v66, v67
    v_cvt_pk_bf16_f32 v130, v68, v69
    v_cvt_pk_bf16_f32 v131, v70, v71
    v_cvt_pk_bf16_f32 v132, v72, v73
    v_cvt_pk_bf16_f32 v133, v74, v75
    v_cvt_pk_bf16_f32 v134, v76, v77
    v_cvt_pk_bf16_f32 v135, v78, v79
    v_mfma_f32_32x32x16_bf16 v[112:127], a[120:123], v[128:131], 0
    v_exp_f32 v48, v48
    buffer_load_dwordx4 v5, s[32:35], s66 offen offset:3072 lds
    v_exp_f32 v49, v49
    v_exp_f32 v50, v50
    v_exp_f32 v51, v51
    v_mfma_f32_32x32x16_bf16 v[112:127], a[124:127], v[132:135], v[112:127]
    v_exp_f32 v52, v52
    buffer_load_dword v254, v15, s[40:43], 0 offen sc1
    v_exp_f32 v53, v53
    v_exp_f32 v54, v54
    v_exp_f32 v55, v55
    v_exp_f32 v56, v56
    v_exp_f32 v57, v57
    v_exp_f32 v58, v58
    v_exp_f32 v59, v59
    v_exp_f32 v60, v60
    v_exp_f32 v61, v61
    v_exp_f32 v62, v62
    v_exp_f32 v63, v63
    v_cvt_pk_bf16_f32 v128, v48, v49
    v_cvt_pk_bf16_f32 v129, v50, v51
    v_cvt_pk_bf16_f32 v130, v52, v53
    v_cvt_pk_bf16_f32 v131, v54, v55
    v_cvt_pk_bf16_f32 v132, v56, v57
    v_cvt_pk_bf16_f32 v133, v58, v59
    v_cvt_pk_bf16_f32 v134, v60, v61
    v_cvt_pk_bf16_f32 v135, v62, v63
    s_waitcnt vmcnt(0)
    v_cmp_ne_u32 vcc, s48, v254
    s_nop 0
    s_cbranch_vccnz Lsp_11_8
Lok_12_8:
    buffer_load_dwordx4 a[128:131], v88, s[40:43], s65 offen offset:0 sc1
    v_mfma_f32_32x32x16_bf16 v[112:127], a[112:115], v[128:131], v[112:127]
    buffer_load_dwordx4 a[132:135], v89, s[40:43], s65 offen offset:0 sc1
    buffer_load_dwordx4 a[136:139], v90, s[40:43], s65 offen offset:0 sc1
    buffer_load_dwordx4 a[140:143], v91, s[40:43], s65 offen offset:0 sc1
    buffer_load_dwordx4 a[144:147], v88, s[40:43], s65 offen offset:1024 sc1
    buffer_load_dwordx4 a[148:151], v89, s[40:43], s65 offen offset:1024 sc1
    buffer_load_dwordx4 a[152:155], v90, s[40:43], s65 offen offset:1024 sc1
    v_mfma_f32_32x32x16_bf16 v[112:127], a[116:119], v[132:135], v[112:127]
    buffer_load_dwordx4 a[156:159], v91, s[40:43], s65 offen offset:1024 sc1
    buffer_load_dwordx4 a[160:163], v88, s[40:43], s65 offen offset:2048 sc1
    buffer_load_dwordx4 a[164:167], v89, s[40:43], s65 offen offset:2048 sc1
    buffer_load_dwordx4 a[168:171], v90, s[40:43], s65 offen offset:2048 sc1
    buffer_load_dwordx4 a[172:175], v91, s[40:43], s65 offen offset:2048 sc1
    s_nop 6
    v_subrev_u32 v11, 0x2b800000, v120
    v_cmp_le_u32 vcc, 0x23000000, v11
    s_nop 0
    s_cbranch_vccnz Lfb_8_1
Lfr_8_1:
    s_add_u32 s60, s60, 98304
    v_rcp_f32 v11, v120
    s_nop 0
    v_mul_f32 v112, v112, v11
    v_mul_f32 v113, v113, v11
    v_and_b32 v112, v12, v112
    v_mul_f32 v114, v114, v11
    v_mul_f32 v115, v115, v11
    v_mul_f32 v116, v116, v11
    v_mul_f32 v117, v117, v11
    v_mul_f32 v118, v118, v11
    v_mul_f32 v119, v119, v11
    v_cvt_pk_bf16_f32 v120, v112, v113
    v_cvt_pk_bf16_f32 v121, v114, v115
    v_cvt_pk_bf16_f32 v122, v116, v117
    v_cvt_pk_bf16_f32 v123, v118, v119
    v_or_b32 v120, v9, v120
    buffer_store_dwordx4 v[120:123], v14, s[40:43], s60 offen sc1
    s_branch Lp3_17
Lcode_end:
Lsp_6:
    s_mov_b32 s3, 0
Lsp_6x:
    s_sleep 2
    buffer_load_dwordx2 v[252:253], off, s[44:47], 0 sc1
    s_add_u32 s3, s3, 1
    s_waitcnt vmcnt(0)
    v_cmp_ne_u32 vcc, 1, v253
    s_cmp_gt_u32 s3, 100000
    s_cbranch_scc1 Lok_7
    s_cbranch_vccnz Lsp_6x
    s_branch Lok_7
Lsp_9:
    s_mov_b32 s3, 0
Lsp_9x:
    s_sleep 2
    buffer_load_dword v7, v6, s[40:43], 0 offen sc1
    s_add_u32 s3, s3, 1
    s_waitcnt vmcnt(0)
    v_cmp_ne_u32 vcc, s48, v7
    s_cmp_gt_u32 s3, 100000
    s_cbranch_scc1 Lok_10
    s_cbranch_vccnz Lsp_9x
    s_branch Lok_10
Lsp_11:
    s_mov_b32 s3, 0
Lsp_11x:
    s_sleep 2
    buffer_load_dword v254, v15, s[40:43], 0 offen sc1
    s_add_u32 s3, s3, 1
    s_waitcnt vmcnt(0)
    v_cmp_ne_u32 vcc, s48, v254
    s_cmp_gt_u32 s3, 100000
    s_cbranch_scc1 Lok_12
    s_cbranch_vccnz Lsp_11x
    s_branch Lok_12
Lsp_18:
    s_mov_b32 s3, 0
Lsp_18x:
    s_sleep 1
    buffer_load_dwordx4 v[96:99], v12, s[40:43], s65 offen offset:0 sc1
    buffer_load_dwordx4 v[100:103], v12, s[40:43], s65 offen offset:2048 sc1
    buffer_load_dwordx4 v[104:107], v12, s[40:43], s62 offen offset:0 sc1
    buffer_load_dwordx4 v[108:111], v12, s[40:43], s62 offen offset:2048 sc1
    s_add_u32 s3, s3, 1
    s_waitcnt vmcnt(0)
    v_bitop3_b32 v2, v96, v100, v104 bitop3:0x80
    v_bitop3_b32 v2, v2, v108, v9 bitop3:0x80
    v_cmp_ne_u32 vcc, v9, v2
    s_cmp_gt_u32 s3, 100000
    s_cbranch_scc1 Lok_19
    s_cbranch_vccnz Lsp_18x
    s_branch Lok_19
Lsp_20:
    s_mov_b32 s3, 0
Lsp_20x:
    s_sleep 1
    buffer_load_dwordx4 v[112:115], v12, s[40:43], s65 offen offset:256 sc1
    buffer_load_dwordx4 v[116:119], v12, s[40:43], s65 offen offset:2304 sc1
    buffer_load_dwordx4 v[120:123], v12, s[40:43], s62 offen offset:256 sc1
    buffer_load_dwordx4 v[124:127], v12, s[40:43], s62 offen offset:2304 sc1
    s_add_u32 s3, s3, 1
    s_waitcnt vmcnt(0)
    v_bitop3_b32 v2, v112, v116, v120 bitop3:0x80
    v_bitop3_b32 v2, v2, v124, v9 bitop3:0x80
    v_cmp_ne_u32 vcc, v9, v2
    s_cmp_gt_u32 s3, 100000
    s_cbranch_scc1 Lok_21
    s_cbranch_vccnz Lsp_20x
    s_branch Lok_21
Lsp_22:
    s_mov_b32 s3, 0
Lsp_22x:
    s_sleep 1
    buffer_load_dwordx4 v[128:131], v13, s[40:43], s65 offen offset:0 sc1
    buffer_load_dwordx4 v[132:135], v13, s[40:43], s65 offen offset:2048 sc1
    buffer_load_dwordx4 v[136:139], v13, s[40:43], s62 offen offset:0 sc1
    buffer_load_dwordx4 v[140:143], v13, s[40:43], s62 offen offset:2048 sc1
    s_add_u32 s3, s3, 1
    s_waitcnt vmcnt(0)
    v_bitop3_b32 v2, v128, v132, v136 bitop3:0x80
    v_bitop3_b32 v2, v2, v140, v9 bitop3:0x80
    v_cmp_ne_u32 vcc, v9, v2
    s_cmp_gt_u32 s3, 100000
    s_cbranch_scc1 Lok_23
    s_cbranch_vccnz Lsp_22x
    s_branch Lok_23
Lsp_24:
    s_mov_b32 s3, 0
Lsp_24x:
    s_sleep 1
    buffer_load_dwordx4 v[144:147], v13, s[40:43], s65 offen offset:256 sc1
    buffer_load_dwordx4 v[148:151], v13, s[40:43], s65 offen offset:2304 sc1
    buffer_load_dwordx4 v[152:155], v13, s[40:43], s62 offen offset:256 sc1
    buffer_load_dwordx4 v[156:159], v13, s[40:43], s62 offen offset:2304 sc1
    s_add_u32 s3, s3, 1
    s_waitcnt vmcnt(0)
    v_bitop3_b32 v2, v144, v148, v152 bitop3:0x80
    v_bitop3_b32 v2, v2, v156, v9 bitop3:0x80
    v_cmp_ne_u32 vcc, v9, v2
    s_cmp_gt_u32 s3, 100000
    s_cbranch_scc1 Lok_25
    s_cbranch_vccnz Lsp_24x
    s_branch Lok_25
Lsp_11_2:
    s_mov_b32 s3, 0
Lsp_11_2x:
    s_sleep 2
    buffer_load_dword v254, v15, s[40:43], 0 offen sc1
    s_add_u32 s3, s3, 1
    s_waitcnt vmcnt(0)
    v_cmp_ne_u32 vcc, s48, v254
    s_cmp_gt_u32 s3, 100000
    s_cbranch_scc1 Lok_12_2
    s_cbranch_vccnz Lsp_11_2x
    s_branch Lok_12_2
Lsp_11_4:
    s_mov_b32 s3, 0
Lsp_11_4x:
    s_sleep 2
    buffer_load_dword v254, v15, s[40:43], 0 offen sc1
    s_add_u32 s3, s3, 1
    s_waitcnt vmcnt(0)
    v_cmp_ne_u32 vcc, s48, v254
    s_cmp_gt_u32 s3, 100000
    s_cbranch_scc1 Lok_12_4
    s_cbranch_vccnz Lsp_11_4x
    s_branch Lok_12_4
Lsp_11_6:
    s_mov_b32 s3, 0
Lsp_11_6x:
    s_sleep 2
    buffer_load_dword v254, v15, s[40:43], 0 offen sc1
    s_add_u32 s3, s3, 1
    s_waitcnt vmcnt(0)
    v_cmp_ne_u32 vcc, s48, v254
    s_cmp_gt_u32 s3, 100000
    s_cbranch_scc1 Lok_12_6
    s_cbranch_vccnz Lsp_11_6x
    s_branch Lok_12_6
Lsp_11_8:
    s_mov_b32 s3, 0
Lsp_11_8x:
    s_sleep 2
    buffer_load_dword v254, v15, s[40:43], 0 offen sc1
    s_add_u32 s3, s3, 1
    s_waitcnt vmcnt(0)
    v_cmp_ne_u32 vcc, s48, v254
    s_cmp_gt_u32 s3, 100000
    s_cbranch_scc1 Lok_12_8
    s_cbranch_vccnz Lsp_11_8x
    s_branch Lok_12_8
Lfb_0_0:
    s_waitcnt vmcnt(0)
    s_nop 2
    v_mfma_f32_32x32x16_bf16 v[32:47], a[40:43], a[0:3], 0
    v_mfma_f32_32x32x16_bf16 v[16:31], a[8:11], a[0:3], 0
    v_mfma_f32_32x32x16_bf16 v[48:63], a[12:15], a[0:3], 0
    s_nop 10
    v_cndmask_b32 v64, v16, v32, s[70:71]
    v_cndmask_b32 v65, v17, v33, s[72:73]
    v_cndmask_b32 v66, v18, v34, s[74:75]
    v_cndmask_b32 v67, v19, v35, s[76:77]
    v_cndmask_b32 v68, v20, v36, s[78:79]
    v_cndmask_b32 v69, v21, v37, s[80:81]
    v_cndmask_b32 v70, v22, v38, s[82:83]
    v_cndmask_b32 v71, v23, v39, s[84:85]
    v_cndmask_b32 v72, v24, v40, s[86:87]
    v_cndmask_b32 v73, v25, v41, s[88:89]
    v_cndmask_b32 v74, v26, v42, s[90:91]
    v_cndmask_b32 v75, v27, v43, s[92:93]
    v_cndmask_b32 v76, v28, v44, s[94:95]
    v_cndmask_b32 v77, v29, v45, s[96:97]
    v_cndmask_b32 v78, v30, v46, s[98:99]
    v_cndmask_b32 v79, v31, v47, s[100:101]
    v_mfma_f32_32x32x16_bf16 v[16:31], a[16:19], a[0:3], 0
    v_max_f32 v10, v64, v65
    v_max_f32 v13, v66, v67
    v_max3_f32 v10, v10, v68, v69
    v_max3_f32 v13, v13, v70, v71
    v_max3_f32 v10, v10, v72, v73
    v_max3_f32 v13, v13, v74, v75
    v_max3_f32 v10, v10, v76, v77
    v_max3_f32 v13, v13, v78, v79
    v_mfma_f32_32x32x16_bf16 v[32:47], a[20:23], a[0:3], 0
    v_max3_f32 v10, v10, v48, v49
    v_max3_f32 v13, v13, v50, v51
    v_max3_f32 v10, v10, v52, v53
    v_max3_f32 v13, v13, v54, v55
    v_max3_f32 v10, v10, v56, v57
    v_max3_f32 v13, v13, v58, v59
    v_max3_f32 v10, v10, v60, v61
    v_max3_f32 v13, v13, v62, v63
    v_mfma_f32_32x32x16_bf16 v[48:63], a[24:27], a[0:3], 0
    v_max3_f32 v10, v10, v16, v17
    v_max3_f32 v13, v13, v18, v19
    v_max3_f32 v10, v10, v20, v21
    v_max3_f32 v13, v13, v22, v23
    v_max3_f32 v10, v10, v24, v25
    v_max3_f32 v13, v13, v26, v27
    v_max3_f32 v10, v10, v28, v29
    v_max3_f32 v13, v13, v30, v31
    v_mfma_f32_32x32x16_bf16 v[16:31], a[28:31], a[0:3], 0
    v_max3_f32 v10, v10, v32, v33
    v_max3_f32 v13, v13, v34, v35
    v_max3_f32 v10, v10, v36, v37
    v_max3_f32 v13, v13, v38, v39
    v_max3_f32 v10, v10, v40, v41
    v_max3_f32 v13, v13, v42, v43
    v_max3_f32 v10, v10, v44, v45
    v_max3_f32 v13, v13, v46, v47
    v_mfma_f32_32x32x16_bf16 v[32:47], a[32:35], a[0:3], 0
    v_max3_f32 v10, v10, v48, v49
    v_max3_f32 v13, v13, v50, v51
    v_max3_f32 v10, v10, v52, v53
    v_max3_f32 v13, v13, v54, v55
    v_max3_f32 v10, v10, v56, v57
    v_max3_f32 v13, v13, v58, v59
    v_max3_f32 v10, v10, v60, v61
    v_max3_f32 v13, v13, v62, v63
    v_mfma_f32_32x32x16_bf16 v[48:63], a[36:39], a[0:3], 0
    v_max3_f32 v10, v10, v16, v17
    v_max3_f32 v13, v13, v18, v19
    v_max3_f32 v10, v10, v20, v21
    v_max3_f32 v13, v13, v22, v23
    v_max3_f32 v10, v10, v24, v25
    v_max3_f32 v13, v13, v26, v27
    v_max3_f32 v10, v10, v28, v29
    v_max3_f32 v13, v13, v30, v31
    v_max3_f32 v10, v10, v32, v33
    v_max3_f32 v13, v13, v34, v35
    v_max3_f32 v10, v10, v36, v37
    v_max3_f32 v13, v13, v38, v39
    v_max3_f32 v10, v10, v40, v41
    v_max3_f32 v13, v13, v42, v43
    v_max3_f32 v10, v10, v44, v45
    v_max3_f32 v13, v13, v46, v47
    v_max3_f32 v10, v10, v48, v49
    v_max3_f32 v13, v13, v50, v51
    v_max3_f32 v10, v10, v52, v53
    v_max3_f32 v13, v13, v54, v55
    v_max3_f32 v10, v10, v56, v57
    v_max3_f32 v13, v13, v58, v59
    v_max3_f32 v10, v10, v60, v61
    v_max3_f32 v13, v13, v62, v63
    v_max_f32 v10, v10, v13
    v_mov_b32 v13, v10
    s_nop 1
    v_permlane32_swap_b32 v10, v13
    v_max_f32 v10, v10, v13
    v_sub_f32 v160, 0, v10
    v_sub_f32 v161, 0, v10
    v_sub_f32 v162, 0, v10
    v_sub_f32 v163, 0, v10
    v_sub_f32 v164, 0, v10
    v_sub_f32 v165, 0, v10
    v_sub_f32 v166, 0, v10
    v_sub_f32 v167, 0, v10
    v_sub_f32 v168, 0, v10
    v_sub_f32 v169, 0, v10
    v_sub_f32 v170, 0, v10
    v_sub_f32 v171, 0, v10
    v_sub_f32 v172, 0, v10
    v_sub_f32 v173, 0, v10
    v_sub_f32 v174, 0, v10
    v_sub_f32 v175, 0, v10
    s_nop 1
    v_mfma_f32_32x32x16_bf16 v[16:31], a[12:15], a[0:3], v[160:175]
    v_mfma_f32_32x32x16_bf16 v[32:47], a[16:19], a[0:3], v[160:175]
    v_sub_f32 v64, v64, v10
    v_sub_f32 v65, v65, v10
    v_sub_f32 v66, v66, v10
    v_sub_f32 v67, v67, v10
    v_sub_f32 v68, v68, v10
    v_sub_f32 v69, v69, v10
    v_sub_f32 v70, v70, v10
    v_sub_f32 v71, v71, v10
    v_sub_f32 v72, v72, v10
    v_sub_f32 v73, v73, v10
    v_sub_f32 v74, v74, v10
    v_sub_f32 v75, v75, v10
    v_sub_f32 v76, v76, v10
    v_sub_f32 v77, v77, v10
    v_sub_f32 v78, v78, v10
    v_sub_f32 v79, v79, v10
    v_exp_f32 v64, v64
    v_exp_f32 v65, v65
    v_exp_f32 v66, v66
    v_exp_f32 v67, v67
    v_exp_f32 v68, v68
    v_exp_f32 v69, v69
    v_exp_f32 v70, v70
    v_exp_f32 v71, v71
    v_exp_f32 v72, v72
    v_exp_f32 v73, v73
    v_exp_f32 v74, v74
    v_exp_f32 v75, v75
    v_exp_f32 v76, v76
    v_exp_f32 v77, v77
    v_exp_f32 v78, v78
    v_exp_f32 v79, v79
    v_cvt_pk_bf16_f32 v128, v64, v65
    v_cvt_pk_bf16_f32 v129, v66, v67
    v_cvt_pk_bf16_f32 v130, v68, v69
    v_cvt_pk_bf16_f32 v131, v70, v71
    v_cvt_pk_bf16_f32 v132, v72, v73
    v_cvt_pk_bf16_f32 v133, v74, v75
    v_cvt_pk_bf16_f32 v134, v76, v77
    v_cvt_pk_bf16_f32 v135, v78, v79
    v_and_b32 v136, v128, v80
    v_and_b32 v137, v129, v81
    v_and_b32 v138, v130, v82
    v_and_b32 v139, v131, v83
    v_and_b32 v140, v132, v84
    v_and_b32 v141, v133, v85
    v_and_b32 v142, v134, v86
    v_and_b32 v143, v135, v87
    v_xor_b32 v128, v128, v136
    v_xor_b32 v129, v129, v137
    v_xor_b32 v130, v130, v138
    v_xor_b32 v131, v131, v139
    v_xor_b32 v132, v132, v140
    v_xor_b32 v133, v133, v141
    v_xor_b32 v134, v134, v142
    v_xor_b32 v135, v135, v143
    v_mfma_f32_32x32x16_bf16 v[96:111], a[112:115], v[136:139], 0
    v_exp_f32 v16, v16
    v_exp_f32 v17, v17
    v_exp_f32 v18, v18
    v_mfma_f32_32x32x16_bf16 v[96:111], a[116:119], v[140:143], v[96:111]
    v_exp_f32 v19, v19
    v_exp_f32 v20, v20
    v_exp_f32 v21, v21
    v_mfma_f32_32x32x16_bf16 v[96:111], a[48:51], v[128:131], v[96:111]
    v_exp_f32 v22, v22
    v_exp_f32 v23, v23
    v_exp_f32 v24, v24
    v_mfma_f32_32x32x16_bf16 v[96:111], a[52:55], v[132:135], v[96:111]
    v_exp_f32 v25, v25
    v_exp_f32 v26, v26
    v_exp_f32 v27, v27
    v_mfma_f32_32x32x16_bf16 v[48:63], a[20:23], a[0:3], v[160:175]
    v_exp_f32 v28, v28
    v_exp_f32 v29, v29
    v_exp_f32 v30, v30
    v_exp_f32 v31, v31
    v_cvt_pk_bf16_f32 v128, v16, v17
    v_cvt_pk_bf16_f32 v129, v18, v19
    v_cvt_pk_bf16_f32 v130, v20, v21
    v_cvt_pk_bf16_f32 v131, v22, v23
    v_cvt_pk_bf16_f32 v132, v24, v25
    v_cvt_pk_bf16_f32 v133, v26, v27
    v_cvt_pk_bf16_f32 v134, v28, v29
    v_cvt_pk_bf16_f32 v135, v30, v31
    v_mfma_f32_32x32x16_bf16 v[96:111], a[56:59], v[128:131], v[96:111]
    v_exp_f32 v32, v32
    v_exp_f32 v33, v33
    v_exp_f32 v34, v34
    v_exp_f32 v35, v35
    v_mfma_f32_32x32x16_bf16 v[96:111], a[60:63], v[132:135], v[96:111]
    v_exp_f32 v36, v36
    v_exp_f32 v37, v37
    v_exp_f32 v38, v38
    v_exp_f32 v39, v39
    v_mfma_f32_32x32x16_bf16 v[16:31], a[24:27], a[0:3], v[160:175]
    v_exp_f32 v40, v40
    v_exp_f32 v41, v41
    v_exp_f32 v42, v42
    v_exp_f32 v43, v43
    v_exp_f32 v44, v44
    v_exp_f32 v45, v45
    v_exp_f32 v46, v46
    v_exp_f32 v47, v47
    v_cvt_pk_bf16_f32 v128, v32, v33
    v_cvt_pk_bf16_f32 v129, v34, v35
    v_cvt_pk_bf16_f32 v130, v36, v37
    v_cvt_pk_bf16_f32 v131, v38, v39
    v_cvt_pk_bf16_f32 v132, v40, v41
    v_cvt_pk_bf16_f32 v133, v42, v43
    v_cvt_pk_bf16_f32 v134, v44, v45
    v_cvt_pk_bf16_f32 v135, v46, v47
    v_mfma_f32_32x32x16_bf16 v[96:111], a[64:67], v[128:131], v[96:111]
    v_exp_f32 v48, v48
    v_exp_f32 v49, v49
    v_exp_f32 v50, v50
    v_exp_f32 v51, v51
    v_mfma_f32_32x32x16_bf16 v[96:111], a[68:71], v[132:135], v[96:111]
    v_exp_f32 v52, v52
    v_exp_f32 v53, v53
    v_exp_f32 v54, v54
    v_exp_f32 v55, v55
    v_mfma_f32_32x32x16_bf16 v[32:47], a[28:31], a[0:3], v[160:175]
    v_exp_f32 v56, v56
    v_exp_f32 v57, v57
    v_exp_f32 v58, v58
    v_exp_f32 v59, v59
    v_exp_f32 v60, v60
    v_exp_f32 v61, v61
    v_exp_f32 v62, v62
    v_exp_f32 v63, v63
    v_cvt_pk_bf16_f32 v128, v48, v49
    v_cvt_pk_bf16_f32 v129, v50, v51
    v_cvt_pk_bf16_f32 v130, v52, v53
    v_cvt_pk_bf16_f32 v131, v54, v55
    v_cvt_pk_bf16_f32 v132, v56, v57
    v_cvt_pk_bf16_f32 v133, v58, v59
    v_cvt_pk_bf16_f32 v134, v60, v61
    v_cvt_pk_bf16_f32 v135, v62, v63
    v_mfma_f32_32x32x16_bf16 v[96:111], a[72:75], v[128:131], v[96:111]
    v_exp_f32 v16, v16
    v_exp_f32 v17, v17
    v_exp_f32 v18, v18
    v_exp_f32 v19, v19
    v_mfma_f32_32x32x16_bf16 v[96:111], a[76:79], v[132:135], v[96:111]
    v_exp_f32 v20, v20
    v_exp_f32 v21, v21
    v_exp_f32 v22, v22
    v_exp_f32 v23, v23
    v_mfma_f32_32x32x16_bf16 v[48:63], a[32:35], a[0:3], v[160:175]
    v_exp_f32 v24, v24
    v_exp_f32 v25, v25
    v_exp_f32 v26, v26
    v_exp_f32 v27, v27
    v_exp_f32 v28, v28
    v_exp_f32 v29, v29
    v_exp_f32 v30, v30
    v_exp_f32 v31, v31
    v_cvt_pk_bf16_f32 v128, v16, v17
    v_cvt_pk_bf16_f32 v129, v18, v19
    v_cvt_pk_bf16_f32 v130, v20, v21
    v_cvt_pk_bf16_f32 v131, v22, v23
    v_cvt_pk_bf16_f32 v132, v24, v25
    v_cvt_pk_bf16_f32 v133, v26, v27
    v_cvt_pk_bf16_f32 v134, v28, v29
    v_cvt_pk_bf16_f32 v135, v30, v31
    v_mfma_f32_32x32x16_bf16 v[96:111], a[80:83], v[128:131], v[96:111]
    v_exp_f32 v32, v32
    v_exp_f32 v33, v33
    v_exp_f32 v34, v34
    v_exp_f32 v35, v35
    v_mfma_f32_32x32x16_bf16 v[96:111], a[84:87], v[132:135], v[96:111]
    v_exp_f32 v36, v36
    v_exp_f32 v37, v37
    v_exp_f32 v38, v38
    v_exp_f32 v39, v39
    v_mfma_f32_32x32x16_bf16 v[16:31], a[36:39], a[0:3], v[160:175]
    v_exp_f32 v40, v40
    v_exp_f32 v41, v41
    v_exp_f32 v42, v42
    v_exp_f32 v43, v43
    v_exp_f32 v44, v44
    v_exp_f32 v45, v45
    v_exp_f32 v46, v46
    v_exp_f32 v47, v47
    v_cvt_pk_bf16_f32 v128, v32, v33
    v_cvt_pk_bf16_f32 v129, v34, v35
    v_cvt_pk_bf16_f32 v130, v36, v37
    v_cvt_pk_bf16_f32 v131, v38, v39
    v_cvt_pk_bf16_f32 v132, v40, v41
    v_cvt_pk_bf16_f32 v133, v42, v43
    v_cvt_pk_bf16_f32 v134, v44, v45
    v_cvt_pk_bf16_f32 v135, v46, v47
    v_mfma_f32_32x32x16_bf16 v[96:111], a[88:91], v[128:131], v[96:111]
    v_exp_f32 v48, v48
    v_exp_f32 v49, v49
    v_exp_f32 v50, v50
    v_exp_f32 v51, v51
    v_mfma_f32_32x32x16_bf16 v[96:111], a[92:95], v[132:135], v[96:111]
    v_exp_f32 v52, v52
    v_exp_f32 v53, v53
    v_exp_f32 v54, v54
    v_exp_f32 v55, v55
    v_exp_f32 v56, v56
    v_exp_f32 v57, v57
    v_exp_f32 v58, v58
    v_exp_f32 v59, v59
    v_exp_f32 v60, v60
    v_exp_f32 v61, v61
    v_exp_f32 v62, v62
    v_exp_f32 v63, v63
    v_cvt_pk_bf16_f32 v128, v48, v49
    v_cvt_pk_bf16_f32 v129, v50, v51
    v_cvt_pk_bf16_f32 v130, v52, v53
    v_cvt_pk_bf16_f32 v131, v54, v55
    v_cvt_pk_bf16_f32 v132, v56, v57
    v_cvt_pk_bf16_f32 v133, v58, v59
    v_cvt_pk_bf16_f32 v134, v60, v61
    v_cvt_pk_bf16_f32 v135, v62, v63
    v_mfma_f32_32x32x16_bf16 v[96:111], a[96:99], v[128:131], v[96:111]
    v_exp_f32 v16, v16
    v_exp_f32 v17, v17
    v_exp_f32 v18, v18
    v_exp_f32 v19, v19
    v_mfma_f32_32x32x16_bf16 v[96:111], a[100:103], v[132:135], v[96:111]
    v_exp_f32 v20, v20
    v_exp_f32 v21, v21
    v_exp_f32 v22, v22
    v_exp_f32 v23, v23
    v_exp_f32 v24, v24
    v_exp_f32 v25, v25
    v_exp_f32 v26, v26
    v_exp_f32 v27, v27
    v_exp_f32 v28, v28
    v_exp_f32 v29, v29
    v_exp_f32 v30, v30
    v_exp_f32 v31, v31
    v_cvt_pk_bf16_f32 v128, v16, v17
    v_cvt_pk_bf16_f32 v129, v18, v19
    v_cvt_pk_bf16_f32 v130, v20, v21
    v_cvt_pk_bf16_f32 v131, v22, v23
    v_cvt_pk_bf16_f32 v132, v24, v25
    v_cvt_pk_bf16_f32 v133, v26, v27
    v_cvt_pk_bf16_f32 v134, v28, v29
    v_cvt_pk_bf16_f32 v135, v30, v31
    v_mfma_f32_32x32x16_bf16 v[96:111], a[104:107], v[128:131], v[96:111]
    s_nop 0
    v_mfma_f32_32x32x16_bf16 v[96:111], a[108:111], v[132:135], v[96:111]
    v_mfma_f32_32x32x16_bf16 v[32:47], a[44:47], a[4:7], 0
    v_mfma_f32_32x32x16_bf16 v[16:31], a[12:15], a[4:7], 0
    v_mfma_f32_32x32x16_bf16 v[48:63], a[16:19], a[4:7], 0
    s_nop 11
    s_branch Lfr_0_0
Lfb_0_1:
    s_waitcnt vmcnt(0)
    v_mfma_f32_32x32x16_bf16 v[32:47], a[44:47], a[4:7], 0
    v_mfma_f32_32x32x16_bf16 v[16:31], a[12:15], a[4:7], 0
    v_mfma_f32_32x32x16_bf16 v[48:63], a[16:19], a[4:7], 0
    s_nop 10
    v_cndmask_b32 v64, v16, v32, s[70:71]
    v_cndmask_b32 v65, v17, v33, s[72:73]
    v_cndmask_b32 v66, v18, v34, s[74:75]
    v_cndmask_b32 v67, v19, v35, s[76:77]
    s_nop 6
    v_cndmask_b32 v68, v20, v36, s[78:79]
    v_cndmask_b32 v69, v21, v37, s[80:81]
    v_cndmask_b32 v70, v22, v38, s[82:83]
    v_cndmask_b32 v71, v23, v39, s[84:85]
    v_cndmask_b32 v72, v24, v40, s[86:87]
    v_cndmask_b32 v73, v25, v41, s[88:89]
    v_cndmask_b32 v74, v26, v42, s[90:91]
    v_cndmask_b32 v75, v27, v43, s[92:93]
    v_cndmask_b32 v76, v28, v44, s[94:95]
    v_cndmask_b32 v77, v29, v45, s[96:97]
    v_cndmask_b32 v78, v30, v46, s[98:99]
    v_cndmask_b32 v79, v31, v47, s[100:101]
    v_mfma_f32_32x32x16_bf16 v[16:31], a[20:23], a[4:7], 0
    v_max_f32 v10, v64, v65
    v_max_f32 v13, v66, v67
    v_max3_f32 v10, v10, v68, v69
    v_max3_f32 v13, v13, v70, v71
    v_max3_f32 v10, v10, v72, v73
    v_max3_f32 v13, v13, v74, v75
    v_max3_f32 v10, v10, v76, v77
    v_max3_f32 v13, v13, v78, v79
    v_mfma_f32_32x32x16_bf16 v[32:47], a[24:27], a[4:7], 0
    v_max3_f32 v10, v10, v48, v49
    v_max3_f32 v13, v13, v50, v51
    v_max3_f32 v10, v10, v52, v53
    v_max3_f32 v13, v13, v54, v55
    v_max3_f32 v10, v10, v56, v57
    v_max3_f32 v13, v13, v58, v59
    v_max3_f32 v10, v10, v60, v61
    v_max3_f32 v13, v13, v62, v63
    v_mfma_f32_32x32x16_bf16 v[48:63], a[28:31], a[4:7], 0
    v_max3_f32 v10, v10, v16, v17
    v_max3_f32 v13, v13, v18, v19
    v_max3_f32 v10, v10, v20, v21
    v_max3_f32 v13, v13, v22, v23
    v_max3_f32 v10, v10, v24, v25
    v_max3_f32 v13, v13, v26, v27
    v_max3_f32 v10, v10, v28, v29
    v_max3_f32 v13, v13, v30, v31
    v_mfma_f32_32x32x16_bf16 v[16:31], a[32:35], a[4:7], 0
    v_max3_f32 v10, v10, v32, v33
    v_max3_f32 v13, v13, v34, v35
    v_max3_f32 v10, v10, v36, v37
    v_max3_f32 v13, v13, v38, v39
    v_max3_f32 v10, v10, v40, v41
    v_max3_f32 v13, v13, v42, v43
    v_max3_f32 v10, v10, v44, v45
    v_max3_f32 v13, v13, v46, v47
    v_mfma_f32_32x32x16_bf16 v[32:47], a[36:39], a[4:7], 0
    v_max3_f32 v10, v10, v48, v49
    v_max3_f32 v13, v13, v50, v51
    v_max3_f32 v10, v10, v52, v53
    v_max3_f32 v13, v13, v54, v55
    v_max3_f32 v10, v10, v56, v57
    v_max3_f32 v13, v13, v58, v59
    v_max3_f32 v10, v10, v60, v61
    v_max3_f32 v13, v13, v62, v63
    v_mfma_f32_32x32x16_bf16 v[48:63], a[40:43], a[4:7], 0
    v_max3_f32 v10, v10, v16, v17
    v_max3_f32 v13, v13, v18, v19
    v_max3_f32 v10, v10, v20, v21
    v_max3_f32 v13, v13, v22, v23
    v_max3_f32 v10, v10, v24, v25
    v_max3_f32 v13, v13, v26, v27
    v_max3_f32 v10, v10, v28, v29
    v_max3_f32 v13, v13, v30, v31
    v_max3_f32 v10, v10, v32, v33
    v_max3_f32 v13, v13, v34, v35
    v_max3_f32 v10, v10, v36, v37
    v_max3_f32 v13, v13, v38, v39
    v_max3_f32 v10, v10, v40, v41
    v_max3_f32 v13, v13, v42, v43
    v_max3_f32 v10, v10, v44, v45
    v_max3_f32 v13, v13, v46, v47
    v_max3_f32 v10, v10, v48, v49
    v_max3_f32 v13, v13, v50, v51
    v_max3_f32 v10, v10, v52, v53
    v_max3_f32 v13, v13, v54, v55
    v_max3_f32 v10, v10, v56, v57
    v_max3_f32 v13, v13, v58, v59
    v_max3_f32 v10, v10, v60, v61
    v_max3_f32 v13, v13, v62, v63
    v_max_f32 v10, v10, v13
    v_mov_b32 v13, v10
    s_nop 1
    v_permlane32_swap_b32 v10, v13
    v_max_f32 v10, v10, v13
    v_sub_f32 v160, 0, v10
    v_sub_f32 v161, 0, v10
    v_sub_f32 v162, 0, v10
    v_sub_f32 v163, 0, v10
    v_sub_f32 v164, 0, v10
    v_sub_f32 v165, 0, v10
    v_sub_f32 v166, 0, v10
    v_sub_f32 v167, 0, v10
    v_sub_f32 v168, 0, v10
    v_sub_f32 v169, 0, v10
    v_sub_f32 v170, 0, v10
    v_sub_f32 v171, 0, v10
    v_sub_f32 v172, 0, v10
    v_sub_f32 v173, 0, v10
    v_sub_f32 v174, 0, v10
    v_sub_f32 v175, 0, v10
    s_nop 1
    v_mfma_f32_32x32x16_bf16 v[16:31], a[16:19], a[4:7], v[160:175]
    v_mfma_f32_32x32x16_bf16 v[32:47], a[20:23], a[4:7], v[160:175]
    v_sub_f32 v64, v64, v10
    v_sub_f32 v65, v65, v10
    v_sub_f32 v66, v66, v10
    v_sub_f32 v67, v67, v10
    v_sub_f32 v68, v68, v10
    v_sub_f32 v69, v69, v10
    v_sub_f32 v70, v70, v10
    v_sub_f32 v71, v71, v10
    v_sub_f32 v72, v72, v10
    v_sub_f32 v73, v73, v10
    v_sub_f32 v74, v74, v10
    v_sub_f32 v75, v75, v10
    v_sub_f32 v76, v76, v10
    v_sub_f32 v77, v77, v10
    v_sub_f32 v78, v78, v10
    v_sub_f32 v79, v79, v10
    v_exp_f32 v64, v64
    v_exp_f32 v65, v65
    v_exp_f32 v66, v66
    v_exp_f32 v67, v67
    v_exp_f32 v68, v68
    v_exp_f32 v69, v69
    v_exp_f32 v70, v70
    v_exp_f32 v71, v71
    v_exp_f32 v72, v72
    v_exp_f32 v73, v73
    v_exp_f32 v74, v74
    v_exp_f32 v75, v75
    v_exp_f32 v76, v76
    v_exp_f32 v77, v77
    v_exp_f32 v78, v78
    v_exp_f32 v79, v79
    v_cvt_pk_bf16_f32 v128, v64, v65
    v_cvt_pk_bf16_f32 v129, v66, v67
    v_cvt_pk_bf16_f32 v130, v68, v69
    v_cvt_pk_bf16_f32 v131, v70, v71
    v_cvt_pk_bf16_f32 v132, v72, v73
    v_cvt_pk_bf16_f32 v133, v74, v75
    v_cvt_pk_bf16_f32 v134, v76, v77
    v_cvt_pk_bf16_f32 v135, v78, v79
    v_and_b32 v136, v128, v80
    v_and_b32 v137, v129, v81
    v_and_b32 v138, v130, v82
    v_and_b32 v139, v131, v83
    v_and_b32 v140, v132, v84
    v_and_b32 v141, v133, v85
    v_and_b32 v142, v134, v86
    v_and_b32 v143, v135, v87
    v_xor_b32 v128, v128, v136
    v_xor_b32 v129, v129, v137
    v_xor_b32 v130, v130, v138
    v_xor_b32 v131, v131, v139
    v_xor_b32 v132, v132, v140
    v_xor_b32 v133, v133, v141
    v_xor_b32 v134, v134, v142
    v_xor_b32 v135, v135, v143
    v_mfma_f32_32x32x16_bf16 v[112:127], a[120:123], v[136:139], 0
    v_exp_f32 v16, v16
    v_exp_f32 v17, v17
    v_exp_f32 v18, v18
    v_mfma_f32_32x32x16_bf16 v[112:127], a[124:127], v[140:143], v[112:127]
    v_exp_f32 v19, v19
    v_exp_f32 v20, v20
    v_exp_f32 v21, v21
    v_mfma_f32_32x32x16_bf16 v[112:127], a[56:59], v[128:131], v[112:127]
    v_exp_f32 v22, v22
    v_exp_f32 v23, v23
    v_exp_f32 v24, v24
    v_mfma_f32_32x32x16_bf16 v[112:127], a[60:63], v[132:135], v[112:127]
    v_exp_f32 v25, v25
    v_exp_f32 v26, v26
    v_exp_f32 v27, v27
    v_mfma_f32_32x32x16_bf16 v[48:63], a[24:27], a[4:7], v[160:175]
    v_exp_f32 v28, v28
    v_exp_f32 v29, v29
    v_exp_f32 v30, v30
    v_exp_f32 v31, v31
    v_cvt_pk_bf16_f32 v128, v16, v17
    v_cvt_pk_bf16_f32 v129, v18, v19
    v_cvt_pk_bf16_f32 v130, v20, v21
    v_cvt_pk_bf16_f32 v131, v22, v23
    v_cvt_pk_bf16_f32 v132, v24, v25
    v_cvt_pk_bf16_f32 v133, v26, v27
    v_cvt_pk_bf16_f32 v134, v28, v29
    v_cvt_pk_bf16_f32 v135, v30, v31
    v_mfma_f32_32x32x16_bf16 v[112:127], a[64:67], v[128:131], v[112:127]
    v_exp_f32 v32, v32
    v_exp_f32 v33, v33
    v_exp_f32 v34, v34
    v_exp_f32 v35, v35
    v_mfma_f32_32x32x16_bf16 v[112:127], a[68:71], v[132:135], v[112:127]
    v_exp_f32 v36, v36
    v_exp_f32 v37, v37
    v_exp_f32 v38, v38
    v_exp_f32 v39, v39
    v_mfma_f32_32x32x16_bf16 v[16:31], a[28:31], a[4:7], v[160:175]
    v_exp_f32 v40, v40
    v_exp_f32 v41, v41
    v_exp_f32 v42, v42
    v_exp_f32 v43, v43
    v_exp_f32 v44, v44
    v_exp_f32 v45, v45
    v_exp_f32 v46, v46
    v_exp_f32 v47, v47
    v_cvt_pk_bf16_f32 v128, v32, v33
    v_cvt_pk_bf16_f32 v129, v34, v35
    v_cvt_pk_bf16_f32 v130, v36, v37
    v_cvt_pk_bf16_f32 v131, v38, v39
    v_cvt_pk_bf16_f32 v132, v40, v41
    v_cvt_pk_bf16_f32 v133, v42, v43
    v_cvt_pk_bf16_f32 v134, v44, v45
    v_cvt_pk_bf16_f32 v135, v46, v47
    v_mfma_f32_32x32x16_bf16 v[112:127], a[72:75], v[128:131], v[112:127]
    v_exp_f32 v48, v48
    v_exp_f32 v49, v49
    v_exp_f32 v50, v50
    v_exp_f32 v51, v51
    v_mfma_f32_32x32x16_bf16 v[112:127], a[76:79], v[132:135], v[112:127]
    v_exp_f32 v52, v52
    v_exp_f32 v53, v53
    v_exp_f32 v54, v54
    v_exp_f32 v55, v55
    v_mfma_f32_32x32x16_bf16 v[32:47], a[32:35], a[4:7], v[160:175]
    v_exp_f32 v56, v56
    v_exp_f32 v57, v57
    v_exp_f32 v58, v58
    v_exp_f32 v59, v59
    v_exp_f32 v60, v60
    v_exp_f32 v61, v61
    v_exp_f32 v62, v62
    v_exp_f32 v63, v63
    v_cvt_pk_bf16_f32 v128, v48, v49
    v_cvt_pk_bf16_f32 v129, v50, v51
    v_cvt_pk_bf16_f32 v130, v52, v53
    v_cvt_pk_bf16_f32 v131, v54, v55
    v_cvt_pk_bf16_f32 v132, v56, v57
    v_cvt_pk_bf16_f32 v133, v58, v59
    v_cvt_pk_bf16_f32 v134, v60, v61
    v_cvt_pk_bf16_f32 v135, v62, v63
    v_mfma_f32_32x32x16_bf16 v[112:127], a[80:83], v[128:131], v[112:127]
    v_exp_f32 v16, v16
    v_exp_f32 v17, v17
    v_exp_f32 v18, v18
    v_exp_f32 v19, v19
    v_mfma_f32_32x32x16_bf16 v[112:127], a[84:87], v[132:135], v[112:127]
    v_exp_f32 v20, v20
    v_exp_f32 v21, v21
    v_exp_f32 v22, v22
    v_exp_f32 v23, v23
    v_mfma_f32_32x32x16_bf16 v[48:63], a[36:39], a[4:7], v[160:175]
    v_exp_f32 v24, v24
    v_exp_f32 v25, v25
    v_exp_f32 v26, v26
    v_exp_f32 v27, v27
    v_exp_f32 v28, v28
    v_exp_f32 v29, v29
    v_exp_f32 v30, v30
    v_exp_f32 v31, v31
    v_cvt_pk_bf16_f32 v128, v16, v17
    v_cvt_pk_bf16_f32 v129, v18, v19
    v_cvt_pk_bf16_f32 v130, v20, v21
    v_cvt_pk_bf16_f32 v131, v22, v23
    v_cvt_pk_bf16_f32 v132, v24, v25
    v_cvt_pk_bf16_f32 v133, v26, v27
    v_cvt_pk_bf16_f32 v134, v28, v29
    v_cvt_pk_bf16_f32 v135, v30, v31
    v_mfma_f32_32x32x16_bf16 v[112:127], a[88:91], v[128:131], v[112:127]
    v_exp_f32 v32, v32
    v_exp_f32 v33, v33
    v_exp_f32 v34, v34
    v_exp_f32 v35, v35
    v_mfma_f32_32x32x16_bf16 v[112:127], a[92:95], v[132:135], v[112:127]
    v_exp_f32 v36, v36
    v_exp_f32 v37, v37
    v_exp_f32 v38, v38
    v_exp_f32 v39, v39
    v_mfma_f32_32x32x16_bf16 v[16:31], a[40:43], a[4:7], v[160:175]
    v_exp_f32 v40, v40
    v_exp_f32 v41, v41
    v_exp_f32 v42, v42
    v_exp_f32 v43, v43
    v_exp_f32 v44, v44
    v_exp_f32 v45, v45
    v_exp_f32 v46, v46
    v_exp_f32 v47, v47
    v_cvt_pk_bf16_f32 v128, v32, v33
    v_cvt_pk_bf16_f32 v129, v34, v35
    v_cvt_pk_bf16_f32 v130, v36, v37
    v_cvt_pk_bf16_f32 v131, v38, v39
    v_cvt_pk_bf16_f32 v132, v40, v41
    v_cvt_pk_bf16_f32 v133, v42, v43
    v_cvt_pk_bf16_f32 v134, v44, v45
    v_cvt_pk_bf16_f32 v135, v46, v47
    v_mfma_f32_32x32x16_bf16 v[112:127], a[96:99], v[128:131], v[112:127]
    v_exp_f32 v48, v48
    v_exp_f32 v49, v49
    v_exp_f32 v50, v50
    v_exp_f32 v51, v51
    v_mfma_f32_32x32x16_bf16 v[112:127], a[100:103], v[132:135], v[112:127]
    v_exp_f32 v52, v52
    v_exp_f32 v53, v53
    v_exp_f32 v54, v54
    v_exp_f32 v55, v55
    v_exp_f32 v56, v56
    v_exp_f32 v57, v57
    v_exp_f32 v58, v58
    v_exp_f32 v59, v59
    v_exp_f32 v60, v60
    v_exp_f32 v61, v61
    v_exp_f32 v62, v62
    v_exp_f32 v63, v63
    v_cvt_pk_bf16_f32 v128, v48, v49
    v_cvt_pk_bf16_f32 v129, v50, v51
    v_cvt_pk_bf16_f32 v130, v52, v53
    v_cvt_pk_bf16_f32 v131, v54, v55
    v_cvt_pk_bf16_f32 v132, v56, v57
    v_cvt_pk_bf16_f32 v133, v58, v59
    v_cvt_pk_bf16_f32 v134, v60, v61
    v_cvt_pk_bf16_f32 v135, v62, v63
    v_mfma_f32_32x32x16_bf16 v[112:127], a[104:107], v[128:131], v[112:127]
    v_exp_f32 v16, v16
    v_exp_f32 v17, v17
    v_exp_f32 v18, v18
    v_exp_f32 v19, v19
    v_mfma_f32_32x32x16_bf16 v[112:127], a[108:111], v[132:135], v[112:127]
    v_exp_f32 v20, v20
    v_exp_f32 v21, v21
    v_exp_f32 v22, v22
    v_exp_f32 v23, v23
    v_exp_f32 v24, v24
    v_exp_f32 v25, v25
    v_exp_f32 v26, v26
    v_exp_f32 v27, v27
    v_exp_f32 v28, v28
    v_exp_f32 v29, v29
    v_exp_f32 v30, v30
    v_exp_f32 v31, v31
    v_cvt_pk_bf16_f32 v128, v16, v17
    v_cvt_pk_bf16_f32 v129, v18, v19
    v_cvt_pk_bf16_f32 v130, v20, v21
    v_cvt_pk_bf16_f32 v131, v22, v23
    v_cvt_pk_bf16_f32 v132, v24, v25
    v_cvt_pk_bf16_f32 v133, v26, v27
    v_cvt_pk_bf16_f32 v134, v28, v29
    v_cvt_pk_bf16_f32 v135, v30, v31
    v_mfma_f32_32x32x16_bf16 v[112:127], a[112:115], v[128:131], v[112:127]
    s_nop 0
    v_mfma_f32_32x32x16_bf16 v[112:127], a[116:119], v[132:135], v[112:127]
    s_nop 11
    s_branch Lfr_0_1
Lfb_2_0:
    s_waitcnt vmcnt(0)
    s_nop 3
    v_mfma_f32_32x32x16_bf16 v[32:47], a[40:43], a[0:3], 0
    v_mfma_f32_32x32x16_bf16 v[48:63], a[16:19], a[0:3], 0
    s_nop 10
    v_cndmask_b32 v64, v8, v32, s[70:71]
    v_cndmask_b32 v65, v8, v33, s[72:73]
    v_cndmask_b32 v66, v8, v34, s[74:75]
    v_cndmask_b32 v67, v8, v35, s[76:77]
    v_cndmask_b32 v68, v8, v36, s[78:79]
    v_cndmask_b32 v69, v8, v37, s[80:81]
    v_cndmask_b32 v70, v8, v38, s[82:83]
    v_cndmask_b32 v71, v8, v39, s[84:85]
    s_nop 2
    v_cndmask_b32 v72, v8, v40, s[86:87]
    v_cndmask_b32 v73, v8, v41, s[88:89]
    v_cndmask_b32 v74, v8, v42, s[90:91]
    v_cndmask_b32 v75, v8, v43, s[92:93]
    v_cndmask_b32 v76, v8, v44, s[94:95]
    v_cndmask_b32 v77, v8, v45, s[96:97]
    v_cndmask_b32 v78, v8, v46, s[98:99]
    v_cndmask_b32 v79, v8, v47, s[100:101]
    v_mfma_f32_32x32x16_bf16 v[16:31], a[20:23], a[0:3], 0
    v_max_f32 v10, v64, v65
    v_max_f32 v13, v66, v67
    v_max3_f32 v10, v10, v68, v69
    v_max3_f32 v13, v13, v70, v71
    v_max3_f32 v10, v10, v72, v73
    v_max3_f32 v13, v13, v74, v75
    v_max3_f32 v10, v10, v76, v77
    v_max3_f32 v13, v13, v78, v79
    v_mfma_f32_32x32x16_bf16 v[32:47], a[24:27], a[0:3], 0
    v_max3_f32 v10, v10, v48, v49
    v_max3_f32 v13, v13, v50, v51
    v_max3_f32 v10, v10, v52, v53
    v_max3_f32 v13, v13, v54, v55
    v_max3_f32 v10, v10, v56, v57
    v_max3_f32 v13, v13, v58, v59
    v_max3_f32 v10, v10, v60, v61
    v_max3_f32 v13, v13, v62, v63
    v_mfma_f32_32x32x16_bf16 v[48:63], a[28:31], a[0:3], 0
    v_max3_f32 v10, v10, v16, v17
    v_max3_f32 v13, v13, v18, v19
    v_max3_f32 v10, v10, v20, v21
    v_max3_f32 v13, v13, v22, v23
    v_max3_f32 v10, v10, v24, v25
    v_max3_f32 v13, v13, v26, v27
    v_max3_f32 v10, v10, v28, v29
    v_max3_f32 v13, v13, v30, v31
    v_mfma_f32_32x32x16_bf16 v[16:31], a[32:35], a[0:3], 0
    v_max3_f32 v10, v10, v32, v33
    v_max3_f32 v13, v13, v34, v35
    v_max3_f32 v10, v10, v36, v37
    v_max3_f32 v13, v13, v38, v39
    v_max3_f32 v10, v10, v40, v41
    v_max3_f32 v13, v13, v42, v43
    v_max3_f32 v10, v10, v44, v45
    v_max3_f32 v13, v13, v46, v47
    v_mfma_f32_32x32x16_bf16 v[32:47], a[36:39], a[0:3], 0
    v_max3_f32 v10, v10, v48, v49
    v_max3_f32 v13, v13, v50, v51
    v_max3_f32 v10, v10, v52, v53
    v_max3_f32 v13, v13, v54, v55
    v_max3_f32 v10, v10, v56, v57
    v_max3_f32 v13, v13, v58, v59
    v_max3_f32 v10, v10, v60, v61
    v_max3_f32 v13, v13, v62, v63
    v_max3_f32 v10, v10, v16, v17
    v_max3_f32 v13, v13, v18, v19
    v_max3_f32 v10, v10, v20, v21
    v_max3_f32 v13, v13, v22, v23
    v_max3_f32 v10, v10, v24, v25
    v_max3_f32 v13, v13, v26, v27
    v_max3_f32 v10, v10, v28, v29
    v_max3_f32 v13, v13, v30, v31
    v_max3_f32 v10, v10, v32, v33
    v_max3_f32 v13, v13, v34, v35
    v_max3_f32 v10, v10, v36, v37
    v_max3_f32 v13, v13, v38, v39
    v_max3_f32 v10, v10, v40, v41
    v_max3_f32 v13, v13, v42, v43
    v_max3_f32 v10, v10, v44, v45
    v_max3_f32 v13, v13, v46, v47
    v_max_f32 v10, v10, v13
    v_mov_b32 v13, v10
    s_nop 1
    v_permlane32_swap_b32 v10, v13
    v_max_f32 v10, v10, v13
    v_sub_f32 v160, 0, v10
    v_sub_f32 v161, 0, v10
    v_sub_f32 v162, 0, v10
    v_sub_f32 v163, 0, v10
    v_sub_f32 v164, 0, v10
    v_sub_f32 v165, 0, v10
    v_sub_f32 v166, 0, v10
    v_sub_f32 v167, 0, v10
    v_sub_f32 v168, 0, v10
    v_sub_f32 v169, 0, v10
    v_sub_f32 v170, 0, v10
    v_sub_f32 v171, 0, v10
    v_sub_f32 v172, 0, v10
    v_sub_f32 v173, 0, v10
    v_sub_f32 v174, 0, v10
    v_sub_f32 v175, 0, v10
    s_nop 1
    v_mfma_f32_32x32x16_bf16 v[16:31], a[16:19], a[0:3], v[160:175]
    v_mfma_f32_32x32x16_bf16 v[32:47], a[20:23], a[0:3], v[160:175]
    v_sub_f32 v64, v64, v10
    v_sub_f32 v65, v65, v10
    v_sub_f32 v66, v66, v10
    v_sub_f32 v67, v67, v10
    v_sub_f32 v68, v68, v10
    v_sub_f32 v69, v69, v10
    v_sub_f32 v70, v70, v10
    v_sub_f32 v71, v71, v10
    v_sub_f32 v72, v72, v10
    v_sub_f32 v73, v73, v10
    v_sub_f32 v74, v74, v10
    v_sub_f32 v75, v75, v10
    v_sub_f32 v76, v76, v10
    v_sub_f32 v77, v77, v10
    v_sub_f32 v78, v78, v10
    v_sub_f32 v79, v79, v10
    v_exp_f32 v64, v64
    v_exp_f32 v65, v65
    v_exp_f32 v66, v66
    v_exp_f32 v67, v67
    v_exp_f32 v68, v68
    v_exp_f32 v69, v69
    v_exp_f32 v70, v70
    v_exp_f32 v71, v71
    v_exp_f32 v72, v72
    v_exp_f32 v73, v73
    v_exp_f32 v74, v74
    v_exp_f32 v75, v75
    v_exp_f32 v76, v76
    v_exp_f32 v77, v77
    v_exp_f32 v78, v78
    v_exp_f32 v79, v79
    v_cvt_pk_bf16_f32 v128, v64, v65
    v_cvt_pk_bf16_f32 v129, v66, v67
    v_cvt_pk_bf16_f32 v130, v68, v69
    v_cvt_pk_bf16_f32 v131, v70, v71
    v_cvt_pk_bf16_f32 v132, v72, v73
    v_cvt_pk_bf16_f32 v133, v74, v75
    v_cvt_pk_bf16_f32 v134, v76, v77
    v_cvt_pk_bf16_f32 v135, v78, v79
    v_mfma_f32_32x32x16_bf16 v[96:111], a[112:115], v[128:131], 0
    v_exp_f32 v16, v16
    v_exp_f32 v17, v17
    v_exp_f32 v18, v18
    v_exp_f32 v19, v19
    v_mfma_f32_32x32x16_bf16 v[96:111], a[116:119], v[132:135], v[96:111]
    v_exp_f32 v20, v20
    v_exp_f32 v21, v21
    v_exp_f32 v22, v22
    v_exp_f32 v23, v23
    v_mfma_f32_32x32x16_bf16 v[48:63], a[24:27], a[0:3], v[160:175]
    v_exp_f32 v24, v24
    v_exp_f32 v25, v25
    v_exp_f32 v26, v26
    v_exp_f32 v27, v27
    v_exp_f32 v28, v28
    v_exp_f32 v29, v29
    v_exp_f32 v30, v30
    v_exp_f32 v31, v31
    v_cvt_pk_bf16_f32 v128, v16, v17
    v_cvt_pk_bf16_f32 v129, v18, v19
    v_cvt_pk_bf16_f32 v130, v20, v21
    v_cvt_pk_bf16_f32 v131, v22, v23
    v_cvt_pk_bf16_f32 v132, v24, v25
    v_cvt_pk_bf16_f32 v133, v26, v27
    v_cvt_pk_bf16_f32 v134, v28, v29
    v_cvt_pk_bf16_f32 v135, v30, v31
    v_mfma_f32_32x32x16_bf16 v[96:111], a[64:67], v[128:131], v[96:111]
    v_exp_f32 v32, v32
    v_exp_f32 v33, v33
    v_exp_f32 v34, v34
    v_exp_f32 v35, v35
    v_mfma_f32_32x32x16_bf16 v[96:111], a[68:71], v[132:135], v[96:111]
    v_exp_f32 v36, v36
    v_exp_f32 v37, v37
    v_exp_f32 v38, v38
    v_exp_f32 v39, v39
    v_mfma_f32_32x32x16_bf16 v[16:31], a[28:31], a[0:3], v[160:175]
    v_exp_f32 v40, v40
    v_exp_f32 v41, v41
    v_exp_f32 v42, v42
    v_exp_f32 v43, v43
    v_exp_f32 v44, v44
    v_exp_f32 v45, v45
    v_exp_f32 v46, v46
    v_exp_f32 v47, v47
    v_cvt_pk_bf16_f32 v128, v32, v33
    v_cvt_pk_bf16_f32 v129, v34, v35
    v_cvt_pk_bf16_f32 v130, v36, v37
    v_cvt_pk_bf16_f32 v131, v38, v39
    v_cvt_pk_bf16_f32 v132, v40, v41
    v_cvt_pk_bf16_f32 v133, v42, v43
    v_cvt_pk_bf16_f32 v134, v44, v45
    v_cvt_pk_bf16_f32 v135, v46, v47
    v_mfma_f32_32x32x16_bf16 v[96:111], a[72:75], v[128:131], v[96:111]
    v_exp_f32 v48, v48
    v_exp_f32 v49, v49
    v_exp_f32 v50, v50
    v_exp_f32 v51, v51
    v_mfma_f32_32x32x16_bf16 v[96:111], a[76:79], v[132:135], v[96:111]
    v_exp_f32 v52, v52
    v_exp_f32 v53, v53
    v_exp_f32 v54, v54
    v_exp_f32 v55, v55
    v_mfma_f32_32x32x16_bf16 v[32:47], a[32:35], a[0:3], v[160:175]
    v_exp_f32 v56, v56
    v_exp_f32 v57, v57
    v_exp_f32 v58, v58
    v_exp_f32 v59, v59
    v_exp_f32 v60, v60
    v_exp_f32 v61, v61
    v_exp_f32 v62, v62
    v_exp_f32 v63, v63
    v_cvt_pk_bf16_f32 v128, v48, v49
    v_cvt_pk_bf16_f32 v129, v50, v51
    v_cvt_pk_bf16_f32 v130, v52, v53
    v_cvt_pk_bf16_f32 v131, v54, v55
    v_cvt_pk_bf16_f32 v132, v56, v57
    v_cvt_pk_bf16_f32 v133, v58, v59
    v_cvt_pk_bf16_f32 v134, v60, v61
    v_cvt_pk_bf16_f32 v135, v62, v63
    v_mfma_f32_32x32x16_bf16 v[96:111], a[80:83], v[128:131], v[96:111]
    v_exp_f32 v16, v16
    v_exp_f32 v17, v17
    v_exp_f32 v18, v18
    v_exp_f32 v19, v19
    v_mfma_f32_32x32x16_bf16 v[96:111], a[84:87], v[132:135], v[96:111]
    v_exp_f32 v20, v20
    v_exp_f32 v21, v21
    v_exp_f32 v22, v22
    v_exp_f32 v23, v23
    v_mfma_f32_32x32x16_bf16 v[48:63], a[36:39], a[0:3], v[160:175]
    v_exp_f32 v24, v24
    v_exp_f32 v25, v25
    v_exp_f32 v26, v26
    v_exp_f32 v27, v27
    v_exp_f32 v28, v28
    v_exp_f32 v29, v29
    v_exp_f32 v30, v30
    v_exp_f32 v31, v31
    v_cvt_pk_bf16_f32 v128, v16, v17
    v_cvt_pk_bf16_f32 v129, v18, v19
    v_cvt_pk_bf16_f32 v130, v20, v21
    v_cvt_pk_bf16_f32 v131, v22, v23
    v_cvt_pk_bf16_f32 v132, v24, v25
    v_cvt_pk_bf16_f32 v133, v26, v27
    v_cvt_pk_bf16_f32 v134, v28, v29
    v_cvt_pk_bf16_f32 v135, v30, v31
    v_mfma_f32_32x32x16_bf16 v[96:111], a[88:91], v[128:131], v[96:111]
    v_exp_f32 v32, v32
    v_exp_f32 v33, v33
    v_exp_f32 v34, v34
    v_exp_f32 v35, v35
    v_mfma_f32_32x32x16_bf16 v[96:111], a[92:95], v[132:135], v[96:111]
    v_exp_f32 v36, v36
    v_exp_f32 v37, v37
    v_exp_f32 v38, v38
    v_exp_f32 v39, v39
    v_exp_f32 v40, v40
    v_exp_f32 v41, v41
    v_exp_f32 v42, v42
    v_exp_f32 v43, v43
    v_exp_f32 v44, v44
    v_exp_f32 v45, v45
    v_exp_f32 v46, v46
    v_exp_f32 v47, v47
    v_cvt_pk_bf16_f32 v128, v32, v33
    v_cvt_pk_bf16_f32 v129, v34, v35
    v_cvt_pk_bf16_f32 v130, v36, v37
    v_cvt_pk_bf16_f32 v131, v38, v39
    v_cvt_pk_bf16_f32 v132, v40, v41
    v_cvt_pk_bf16_f32 v133, v42, v43
    v_cvt_pk_bf16_f32 v134, v44, v45
    v_cvt_pk_bf16_f32 v135, v46, v47
    v_mfma_f32_32x32x16_bf16 v[96:111], a[96:99], v[128:131], v[96:111]
    v_exp_f32 v48, v48
    v_exp_f32 v49, v49
    v_exp_f32 v50, v50
    v_exp_f32 v51, v51
    v_mfma_f32_32x32x16_bf16 v[96:111], a[100:103], v[132:135], v[96:111]
    v_exp_f32 v52, v52
    v_exp_f32 v53, v53
    v_exp_f32 v54, v54
    v_exp_f32 v55, v55
    v_exp_f32 v56, v56
    v_exp_f32 v57, v57
    v_exp_f32 v58, v58
    v_exp_f32 v59, v59
    v_exp_f32 v60, v60
    v_exp_f32 v61, v61
    v_exp_f32 v62, v62
    v_exp_f32 v63, v63
    v_cvt_pk_bf16_f32 v128, v48, v49
    v_cvt_pk_bf16_f32 v129, v50, v51
    v_cvt_pk_bf16_f32 v130, v52, v53
    v_cvt_pk_bf16_f32 v131, v54, v55
    v_cvt_pk_bf16_f32 v132, v56, v57
    v_cvt_pk_bf16_f32 v133, v58, v59
    v_cvt_pk_bf16_f32 v134, v60, v61
    v_cvt_pk_bf16_f32 v135, v62, v63
    v_mfma_f32_32x32x16_bf16 v[96:111], a[104:107], v[128:131], v[96:111]
    s_nop 0
    v_mfma_f32_32x32x16_bf16 v[96:111], a[108:111], v[132:135], v[96:111]
    v_mfma_f32_32x32x16_bf16 v[32:47], a[44:47], a[4:7], 0
    v_mfma_f32_32x32x16_bf16 v[48:63], a[16:19], a[4:7], 0
    s_nop 11
    s_branch Lfr_2_0
Lfb_2_1:
    s_waitcnt vmcnt(0)
    v_mfma_f32_32x32x16_bf16 v[32:47], a[44:47], a[4:7], 0
    v_mfma_f32_32x32x16_bf16 v[48:63], a[16:19], a[4:7], 0
    s_nop 10
    v_cndmask_b32 v64, v8, v32, s[70:71]
    v_cndmask_b32 v65, v8, v33, s[72:73]
    v_cndmask_b32 v66, v8, v34, s[74:75]
    v_cndmask_b32 v67, v8, v35, s[76:77]
    v_cndmask_b32 v68, v8, v36, s[78:79]
    v_cndmask_b32 v69, v8, v37, s[80:81]
    s_nop 4
    v_cndmask_b32 v70, v8, v38, s[82:83]
    v_cndmask_b32 v71, v8, v39, s[84:85]
    v_cndmask_b32 v72, v8, v40, s[86:87]
    v_cndmask_b32 v73, v8, v41, s[88:89]
    v_cndmask_b32 v74, v8, v42, s[90:91]
    v_cndmask_b32 v75, v8, v43, s[92:93]
    v_cndmask_b32 v76, v8, v44, s[94:95]
    v_cndmask_b32 v77, v8, v45, s[96:97]
    v_cndmask_b32 v78, v8, v46, s[98:99]
    v_cndmask_b32 v79, v8, v47, s[100:101]
    v_mfma_f32_32x32x16_bf16 v[16:31], a[20:23], a[4:7], 0
    v_max_f32 v10, v64, v65
    v_max_f32 v13, v66, v67
    v_max3_f32 v10, v10, v68, v69
    v_max3_f32 v13, v13, v70, v71
    v_max3_f32 v10, v10, v72, v73
    v_max3_f32 v13, v13, v74, v75
    v_max3_f32 v10, v10, v76, v77
    v_max3_f32 v13, v13, v78, v79
    v_mfma_f32_32x32x16_bf16 v[32:47], a[24:27], a[4:7], 0
    v_max3_f32 v10, v10, v48, v49
    v_max3_f32 v13, v13, v50, v51
    v_max3_f32 v10, v10, v52, v53
    v_max3_f32 v13, v13, v54, v55
    v_max3_f32 v10, v10, v56, v57
    v_max3_f32 v13, v13, v58, v59
    v_max3_f32 v10, v10, v60, v61
    v_max3_f32 v13, v13, v62, v63
    v_mfma_f32_32x32x16_bf16 v[48:63], a[28:31], a[4:7], 0
    v_max3_f32 v10, v10, v16, v17
    v_max3_f32 v13, v13, v18, v19
    v_max3_f32 v10, v10, v20, v21
    v_max3_f32 v13, v13, v22, v23
    v_max3_f32 v10, v10, v24, v25
    v_max3_f32 v13, v13, v26, v27
    v_max3_f32 v10, v10, v28, v29
    v_max3_f32 v13, v13, v30, v31
    v_mfma_f32_32x32x16_bf16 v[16:31], a[32:35], a[4:7], 0
    v_max3_f32 v10, v10, v32, v33
    v_max3_f32 v13, v13, v34, v35
    v_max3_f32 v10, v10, v36, v37
    v_max3_f32 v13, v13, v38, v39
    v_max3_f32 v10, v10, v40, v41
    v_max3_f32 v13, v13, v42, v43
    v_max3_f32 v10, v10, v44, v45
    v_max3_f32 v13, v13, v46, v47
    v_mfma_f32_32x32x16_bf16 v[32:47], a[36:39], a[4:7], 0
    v_max3_f32 v10, v10, v48, v49
    v_max3_f32 v13, v13, v50, v51
    v_max3_f32 v10, v10, v52, v53
    v_max3_f32 v13, v13, v54, v55
    v_max3_f32 v10, v10, v56, v57
    v_max3_f32 v13, v13, v58, v59
    v_max3_f32 v10, v10, v60, v61
    v_max3_f32 v13, v13, v62, v63
    v_mfma_f32_32x32x16_bf16 v[48:63], a[40:43], a[4:7], 0
    v_max3_f32 v10, v10, v16, v17
    v_max3_f32 v13, v13, v18, v19
    v_max3_f32 v10, v10, v20, v21
    v_max3_f32 v13, v13, v22, v23
    v_max3_f32 v10, v10, v24, v25
    v_max3_f32 v13, v13, v26, v27
    v_max3_f32 v10, v10, v28, v29
    v_max3_f32 v13, v13, v30, v31
    v_max3_f32 v10, v10, v32, v33
    v_max3_f32 v13, v13, v34, v35
    v_max3_f32 v10, v10, v36, v37
    v_max3_f32 v13, v13, v38, v39
    v_max3_f32 v10, v10, v40, v41
    v_max3_f32 v13, v13, v42, v43
    v_max3_f32 v10, v10, v44, v45
    v_max3_f32 v13, v13, v46, v47
    v_max3_f32 v10, v10, v48, v49
    v_max3_f32 v13, v13, v50, v51
    v_max3_f32 v10, v10, v52, v53
    v_max3_f32 v13, v13, v54, v55
    v_max3_f32 v10, v10, v56, v57
    v_max3_f32 v13, v13, v58, v59
    v_max3_f32 v10, v10, v60, v61
    v_max3_f32 v13, v13, v62, v63
    v_max_f32 v10, v10, v13
    v_mov_b32 v13, v10
    s_nop 1
    v_permlane32_swap_b32 v10, v13
    v_max_f32 v10, v10, v13
    v_sub_f32 v160, 0, v10
    v_sub_f32 v161, 0, v10
    v_sub_f32 v162, 0, v10
    v_sub_f32 v163, 0, v10
    v_sub_f32 v164, 0, v10
    v_sub_f32 v165, 0, v10
    v_sub_f32 v166, 0, v10
    v_sub_f32 v167, 0, v10
    v_sub_f32 v168, 0, v10
    v_sub_f32 v169, 0, v10
    v_sub_f32 v170, 0, v10
    v_sub_f32 v171, 0, v10
    v_sub_f32 v172, 0, v10
    v_sub_f32 v173, 0, v10
    v_sub_f32 v174, 0, v10
    v_sub_f32 v175, 0, v10
    s_nop 1
    v_mfma_f32_32x32x16_bf16 v[16:31], a[16:19], a[4:7], v[160:175]
    v_mfma_f32_32x32x16_bf16 v[32:47], a[20:23], a[4:7], v[160:175]
    v_sub_f32 v64, v64, v10
    v_sub_f32 v65, v65, v10
    v_sub_f32 v66, v66, v10
    v_sub_f32 v67, v67, v10
    v_sub_f32 v68, v68, v10
    v_sub_f32 v69, v69, v10
    v_sub_f32 v70, v70, v10
    v_sub_f32 v71, v71, v10
    v_sub_f32 v72, v72, v10
    v_sub_f32 v73, v73, v10
    v_sub_f32 v74, v74, v10
    v_sub_f32 v75, v75, v10
    v_sub_f32 v76, v76, v10
    v_sub_f32 v77, v77, v10
    v_sub_f32 v78, v78, v10
    v_sub_f32 v79, v79, v10
    v_exp_f32 v64, v64
    v_exp_f32 v65, v65
    v_exp_f32 v66, v66
    v_exp_f32 v67, v67
    v_exp_f32 v68, v68
    v_exp_f32 v69, v69
    v_exp_f32 v70, v70
    v_exp_f32 v71, v71
    v_exp_f32 v72, v72
    v_exp_f32 v73, v73
    v_exp_f32 v74, v74
    v_exp_f32 v75, v75
    v_exp_f32 v76, v76
    v_exp_f32 v77, v77
    v_exp_f32 v78, v78
    v_exp_f32 v79, v79
    v_cvt_pk_bf16_f32 v128, v64, v65
    v_cvt_pk_bf16_f32 v129, v66, v67
    v_cvt_pk_bf16_f32 v130, v68, v69
    v_cvt_pk_bf16_f32 v131, v70, v71
    v_cvt_pk_bf16_f32 v132, v72, v73
    v_cvt_pk_bf16_f32 v133, v74, v75
    v_cvt_pk_bf16_f32 v134, v76, v77
    v_cvt_pk_bf16_f32 v135, v78, v79
    v_mfma_f32_32x32x16_bf16 v[112:127], a[120:123], v[128:131], 0
    v_exp_f32 v16, v16
    v_exp_f32 v17, v17
    v_exp_f32 v18, v18
    v_exp_f32 v19, v19
    v_mfma_f32_32x32x16_bf16 v[112:127], a[124:127], v[132:135], v[112:127]
    v_exp_f32 v20, v20
    v_exp_f32 v21, v21
    v_exp_f32 v22, v22
    v_exp_f32 v23, v23
    v_mfma_f32_32x32x16_bf16 v[48:63], a[24:27], a[4:7], v[160:175]
    v_exp_f32 v24, v24
    v_exp_f32 v25, v25
    v_exp_f32 v26, v26
    v_exp_f32 v27, v27
    v_exp_f32 v28, v28
    v_exp_f32 v29, v29
    v_exp_f32 v30, v30
    v_exp_f32 v31, v31
    v_cvt_pk_bf16_f32 v128, v16, v17
    v_cvt_pk_bf16_f32 v129, v18, v19
    v_cvt_pk_bf16_f32 v130, v20, v21
    v_cvt_pk_bf16_f32 v131, v22, v23
    v_cvt_pk_bf16_f32 v132, v24, v25
    v_cvt_pk_bf16_f32 v133, v26, v27
    v_cvt_pk_bf16_f32 v134, v28, v29
    v_cvt_pk_bf16_f32 v135, v30, v31
    v_mfma_f32_32x32x16_bf16 v[112:127], a[64:67], v[128:131], v[112:127]
    v_exp_f32 v32, v32
    v_exp_f32 v33, v33
    v_exp_f32 v34, v34
    v_exp_f32 v35, v35
    v_mfma_f32_32x32x16_bf16 v[112:127], a[68:71], v[132:135], v[112:127]
    v_exp_f32 v36, v36
    v_exp_f32 v37, v37
    v_exp_f32 v38, v38
    v_exp_f32 v39, v39
    v_mfma_f32_32x32x16_bf16 v[16:31], a[28:31], a[4:7], v[160:175]
    v_exp_f32 v40, v40
    v_exp_f32 v41, v41
    v_exp_f32 v42, v42
    v_exp_f32 v43, v43
    v_exp_f32 v44, v44
    v_exp_f32 v45, v45
    v_exp_f32 v46, v46
    v_exp_f32 v47, v47
    v_cvt_pk_bf16_f32 v128, v32, v33
    v_cvt_pk_bf16_f32 v129, v34, v35
    v_cvt_pk_bf16_f32 v130, v36, v37
    v_cvt_pk_bf16_f32 v131, v38, v39
    v_cvt_pk_bf16_f32 v132, v40, v41
    v_cvt_pk_bf16_f32 v133, v42, v43
    v_cvt_pk_bf16_f32 v134, v44, v45
    v_cvt_pk_bf16_f32 v135, v46, v47
    v_mfma_f32_32x32x16_bf16 v[112:127], a[72:75], v[128:131], v[112:127]
    v_exp_f32 v48, v48
    v_exp_f32 v49, v49
    v_exp_f32 v50, v50
    v_exp_f32 v51, v51
    v_mfma_f32_32x32x16_bf16 v[112:127], a[76:79], v[132:135], v[112:127]
    v_exp_f32 v52, v52
    v_exp_f32 v53, v53
    v_exp_f32 v54, v54
    v_exp_f32 v55, v55
    v_mfma_f32_32x32x16_bf16 v[32:47], a[32:35], a[4:7], v[160:175]
    v_exp_f32 v56, v56
    v_exp_f32 v57, v57
    v_exp_f32 v58, v58
    v_exp_f32 v59, v59
    v_exp_f32 v60, v60
    v_exp_f32 v61, v61
    v_exp_f32 v62, v62
    v_exp_f32 v63, v63
    v_cvt_pk_bf16_f32 v128, v48, v49
    v_cvt_pk_bf16_f32 v129, v50, v51
    v_cvt_pk_bf16_f32 v130, v52, v53
    v_cvt_pk_bf16_f32 v131, v54, v55
    v_cvt_pk_bf16_f32 v132, v56, v57
    v_cvt_pk_bf16_f32 v133, v58, v59
    v_cvt_pk_bf16_f32 v134, v60, v61
    v_cvt_pk_bf16_f32 v135, v62, v63
    v_mfma_f32_32x32x16_bf16 v[112:127], a[80:83], v[128:131], v[112:127]
    v_exp_f32 v16, v16
    v_exp_f32 v17, v17
    v_exp_f32 v18, v18
    v_exp_f32 v19, v19
    v_mfma_f32_32x32x16_bf16 v[112:127], a[84:87], v[132:135], v[112:127]
    v_exp_f32 v20, v20
    v_exp_f32 v21, v21
    v_exp_f32 v22, v22
    v_exp_f32 v23, v23
    v_mfma_f32_32x32x16_bf16 v[48:63], a[36:39], a[4:7], v[160:175]
    v_exp_f32 v24, v24
    v_exp_f32 v25, v25
    v_exp_f32 v26, v26
    v_exp_f32 v27, v27
    v_exp_f32 v28, v28
    v_exp_f32 v29, v29
    v_exp_f32 v30, v30
    v_exp_f32 v31, v31
    v_cvt_pk_bf16_f32 v128, v16, v17
    v_cvt_pk_bf16_f32 v129, v18, v19
    v_cvt_pk_bf16_f32 v130, v20, v21
    v_cvt_pk_bf16_f32 v131, v22, v23
    v_cvt_pk_bf16_f32 v132, v24, v25
    v_cvt_pk_bf16_f32 v133, v26, v27
    v_cvt_pk_bf16_f32 v134, v28, v29
    v_cvt_pk_bf16_f32 v135, v30, v31
    v_mfma_f32_32x32x16_bf16 v[112:127], a[88:91], v[128:131], v[112:127]
    v_exp_f32 v32, v32
    v_exp_f32 v33, v33
    v_exp_f32 v34, v34
    v_exp_f32 v35, v35
    v_mfma_f32_32x32x16_bf16 v[112:127], a[92:95], v[132:135], v[112:127]
    v_exp_f32 v36, v36
    v_exp_f32 v37, v37
    v_exp_f32 v38, v38
    v_exp_f32 v39, v39
    v_mfma_f32_32x32x16_bf16 v[16:31], a[40:43], a[4:7], v[160:175]
    v_exp_f32 v40, v40
    v_exp_f32 v41, v41
    v_exp_f32 v42, v42
    v_exp_f32 v43, v43
    v_exp_f32 v44, v44
    v_exp_f32 v45, v45
    v_exp_f32 v46, v46
    v_exp_f32 v47, v47
    v_cvt_pk_bf16_f32 v128, v32, v33
    v_cvt_pk_bf16_f32 v129, v34, v35
    v_cvt_pk_bf16_f32 v130, v36, v37
    v_cvt_pk_bf16_f32 v131, v38, v39
    v_cvt_pk_bf16_f32 v132, v40, v41
    v_cvt_pk_bf16_f32 v133, v42, v43
    v_cvt_pk_bf16_f32 v134, v44, v45
    v_cvt_pk_bf16_f32 v135, v46, v47
    v_mfma_f32_32x32x16_bf16 v[112:127], a[96:99], v[128:131], v[112:127]
    v_exp_f32 v48, v48
    v_exp_f32 v49, v49
    v_exp_f32 v50, v50
    v_exp_f32 v51, v51
    v_mfma_f32_32x32x16_bf16 v[112:127], a[100:103], v[132:135], v[112:127]
    v_exp_f32 v52, v52
    v_exp_f32 v53, v53
    v_exp_f32 v54, v54
    v_exp_f32 v55, v55
    v_exp_f32 v56, v56
    v_exp_f32 v57, v57
    v_exp_f32 v58, v58
    v_exp_f32 v59, v59
    v_exp_f32 v60, v60
    v_exp_f32 v61, v61
    v_exp_f32 v62, v62
    v_exp_f32 v63, v63
    v_cvt_pk_bf16_f32 v128, v48, v49
    v_cvt_pk_bf16_f32 v129, v50, v51
    v_cvt_pk_bf16_f32 v130, v52, v53
    v_cvt_pk_bf16_f32 v131, v54, v55
    v_cvt_pk_bf16_f32 v132, v56, v57
    v_cvt_pk_bf16_f32 v133, v58, v59
    v_cvt_pk_bf16_f32 v134, v60, v61
    v_cvt_pk_bf16_f32 v135, v62, v63
    v_mfma_f32_32x32x16_bf16 v[112:127], a[104:107], v[128:131], v[112:127]
    v_exp_f32 v16, v16
    v_exp_f32 v17, v17
    v_exp_f32 v18, v18
    v_exp_f32 v19, v19
    v_mfma_f32_32x32x16_bf16 v[112:127], a[108:111], v[132:135], v[112:127]
    v_exp_f32 v20, v20
    v_exp_f32 v21, v21
    v_exp_f32 v22, v22
    v_exp_f32 v23, v23
    v_exp_f32 v24, v24
    v_exp_f32 v25, v25
    v_exp_f32 v26, v26
    v_exp_f32 v27, v27
    v_exp_f32 v28, v28
    v_exp_f32 v29, v29
    v_exp_f32 v30, v30
    v_exp_f32 v31, v31
    v_cvt_pk_bf16_f32 v128, v16, v17
    v_cvt_pk_bf16_f32 v129, v18, v19
    v_cvt_pk_bf16_f32 v130, v20, v21
    v_cvt_pk_bf16_f32 v131, v22, v23
    v_cvt_pk_bf16_f32 v132, v24, v25
    v_cvt_pk_bf16_f32 v133, v26, v27
    v_cvt_pk_bf16_f32 v134, v28, v29
    v_cvt_pk_bf16_f32 v135, v30, v31
    v_mfma_f32_32x32x16_bf16 v[112:127], a[112:115], v[128:131], v[112:127]
    s_nop 0
    v_mfma_f32_32x32x16_bf16 v[112:127], a[116:119], v[132:135], v[112:127]
    s_nop 11
    s_branch Lfr_2_1
Lfb_4_0:
    s_waitcnt vmcnt(0)
    s_nop 3
    v_mfma_f32_32x32x16_bf16 v[32:47], a[40:43], a[0:3], 0
    v_mfma_f32_32x32x16_bf16 v[48:63], a[24:27], a[0:3], 0
    s_nop 10
    v_cndmask_b32 v64, v8, v32, s[70:71]
    v_cndmask_b32 v65, v8, v33, s[72:73]
    v_cndmask_b32 v66, v8, v34, s[74:75]
    v_cndmask_b32 v67, v8, v35, s[76:77]
    v_cndmask_b32 v68, v8, v36, s[78:79]
    v_cndmask_b32 v69, v8, v37, s[80:81]
    v_cndmask_b32 v70, v8, v38, s[82:83]
    v_cndmask_b32 v71, v8, v39, s[84:85]
    s_nop 2
    v_cndmask_b32 v72, v8, v40, s[86:87]
    v_cndmask_b32 v73, v8, v41, s[88:89]
    v_cndmask_b32 v74, v8, v42, s[90:91]
    v_cndmask_b32 v75, v8, v43, s[92:93]
    v_cndmask_b32 v76, v8, v44, s[94:95]
    v_cndmask_b32 v77, v8, v45, s[96:97]
    v_cndmask_b32 v78, v8, v46, s[98:99]
    v_cndmask_b32 v79, v8, v47, s[100:101]
    v_mfma_f32_32x32x16_bf16 v[16:31], a[28:31], a[0:3], 0
    v_max_f32 v10, v64, v65
    v_max_f32 v13, v66, v67
    v_max3_f32 v10, v10, v68, v69
    v_max3_f32 v13, v13, v70, v71
    v_max3_f32 v10, v10, v72, v73
    v_max3_f32 v13, v13, v74, v75
    v_max3_f32 v10, v10, v76, v77
    v_max3_f32 v13, v13, v78, v79
    v_mfma_f32_32x32x16_bf16 v[32:47], a[32:35], a[0:3], 0
    v_max3_f32 v10, v10, v48, v49
    v_max3_f32 v13, v13, v50, v51
    v_max3_f32 v10, v10, v52, v53
    v_max3_f32 v13, v13, v54, v55
    v_max3_f32 v10, v10, v56, v57
    v_max3_f32 v13, v13, v58, v59
    v_max3_f32 v10, v10, v60, v61
    v_max3_f32 v13, v13, v62, v63
    v_mfma_f32_32x32x16_bf16 v[48:63], a[36:39], a[0:3], 0
    v_max3_f32 v10, v10, v16, v17
    v_max3_f32 v13, v13, v18, v19
    v_max3_f32 v10, v10, v20, v21
    v_max3_f32 v13, v13, v22, v23
    v_max3_f32 v10, v10, v24, v25
    v_max3_f32 v13, v13, v26, v27
    v_max3_f32 v10, v10, v28, v29
    v_max3_f32 v13, v13, v30, v31
    v_max3_f32 v10, v10, v32, v33
    v_max3_f32 v13, v13, v34, v35
    v_max3_f32 v10, v10, v36, v37
    v_max3_f32 v13, v13, v38, v39
    v_max3_f32 v10, v10, v40, v41
    v_max3_f32 v13, v13, v42, v43
    v_max3_f32 v10, v10, v44, v45
    v_max3_f32 v13, v13, v46, v47
    v_max3_f32 v10, v10, v48, v49
    v_max3_f32 v13, v13, v50, v51
    v_max3_f32 v10, v10, v52, v53
    v_max3_f32 v13, v13, v54, v55
    v_max3_f32 v10, v10, v56, v57
    v_max3_f32 v13, v13, v58, v59
    v_max3_f32 v10, v10, v60, v61
    v_max3_f32 v13, v13, v62, v63
    v_max_f32 v10, v10, v13
    v_mov_b32 v13, v10
    s_nop 1
    v_permlane32_swap_b32 v10, v13
    v_max_f32 v10, v10, v13
    v_sub_f32 v160, 0, v10
    v_sub_f32 v161, 0, v10
    v_sub_f32 v162, 0, v10
    v_sub_f32 v163, 0, v10
    v_sub_f32 v164, 0, v10
    v_sub_f32 v165, 0, v10
    v_sub_f32 v166, 0, v10
    v_sub_f32 v167, 0, v10
    v_sub_f32 v168, 0, v10
    v_sub_f32 v169, 0, v10
    v_sub_f32 v170, 0, v10
    v_sub_f32 v171, 0, v10
    v_sub_f32 v172, 0, v10
    v_sub_f32 v173, 0, v10
    v_sub_f32 v174, 0, v10
    v_sub_f32 v175, 0, v10
    s_nop 1
    v_mfma_f32_32x32x16_bf16 v[16:31], a[24:27], a[0:3], v[160:175]
    v_mfma_f32_32x32x16_bf16 v[32:47], a[28:31], a[0:3], v[160:175]
    v_sub_f32 v64, v64, v10
    v_sub_f32 v65, v65, v10
    v_sub_f32 v66, v66, v10
    v_sub_f32 v67, v67, v10
    v_sub_f32 v68, v68, v10
    v_sub_f32 v69, v69, v10
    v_sub_f32 v70, v70, v10
    v_sub_f32 v71, v71, v10
    v_sub_f32 v72, v72, v10
    v_sub_f32 v73, v73, v10
    v_sub_f32 v74, v74, v10
    v_sub_f32 v75, v75, v10
    v_sub_f32 v76, v76, v10
    v_sub_f32 v77, v77, v10
    v_sub_f32 v78, v78, v10
    v_sub_f32 v79, v79, v10
    v_exp_f32 v64, v64
    v_exp_f32 v65, v65
    v_exp_f32 v66, v66
    v_exp_f32 v67, v67
    v_exp_f32 v68, v68
    v_exp_f32 v69, v69
    v_exp_f32 v70, v70
    v_exp_f32 v71, v71
    v_exp_f32 v72, v72
    v_exp_f32 v73, v73
    v_exp_f32 v74, v74
    v_exp_f32 v75, v75
    v_exp_f32 v76, v76
    v_exp_f32 v77, v77
    v_exp_f32 v78, v78
    v_exp_f32 v79, v79
    v_cvt_pk_bf16_f32 v128, v64, v65
    v_cvt_pk_bf16_f32 v129, v66, v67
    v_cvt_pk_bf16_f32 v130, v68, v69
    v_cvt_pk_bf16_f32 v131, v70, v71
    v_cvt_pk_bf16_f32 v132, v72, v73
    v_cvt_pk_bf16_f32 v133, v74, v75
    v_cvt_pk_bf16_f32 v134, v76, v77
    v_cvt_pk_bf16_f32 v135, v78, v79
    v_mfma_f32_32x32x16_bf16 v[96:111], a[112:115], v[128:131], 0
    v_exp_f32 v16, v16
    v_exp_f32 v17, v17
    v_exp_f32 v18, v18
    v_exp_f32 v19, v19
    v_mfma_f32_32x32x16_bf16 v[96:111], a[116:119], v[132:135], v[96:111]
    v_exp_f32 v20, v20
    v_exp_f32 v21, v21
    v_exp_f32 v22, v22
    v_exp_f32 v23, v23
    v_mfma_f32_32x32x16_bf16 v[48:63], a[32:35], a[0:3], v[160:175]
    v_exp_f32 v24, v24
    v_exp_f32 v25, v25
    v_exp_f32 v26, v26
    v_exp_f32 v27, v27
    v_exp_f32 v28, v28
    v_exp_f32 v29, v29
    v_exp_f32 v30, v30
    v_exp_f32 v31, v31
    v_cvt_pk_bf16_f32 v128, v16, v17
    v_cvt_pk_bf16_f32 v129, v18, v19
    v_cvt_pk_bf16_f32 v130, v20, v21
    v_cvt_pk_bf16_f32 v131, v22, v23
    v_cvt_pk_bf16_f32 v132, v24, v25
    v_cvt_pk_bf16_f32 v133, v26, v27
    v_cvt_pk_bf16_f32 v134, v28, v29
    v_cvt_pk_bf16_f32 v135, v30, v31
    v_mfma_f32_32x32x16_bf16 v[96:111], a[80:83], v[128:131], v[96:111]
    v_exp_f32 v32, v32
    v_exp_f32 v33, v33
    v_exp_f32 v34, v34
    v_exp_f32 v35, v35
    v_mfma_f32_32x32x16_bf16 v[96:111], a[84:87], v[132:135], v[96:111]
    v_exp_f32 v36, v36
    v_exp_f32 v37, v37
    v_exp_f32 v38, v38
    v_exp_f32 v39, v39
    v_mfma_f32_32x32x16_bf16 v[16:31], a[36:39], a[0:3], v[160:175]
    v_exp_f32 v40, v40
    v_exp_f32 v41, v41
    v_exp_f32 v42, v42
    v_exp_f32 v43, v43
    v_exp_f32 v44, v44
    v_exp_f32 v45, v45
    v_exp_f32 v46, v46
    v_exp_f32 v47, v47
    v_cvt_pk_bf16_f32 v128, v32, v33
    v_cvt_pk_bf16_f32 v129, v34, v35
    v_cvt_pk_bf16_f32 v130, v36, v37
    v_cvt_pk_bf16_f32 v131, v38, v39
    v_cvt_pk_bf16_f32 v132, v40, v41
    v_cvt_pk_bf16_f32 v133, v42, v43
    v_cvt_pk_bf16_f32 v134, v44, v45
    v_cvt_pk_bf16_f32 v135, v46, v47
    v_mfma_f32_32x32x16_bf16 v[96:111], a[88:91], v[128:131], v[96:111]
    v_exp_f32 v48, v48
    v_exp_f32 v49, v49
    v_exp_f32 v50, v50
    v_exp_f32 v51, v51
    v_mfma_f32_32x32x16_bf16 v[96:111], a[92:95], v[132:135], v[96:111]
    v_exp_f32 v52, v52
    v_exp_f32 v53, v53
    v_exp_f32 v54, v54
    v_exp_f32 v55, v55
    v_exp_f32 v56, v56
    v_exp_f32 v57, v57
    v_exp_f32 v58, v58
    v_exp_f32 v59, v59
    v_exp_f32 v60, v60
    v_exp_f32 v61, v61
    v_exp_f32 v62, v62
    v_exp_f32 v63, v63
    v_cvt_pk_bf16_f32 v128, v48, v49
    v_cvt_pk_bf16_f32 v129, v50, v51
    v_cvt_pk_bf16_f32 v130, v52, v53
    v_cvt_pk_bf16_f32 v131, v54, v55
    v_cvt_pk_bf16_f32 v132, v56, v57
    v_cvt_pk_bf16_f32 v133, v58, v59
    v_cvt_pk_bf16_f32 v134, v60, v61
    v_cvt_pk_bf16_f32 v135, v62, v63
    v_mfma_f32_32x32x16_bf16 v[96:111], a[96:99], v[128:131], v[96:111]
    v_exp_f32 v16, v16
    v_exp_f32 v17, v17
    v_exp_f32 v18, v18
    v_exp_f32 v19, v19
    v_mfma_f32_32x32x16_bf16 v[96:111], a[100:103], v[132:135], v[96:111]
    v_exp_f32 v20, v20
    v_exp_f32 v21, v21
    v_exp_f32 v22, v22
    v_exp_f32 v23, v23
    v_exp_f32 v24, v24
    v_exp_f32 v25, v25
    v_exp_f32 v26, v26
    v_exp_f32 v27, v27
    v_exp_f32 v28, v28
    v_exp_f32 v29, v29
    v_exp_f32 v30, v30
    v_exp_f32 v31, v31
    v_cvt_pk_bf16_f32 v128, v16, v17
    v_cvt_pk_bf16_f32 v129, v18, v19
    v_cvt_pk_bf16_f32 v130, v20, v21
    v_cvt_pk_bf16_f32 v131, v22, v23
    v_cvt_pk_bf16_f32 v132, v24, v25
    v_cvt_pk_bf16_f32 v133, v26, v27
    v_cvt_pk_bf16_f32 v134, v28, v29
    v_cvt_pk_bf16_f32 v135, v30, v31
    v_mfma_f32_32x32x16_bf16 v[96:111], a[104:107], v[128:131], v[96:111]
    s_nop 0
    v_mfma_f32_32x32x16_bf16 v[96:111], a[108:111], v[132:135], v[96:111]
    v_mfma_f32_32x32x16_bf16 v[32:47], a[44:47], a[4:7], 0
    v_mfma_f32_32x32x16_bf16 v[48:63], a[24:27], a[4:7], 0
    s_nop 11
    s_branch Lfr_4_0
Lfb_4_1:
    s_waitcnt vmcnt(0)
    v_mfma_f32_32x32x16_bf16 v[32:47], a[44:47], a[4:7], 0
    v_mfma_f32_32x32x16_bf16 v[48:63], a[24:27], a[4:7], 0
    s_nop 10
    v_cndmask_b32 v64, v8, v32, s[70:71]
    v_cndmask_b32 v65, v8, v33, s[72:73]
    v_cndmask_b32 v66, v8, v34, s[74:75]
    v_cndmask_b32 v67, v8, v35, s[76:77]
    v_cndmask_b32 v68, v8, v36, s[78:79]
    v_cndmask_b32 v69, v8, v37, s[80:81]
    s_nop 4
    v_cndmask_b32 v70, v8, v38, s[82:83]
    v_cndmask_b32 v71, v8, v39, s[84:85]
    v_cndmask_b32 v72, v8, v40, s[86:87]
    v_cndmask_b32 v73, v8, v41, s[88:89]
    v_cndmask_b32 v74, v8, v42, s[90:91]
    v_cndmask_b32 v75, v8, v43, s[92:93]
    v_cndmask_b32 v76, v8, v44, s[94:95]
    v_cndmask_b32 v77, v8, v45, s[96:97]
    v_cndmask_b32 v78, v8, v46, s[98:99]
    v_cndmask_b32 v79, v8, v47, s[100:101]
    v_mfma_f32_32x32x16_bf16 v[16:31], a[28:31], a[4:7], 0
    v_max_f32 v10, v64, v65
    v_max_f32 v13, v66, v67
    v_max3_f32 v10, v10, v68, v69
    v_max3_f32 v13, v13, v70, v71
    v_max3_f32 v10, v10, v72, v73
    v_max3_f32 v13, v13, v74, v75
    v_max3_f32 v10, v10, v76, v77
    v_max3_f32 v13, v13, v78, v79
    v_mfma_f32_32x32x16_bf16 v[32:47], a[32:35], a[4:7], 0
    v_max3_f32 v10, v10, v48, v49
    v_max3_f32 v13, v13, v50, v51
    v_max3_f32 v10, v10, v52, v53
    v_max3_f32 v13, v13, v54, v55
    v_max3_f32 v10, v10, v56, v57
    v_max3_f32 v13, v13, v58, v59
    v_max3_f32 v10, v10, v60, v61
    v_max3_f32 v13, v13, v62, v63
    v_mfma_f32_32x32x16_bf16 v[48:63], a[36:39], a[4:7], 0
    v_max3_f32 v10, v10, v16, v17
    v_max3_f32 v13, v13, v18, v19
    v_max3_f32 v10, v10, v20, v21
    v_max3_f32 v13, v13, v22, v23
    v_max3_f32 v10, v10, v24, v25
    v_max3_f32 v13, v13, v26, v27
    v_max3_f32 v10, v10, v28, v29
    v_max3_f32 v13, v13, v30, v31
    v_mfma_f32_32x32x16_bf16 v[16:31], a[40:43], a[4:7], 0
    v_max3_f32 v10, v10, v32, v33
    v_max3_f32 v13, v13, v34, v35
    v_max3_f32 v10, v10, v36, v37
    v_max3_f32 v13, v13, v38, v39
    v_max3_f32 v10, v10, v40, v41
    v_max3_f32 v13, v13, v42, v43
    v_max3_f32 v10, v10, v44, v45
    v_max3_f32 v13, v13, v46, v47
    v_max3_f32 v10, v10, v48, v49
    v_max3_f32 v13, v13, v50, v51
    v_max3_f32 v10, v10, v52, v53
    v_max3_f32 v13, v13, v54, v55
    v_max3_f32 v10, v10, v56, v57
    v_max3_f32 v13, v13, v58, v59
    v_max3_f32 v10, v10, v60, v61
    v_max3_f32 v13, v13, v62, v63
    v_max3_f32 v10, v10, v16, v17
    v_max3_f32 v13, v13, v18, v19
    v_max3_f32 v10, v10, v20, v21
    v_max3_f32 v13, v13, v22, v23
    v_max3_f32 v10, v10, v24, v25
    v_max3_f32 v13, v13, v26, v27
    v_max3_f32 v10, v10, v28, v29
    v_max3_f32 v13, v13, v30, v31
    v_max_f32 v10, v10, v13
    v_mov_b32 v13, v10
    s_nop 1
    v_permlane32_swap_b32 v10, v13
    v_max_f32 v10, v10, v13
    v_sub_f32 v160, 0, v10
    v_sub_f32 v161, 0, v10
    v_sub_f32 v162, 0, v10
    v_sub_f32 v163, 0, v10
    v_sub_f32 v164, 0, v10
    v_sub_f32 v165, 0, v10
    v_sub_f32 v166, 0, v10
    v_sub_f32 v167, 0, v10
    v_sub_f32 v168, 0, v10
    v_sub_f32 v169, 0, v10
    v_sub_f32 v170, 0, v10
    v_sub_f32 v171, 0, v10
    v_sub_f32 v172, 0, v10
    v_sub_f32 v173, 0, v10
    v_sub_f32 v174, 0, v10
    v_sub_f32 v175, 0, v10
    s_nop 1
    v_mfma_f32_32x32x16_bf16 v[16:31], a[24:27], a[4:7], v[160:175]
    v_mfma_f32_32x32x16_bf16 v[32:47], a[28:31], a[4:7], v[160:175]
    v_sub_f32 v64, v64, v10
    v_sub_f32 v65, v65, v10
    v_sub_f32 v66, v66, v10
    v_sub_f32 v67, v67, v10
    v_sub_f32 v68, v68, v10
    v_sub_f32 v69, v69, v10
    v_sub_f32 v70, v70, v10
    v_sub_f32 v71, v71, v10
    v_sub_f32 v72, v72, v10
    v_sub_f32 v73, v73, v10
    v_sub_f32 v74, v74, v10
    v_sub_f32 v75, v75, v10
    v_sub_f32 v76, v76, v10
    v_sub_f32 v77, v77, v10
    v_sub_f32 v78, v78, v10
    v_sub_f32 v79, v79, v10
    v_exp_f32 v64, v64
    v_exp_f32 v65, v65
    v_exp_f32 v66, v66
    v_exp_f32 v67, v67
    v_exp_f32 v68, v68
    v_exp_f32 v69, v69
    v_exp_f32 v70, v70
    v_exp_f32 v71, v71
    v_exp_f32 v72, v72
    v_exp_f32 v73, v73
    v_exp_f32 v74, v74
    v_exp_f32 v75, v75
    v_exp_f32 v76, v76
    v_exp_f32 v77, v77
    v_exp_f32 v78, v78
    v_exp_f32 v79, v79
    v_cvt_pk_bf16_f32 v128, v64, v65
    v_cvt_pk_bf16_f32 v129, v66, v67
    v_cvt_pk_bf16_f32 v130, v68, v69
    v_cvt_pk_bf16_f32 v131, v70, v71
    v_cvt_pk_bf16_f32 v132, v72, v73
    v_cvt_pk_bf16_f32 v133, v74, v75
    v_cvt_pk_bf16_f32 v134, v76, v77
    v_cvt_pk_bf16_f32 v135, v78, v79
    v_mfma_f32_32x32x16_bf16 v[112:127], a[120:123], v[128:131], 0
    v_exp_f32 v16, v16
    v_exp_f32 v17, v17
    v_exp_f32 v18, v18
    v_exp_f32 v19, v19
    v_mfma_f32_32x32x16_bf16 v[112:127], a[124:127], v[132:135], v[112:127]
    v_exp_f32 v20, v20
    v_exp_f32 v21, v21
    v_exp_f32 v22, v22
    v_exp_f32 v23, v23
    v_mfma_f32_32x32x16_bf16 v[48:63], a[32:35], a[4:7], v[160:175]
    v_exp_f32 v24, v24
    v_exp_f32 v25, v25
    v_exp_f32 v26, v26
    v_exp_f32 v27, v27
    v_exp_f32 v28, v28
    v_exp_f32 v29, v29
    v_exp_f32 v30, v30
    v_exp_f32 v31, v31
    v_cvt_pk_bf16_f32 v128, v16, v17
    v_cvt_pk_bf16_f32 v129, v18, v19
    v_cvt_pk_bf16_f32 v130, v20, v21
    v_cvt_pk_bf16_f32 v131, v22, v23
    v_cvt_pk_bf16_f32 v132, v24, v25
    v_cvt_pk_bf16_f32 v133, v26, v27
    v_cvt_pk_bf16_f32 v134, v28, v29
    v_cvt_pk_bf16_f32 v135, v30, v31
    v_mfma_f32_32x32x16_bf16 v[112:127], a[80:83], v[128:131], v[112:127]
    v_exp_f32 v32, v32
    v_exp_f32 v33, v33
    v_exp_f32 v34, v34
    v_exp_f32 v35, v35
    v_mfma_f32_32x32x16_bf16 v[112:127], a[84:87], v[132:135], v[112:127]
    v_exp_f32 v36, v36
    v_exp_f32 v37, v37
    v_exp_f32 v38, v38
    v_exp_f32 v39, v39
    v_mfma_f32_32x32x16_bf16 v[16:31], a[36:39], a[4:7], v[160:175]
    v_exp_f32 v40, v40
    v_exp_f32 v41, v41
    v_exp_f32 v42, v42
    v_exp_f32 v43, v43
    v_exp_f32 v44, v44
    v_exp_f32 v45, v45
    v_exp_f32 v46, v46
    v_exp_f32 v47, v47
    v_cvt_pk_bf16_f32 v128, v32, v33
    v_cvt_pk_bf16_f32 v129, v34, v35
    v_cvt_pk_bf16_f32 v130, v36, v37
    v_cvt_pk_bf16_f32 v131, v38, v39
    v_cvt_pk_bf16_f32 v132, v40, v41
    v_cvt_pk_bf16_f32 v133, v42, v43
    v_cvt_pk_bf16_f32 v134, v44, v45
    v_cvt_pk_bf16_f32 v135, v46, v47
    v_mfma_f32_32x32x16_bf16 v[112:127], a[88:91], v[128:131], v[112:127]
    v_exp_f32 v48, v48
    v_exp_f32 v49, v49
    v_exp_f32 v50, v50
    v_exp_f32 v51, v51
    v_mfma_f32_32x32x16_bf16 v[112:127], a[92:95], v[132:135], v[112:127]
    v_exp_f32 v52, v52
    v_exp_f32 v53, v53
    v_exp_f32 v54, v54
    v_exp_f32 v55, v55
    v_mfma_f32_32x32x16_bf16 v[32:47], a[40:43], a[4:7], v[160:175]
    v_exp_f32 v56, v56
    v_exp_f32 v57, v57
    v_exp_f32 v58, v58
    v_exp_f32 v59, v59
    v_exp_f32 v60, v60
    v_exp_f32 v61, v61
    v_exp_f32 v62, v62
    v_exp_f32 v63, v63
    v_cvt_pk_bf16_f32 v128, v48, v49
    v_cvt_pk_bf16_f32 v129, v50, v51
    v_cvt_pk_bf16_f32 v130, v52, v53
    v_cvt_pk_bf16_f32 v131, v54, v55
    v_cvt_pk_bf16_f32 v132, v56, v57
    v_cvt_pk_bf16_f32 v133, v58, v59
    v_cvt_pk_bf16_f32 v134, v60, v61
    v_cvt_pk_bf16_f32 v135, v62, v63
    v_mfma_f32_32x32x16_bf16 v[112:127], a[96:99], v[128:131], v[112:127]
    v_exp_f32 v16, v16
    v_exp_f32 v17, v17
    v_exp_f32 v18, v18
    v_exp_f32 v19, v19
    v_mfma_f32_32x32x16_bf16 v[112:127], a[100:103], v[132:135], v[112:127]
    v_exp_f32 v20, v20
    v_exp_f32 v21, v21
    v_exp_f32 v22, v22
    v_exp_f32 v23, v23
    v_exp_f32 v24, v24
    v_exp_f32 v25, v25
    v_exp_f32 v26, v26
    v_exp_f32 v27, v27
    v_exp_f32 v28, v28
    v_exp_f32 v29, v29
    v_exp_f32 v30, v30
    v_exp_f32 v31, v31
    v_cvt_pk_bf16_f32 v128, v16, v17
    v_cvt_pk_bf16_f32 v129, v18, v19
    v_cvt_pk_bf16_f32 v130, v20, v21
    v_cvt_pk_bf16_f32 v131, v22, v23
    v_cvt_pk_bf16_f32 v132, v24, v25
    v_cvt_pk_bf16_f32 v133, v26, v27
    v_cvt_pk_bf16_f32 v134, v28, v29
    v_cvt_pk_bf16_f32 v135, v30, v31
    v_mfma_f32_32x32x16_bf16 v[112:127], a[104:107], v[128:131], v[112:127]
    v_exp_f32 v32, v32
    v_exp_f32 v33, v33
    v_exp_f32 v34, v34
    v_exp_f32 v35, v35
    v_mfma_f32_32x32x16_bf16 v[112:127], a[108:111], v[132:135], v[112:127]
    v_exp_f32 v36, v36
    v_exp_f32 v37, v37
    v_exp_f32 v38, v38
    v_exp_f32 v39, v39
    v_exp_f32 v40, v40
    v_exp_f32 v41, v41
    v_exp_f32 v42, v42
    v_exp_f32 v43, v43
    v_exp_f32 v44, v44
    v_exp_f32 v45, v45
    v_exp_f32 v46, v46
    v_exp_f32 v47, v47
    v_cvt_pk_bf16_f32 v128, v32, v33
    v_cvt_pk_bf16_f32 v129, v34, v35
    v_cvt_pk_bf16_f32 v130, v36, v37
    v_cvt_pk_bf16_f32 v131, v38, v39
    v_cvt_pk_bf16_f32 v132, v40, v41
    v_cvt_pk_bf16_f32 v133, v42, v43
    v_cvt_pk_bf16_f32 v134, v44, v45
    v_cvt_pk_bf16_f32 v135, v46, v47
    v_mfma_f32_32x32x16_bf16 v[112:127], a[112:115], v[128:131], v[112:127]
    s_nop 0
    v_mfma_f32_32x32x16_bf16 v[112:127], a[116:119], v[132:135], v[112:127]
    s_nop 11
    s_branch Lfr_4_1
Lfb_6_0:
    s_waitcnt vmcnt(0)
    v_mfma_f32_32x32x16_bf16 v[32:47], a[40:43], a[0:3], 0
    v_mfma_f32_32x32x16_bf16 v[48:63], a[32:35], a[0:3], 0
    s_nop 10
    v_cndmask_b32 v64, v8, v32, s[70:71]
    v_cndmask_b32 v65, v8, v33, s[72:73]
    v_cndmask_b32 v66, v8, v34, s[74:75]
    v_cndmask_b32 v67, v8, v35, s[76:77]
    v_cndmask_b32 v68, v8, v36, s[78:79]
    v_cndmask_b32 v69, v8, v37, s[80:81]
    v_cndmask_b32 v70, v8, v38, s[82:83]
    v_cndmask_b32 v71, v8, v39, s[84:85]
    s_nop 2
    v_cndmask_b32 v72, v8, v40, s[86:87]
    v_cndmask_b32 v73, v8, v41, s[88:89]
    v_cndmask_b32 v74, v8, v42, s[90:91]
    v_cndmask_b32 v75, v8, v43, s[92:93]
    v_cndmask_b32 v76, v8, v44, s[94:95]
    v_cndmask_b32 v77, v8, v45, s[96:97]
    v_cndmask_b32 v78, v8, v46, s[98:99]
    v_cndmask_b32 v79, v8, v47, s[100:101]
    v_mfma_f32_32x32x16_bf16 v[16:31], a[36:39], a[0:3], 0
    v_max_f32 v10, v64, v65
    v_max_f32 v13, v66, v67
    v_max3_f32 v10, v10, v68, v69
    v_max3_f32 v13, v13, v70, v71
    v_max3_f32 v10, v10, v72, v73
    v_max3_f32 v13, v13, v74, v75
    v_max3_f32 v10, v10, v76, v77
    v_max3_f32 v13, v13, v78, v79
    v_max3_f32 v10, v10, v48, v49
    v_max3_f32 v13, v13, v50, v51
    v_max3_f32 v10, v10, v52, v53
    v_max3_f32 v13, v13, v54, v55
    v_max3_f32 v10, v10, v56, v57
    v_max3_f32 v13, v13, v58, v59
    v_max3_f32 v10, v10, v60, v61
    v_max3_f32 v13, v13, v62, v63
    v_max3_f32 v10, v10, v16, v17
    v_max3_f32 v13, v13, v18, v19
    v_max3_f32 v10, v10, v20, v21
    v_max3_f32 v13, v13, v22, v23
    v_max3_f32 v10, v10, v24, v25
    v_max3_f32 v13, v13, v26, v27
    v_max3_f32 v10, v10, v28, v29
    v_max3_f32 v13, v13, v30, v31
    v_max_f32 v10, v10, v13
    v_mov_b32 v13, v10
    s_nop 1
    v_permlane32_swap_b32 v10, v13
    v_max_f32 v10, v10, v13
    v_sub_f32 v160, 0, v10
    v_sub_f32 v161, 0, v10
    v_sub_f32 v162, 0, v10
    v_sub_f32 v163, 0, v10
    v_sub_f32 v164, 0, v10
    v_sub_f32 v165, 0, v10
    v_sub_f32 v166, 0, v10
    v_sub_f32 v167, 0, v10
    v_sub_f32 v168, 0, v10
    v_sub_f32 v169, 0, v10
    v_sub_f32 v170, 0, v10
    v_sub_f32 v171, 0, v10
    v_sub_f32 v172, 0, v10
    v_sub_f32 v173, 0, v10
    v_sub_f32 v174, 0, v10
    v_sub_f32 v175, 0, v10
    s_nop 1
    v_mfma_f32_32x32x16_bf16 v[16:31], a[32:35], a[0:3], v[160:175]
    v_mfma_f32_32x32x16_bf16 v[32:47], a[36:39], a[0:3], v[160:175]
    v_sub_f32 v64, v64, v10
    v_sub_f32 v65, v65, v10
    v_sub_f32 v66, v66, v10
    v_sub_f32 v67, v67, v10
    v_sub_f32 v68, v68, v10
    v_sub_f32 v69, v69, v10
    v_sub_f32 v70, v70, v10
    v_sub_f32 v71, v71, v10
    v_sub_f32 v72, v72, v10
    v_sub_f32 v73, v73, v10
    v_sub_f32 v74, v74, v10
    v_sub_f32 v75, v75, v10
    v_sub_f32 v76, v76, v10
    v_sub_f32 v77, v77, v10
    v_sub_f32 v78, v78, v10
    v_sub_f32 v79, v79, v10
    v_exp_f32 v64, v64
    v_exp_f32 v65, v65
    v_exp_f32 v66, v66
    v_exp_f32 v67, v67
    v_exp_f32 v68, v68
    v_exp_f32 v69, v69
    v_exp_f32 v70, v70
    v_exp_f32 v71, v71
    v_exp_f32 v72, v72
    v_exp_f32 v73, v73
    v_exp_f32 v74, v74
    v_exp_f32 v75, v75
    v_exp_f32 v76, v76
    v_exp_f32 v77, v77
    v_exp_f32 v78, v78
    v_exp_f32 v79, v79
    v_cvt_pk_bf16_f32 v128, v64, v65
    v_cvt_pk_bf16_f32 v129, v66, v67
    v_cvt_pk_bf16_f32 v130, v68, v69
    v_cvt_pk_bf16_f32 v131, v70, v71
    v_cvt_pk_bf16_f32 v132, v72, v73
    v_cvt_pk_bf16_f32 v133, v74, v75
    v_cvt_pk_bf16_f32 v134, v76, v77
    v_cvt_pk_bf16_f32 v135, v78, v79
    v_mfma_f32_32x32x16_bf16 v[96:111], a[112:115], v[128:131], 0
    v_exp_f32 v16, v16
    v_exp_f32 v17, v17
    v_exp_f32 v18, v18
    v_exp_f32 v19, v19
    v_mfma_f32_32x32x16_bf16 v[96:111], a[116:119], v[132:135], v[96:111]
    v_exp_f32 v20, v20
    v_exp_f32 v21, v21
    v_exp_f32 v22, v22
    v_exp_f32 v23, v23
    v_exp_f32 v24, v24
    v_exp_f32 v25, v25
    v_exp_f32 v26, v26
    v_exp_f32 v27, v27
    v_exp_f32 v28, v28
    v_exp_f32 v29, v29
    v_exp_f32 v30, v30
    v_exp_f32 v31, v31
    v_cvt_pk_bf16_f32 v128, v16, v17
    v_cvt_pk_bf16_f32 v129, v18, v19
    v_cvt_pk_bf16_f32 v130, v20, v21
    v_cvt_pk_bf16_f32 v131, v22, v23
    v_cvt_pk_bf16_f32 v132, v24, v25
    v_cvt_pk_bf16_f32 v133, v26, v27
    v_cvt_pk_bf16_f32 v134, v28, v29
    v_cvt_pk_bf16_f32 v135, v30, v31
    v_mfma_f32_32x32x16_bf16 v[96:111], a[96:99], v[128:131], v[96:111]
    v_exp_f32 v32, v32
    v_exp_f32 v33, v33
    v_exp_f32 v34, v34
    v_exp_f32 v35, v35
    v_mfma_f32_32x32x16_bf16 v[96:111], a[100:103], v[132:135], v[96:111]
    v_exp_f32 v36, v36
    v_exp_f32 v37, v37
    v_exp_f32 v38, v38
    v_exp_f32 v39, v39
    v_exp_f32 v40, v40
    v_exp_f32 v41, v41
    v_exp_f32 v42, v42
    v_exp_f32 v43, v43
    v_exp_f32 v44, v44
    v_exp_f32 v45, v45
    v_exp_f32 v46, v46
    v_exp_f32 v47, v47
    v_cvt_pk_bf16_f32 v128, v32, v33
    v_cvt_pk_bf16_f32 v129, v34, v35
    v_cvt_pk_bf16_f32 v130, v36, v37
    v_cvt_pk_bf16_f32 v131, v38, v39
    v_cvt_pk_bf16_f32 v132, v40, v41
    v_cvt_pk_bf16_f32 v133, v42, v43
    v_cvt_pk_bf16_f32 v134, v44, v45
    v_cvt_pk_bf16_f32 v135, v46, v47
    v_mfma_f32_32x32x16_bf16 v[96:111], a[104:107], v[128:131], v[96:111]
    s_nop 0
    v_mfma_f32_32x32x16_bf16 v[96:111], a[108:111], v[132:135], v[96:111]
    v_mfma_f32_32x32x16_bf16 v[32:47], a[44:47], a[4:7], 0
    v_mfma_f32_32x32x16_bf16 v[48:63], a[32:35], a[4:7], 0
    s_nop 11
    s_branch Lfr_6_0
Lfb_6_1:
    s_waitcnt vmcnt(0)
    v_mfma_f32_32x32x16_bf16 v[32:47], a[44:47], a[4:7], 0
    v_mfma_f32_32x32x16_bf16 v[48:63], a[32:35], a[4:7], 0
    s_nop 10
    v_cndmask_b32 v64, v8, v32, s[70:71]
    v_cndmask_b32 v65, v8, v33, s[72:73]
    v_cndmask_b32 v66, v8, v34, s[74:75]
    v_cndmask_b32 v67, v8, v35, s[76:77]
    v_cndmask_b32 v68, v8, v36, s[78:79]
    v_cndmask_b32 v69, v8, v37, s[80:81]
    s_nop 4
    v_cndmask_b32 v70, v8, v38, s[82:83]
    v_cndmask_b32 v71, v8, v39, s[84:85]
    v_cndmask_b32 v72, v8, v40, s[86:87]
    v_cndmask_b32 v73, v8, v41, s[88:89]
    v_cndmask_b32 v74, v8, v42, s[90:91]
    v_cndmask_b32 v75, v8, v43, s[92:93]
    v_cndmask_b32 v76, v8, v44, s[94:95]
    v_cndmask_b32 v77, v8, v45, s[96:97]
    v_cndmask_b32 v78, v8, v46, s[98:99]
    v_cndmask_b32 v79, v8, v47, s[100:101]
    v_mfma_f32_32x32x16_bf16 v[16:31], a[36:39], a[4:7], 0
    v_max_f32 v10, v64, v65
    v_max_f32 v13, v66, v67
    v_max3_f32 v10, v10, v68, v69
    v_max3_f32 v13, v13, v70, v71
    v_max3_f32 v10, v10, v72, v73
    v_max3_f32 v13, v13, v74, v75
    v_max3_f32 v10, v10, v76, v77
    v_max3_f32 v13, v13, v78, v79
    v_mfma_f32_32x32x16_bf16 v[32:47], a[40:43], a[4:7], 0
    v_max3_f32 v10, v10, v48, v49
    v_max3_f32 v13, v13, v50, v51
    v_max3_f32 v10, v10, v52, v53
    v_max3_f32 v13, v13, v54, v55
    v_max3_f32 v10, v10, v56, v57
    v_max3_f32 v13, v13, v58, v59
    v_max3_f32 v10, v10, v60, v61
    v_max3_f32 v13, v13, v62, v63
    v_max3_f32 v10, v10, v16, v17
    v_max3_f32 v13, v13, v18, v19
    v_max3_f32 v10, v10, v20, v21
    v_max3_f32 v13, v13, v22, v23
    v_max3_f32 v10, v10, v24, v25
    v_max3_f32 v13, v13, v26, v27
    v_max3_f32 v10, v10, v28, v29
    v_max3_f32 v13, v13, v30, v31
    v_max3_f32 v10, v10, v32, v33
    v_max3_f32 v13, v13, v34, v35
    v_max3_f32 v10, v10, v36, v37
    v_max3_f32 v13, v13, v38, v39
    v_max3_f32 v10, v10, v40, v41
    v_max3_f32 v13, v13, v42, v43
    v_max3_f32 v10, v10, v44, v45
    v_max3_f32 v13, v13, v46, v47
    v_max_f32 v10, v10, v13
    v_mov_b32 v13, v10
    s_nop 1
    v_permlane32_swap_b32 v10, v13
    v_max_f32 v10, v10, v13
    v_sub_f32 v160, 0, v10
    v_sub_f32 v161, 0, v10
    v_sub_f32 v162, 0, v10
    v_sub_f32 v163, 0, v10
    v_sub_f32 v164, 0, v10
    v_sub_f32 v165, 0, v10
    v_sub_f32 v166, 0, v10
    v_sub_f32 v167, 0, v10
    v_sub_f32 v168, 0, v10
    v_sub_f32 v169, 0, v10
    v_sub_f32 v170, 0, v10
    v_sub_f32 v171, 0, v10
    v_sub_f32 v172, 0, v10
    v_sub_f32 v173, 0, v10
    v_sub_f32 v174, 0, v10
    v_sub_f32 v175, 0, v10
    s_nop 1
    v_mfma_f32_32x32x16_bf16 v[16:31], a[32:35], a[4:7], v[160:175]
    v_mfma_f32_32x32x16_bf16 v[32:47], a[36:39], a[4:7], v[160:175]
    v_sub_f32 v64, v64, v10
    v_sub_f32 v65, v65, v10
    v_sub_f32 v66, v66, v10
    v_sub_f32 v67, v67, v10
    v_sub_f32 v68, v68, v10
    v_sub_f32 v69, v69, v10
    v_sub_f32 v70, v70, v10
    v_sub_f32 v71, v71, v10
    v_sub_f32 v72, v72, v10
    v_sub_f32 v73, v73, v10
    v_sub_f32 v74, v74, v10
    v_sub_f32 v75, v75, v10
    v_sub_f32 v76, v76, v10
    v_sub_f32 v77, v77, v10
    v_sub_f32 v78, v78, v10
    v_sub_f32 v79, v79, v10
    v_exp_f32 v64, v64
    v_exp_f32 v65, v65
    v_exp_f32 v66, v66
    v_exp_f32 v67, v67
    v_exp_f32 v68, v68
    v_exp_f32 v69, v69
    v_exp_f32 v70, v70
    v_exp_f32 v71, v71
    v_exp_f32 v72, v72
    v_exp_f32 v73, v73
    v_exp_f32 v74, v74
    v_exp_f32 v75, v75
    v_exp_f32 v76, v76
    v_exp_f32 v77, v77
    v_exp_f32 v78, v78
    v_exp_f32 v79, v79
    v_cvt_pk_bf16_f32 v128, v64, v65
    v_cvt_pk_bf16_f32 v129, v66, v67
    v_cvt_pk_bf16_f32 v130, v68, v69
    v_cvt_pk_bf16_f32 v131, v70, v71
    v_cvt_pk_bf16_f32 v132, v72, v73
    v_cvt_pk_bf16_f32 v133, v74, v75
    v_cvt_pk_bf16_f32 v134, v76, v77
    v_cvt_pk_bf16_f32 v135, v78, v79
    v_mfma_f32_32x32x16_bf16 v[112:127], a[120:123], v[128:131], 0
    v_exp_f32 v16, v16
    v_exp_f32 v17, v17
    v_exp_f32 v18, v18
    v_exp_f32 v19, v19
    v_mfma_f32_32x32x16_bf16 v[112:127], a[124:127], v[132:135], v[112:127]
    v_exp_f32 v20, v20
    v_exp_f32 v21, v21
    v_exp_f32 v22, v22
    v_exp_f32 v23, v23
    v_mfma_f32_32x32x16_bf16 v[48:63], a[40:43], a[4:7], v[160:175]
    v_exp_f32 v24, v24
    v_exp_f32 v25, v25
    v_exp_f32 v26, v26
    v_exp_f32 v27, v27
    v_exp_f32 v28, v28
    v_exp_f32 v29, v29
    v_exp_f32 v30, v30
    v_exp_f32 v31, v31
    v_cvt_pk_bf16_f32 v128, v16, v17
    v_cvt_pk_bf16_f32 v129, v18, v19
    v_cvt_pk_bf16_f32 v130, v20, v21
    v_cvt_pk_bf16_f32 v131, v22, v23
    v_cvt_pk_bf16_f32 v132, v24, v25
    v_cvt_pk_bf16_f32 v133, v26, v27
    v_cvt_pk_bf16_f32 v134, v28, v29
    v_cvt_pk_bf16_f32 v135, v30, v31
    v_mfma_f32_32x32x16_bf16 v[112:127], a[96:99], v[128:131], v[112:127]
    v_exp_f32 v32, v32
    v_exp_f32 v33, v33
    v_exp_f32 v34, v34
    v_exp_f32 v35, v35
    v_mfma_f32_32x32x16_bf16 v[112:127], a[100:103], v[132:135], v[112:127]
    v_exp_f32 v36, v36
    v_exp_f32 v37, v37
    v_exp_f32 v38, v38
    v_exp_f32 v39, v39
    v_exp_f32 v40, v40
    v_exp_f32 v41, v41
    v_exp_f32 v42, v42
    v_exp_f32 v43, v43
    v_exp_f32 v44, v44
    v_exp_f32 v45, v45
    v_exp_f32 v46, v46
    v_exp_f32 v47, v47
    v_cvt_pk_bf16_f32 v128, v32, v33
    v_cvt_pk_bf16_f32 v129, v34, v35
    v_cvt_pk_bf16_f32 v130, v36, v37
    v_cvt_pk_bf16_f32 v131, v38, v39
    v_cvt_pk_bf16_f32 v132, v40, v41
    v_cvt_pk_bf16_f32 v133, v42, v43
    v_cvt_pk_bf16_f32 v134, v44, v45
    v_cvt_pk_bf16_f32 v135, v46, v47
    v_mfma_f32_32x32x16_bf16 v[112:127], a[104:107], v[128:131], v[112:127]
    v_exp_f32 v48, v48
    v_exp_f32 v49, v49
    v_exp_f32 v50, v50
    v_exp_f32 v51, v51
    v_mfma_f32_32x32x16_bf16 v[112:127], a[108:111], v[132:135], v[112:127]
    v_exp_f32 v52, v52
    v_exp_f32 v53, v53
    v_exp_f32 v54, v54
    v_exp_f32 v55, v55
    v_exp_f32 v56, v56
    v_exp_f32 v57, v57
    v_exp_f32 v58, v58
    v_exp_f32 v59, v59
    v_exp_f32 v60, v60
    v_exp_f32 v61, v61
    v_exp_f32 v62, v62
    v_exp_f32 v63, v63
    v_cvt_pk_bf16_f32 v128, v48, v49
    v_cvt_pk_bf16_f32 v129, v50, v51
    v_cvt_pk_bf16_f32 v130, v52, v53
    v_cvt_pk_bf16_f32 v131, v54, v55
    v_cvt_pk_bf16_f32 v132, v56, v57
    v_cvt_pk_bf16_f32 v133, v58, v59
    v_cvt_pk_bf16_f32 v134, v60, v61
    v_cvt_pk_bf16_f32 v135, v62, v63
    v_mfma_f32_32x32x16_bf16 v[112:127], a[112:115], v[128:131], v[112:127]
    s_nop 0
    v_mfma_f32_32x32x16_bf16 v[112:127], a[116:119], v[132:135], v[112:127]
    s_nop 11
    s_branch Lfr_6_1
Lfb_8_0:
    s_waitcnt vmcnt(0)
    s_nop 3
    v_mfma_f32_32x32x16_bf16 v[32:47], a[40:43], a[0:3], 0
    s_nop 11
    v_cndmask_b32 v64, v8, v32, s[70:71]
    v_cndmask_b32 v65, v8, v33, s[72:73]
    v_cndmask_b32 v66, v8, v34, s[74:75]
    v_cndmask_b32 v67, v8, v35, s[76:77]
    v_cndmask_b32 v68, v8, v36, s[78:79]
    v_cndmask_b32 v69, v8, v37, s[80:81]
    v_cndmask_b32 v70, v8, v38, s[82:83]
    v_cndmask_b32 v71, v8, v39, s[84:85]
    v_cndmask_b32 v72, v8, v40, s[86:87]
    s_nop 2
    v_cndmask_b32 v73, v8, v41, s[88:89]
    v_cndmask_b32 v74, v8, v42, s[90:91]
    v_cndmask_b32 v75, v8, v43, s[92:93]
    v_cndmask_b32 v76, v8, v44, s[94:95]
    v_cndmask_b32 v77, v8, v45, s[96:97]
    v_cndmask_b32 v78, v8, v46, s[98:99]
    v_cndmask_b32 v79, v8, v47, s[100:101]
    v_max_f32 v10, v64, v65
    v_max_f32 v13, v66, v67
    v_max3_f32 v10, v10, v68, v69
    v_max3_f32 v13, v13, v70, v71
    v_max3_f32 v10, v10, v72, v73
    v_max3_f32 v13, v13, v74, v75
    v_max3_f32 v10, v10, v76, v77
    v_max3_f32 v13, v13, v78, v79
    v_max_f32 v10, v10, v13
    v_mov_b32 v13, v10
    s_nop 1
    v_permlane32_swap_b32 v10, v13
    v_max_f32 v10, v10, v13
    v_sub_f32 v64, v64, v10
    v_sub_f32 v65, v65, v10
    v_sub_f32 v66, v66, v10
    v_sub_f32 v67, v67, v10
    v_sub_f32 v68, v68, v10
    v_sub_f32 v69, v69, v10
    v_sub_f32 v70, v70, v10
    v_sub_f32 v71, v71, v10
    v_sub_f32 v72, v72, v10
    v_sub_f32 v73, v73, v10
    v_sub_f32 v74, v74, v10
    v_sub_f32 v75, v75, v10
    v_sub_f32 v76, v76, v10
    v_sub_f32 v77, v77, v10
    v_sub_f32 v78, v78, v10
    v_sub_f32 v79, v79, v10
    v_exp_f32 v64, v64
    v_exp_f32 v65, v65
    v_exp_f32 v66, v66
    v_exp_f32 v67, v67
    v_exp_f32 v68, v68
    v_exp_f32 v69, v69
    v_exp_f32 v70, v70
    v_exp_f32 v71, v71
    v_exp_f32 v72, v72
    v_exp_f32 v73, v73
    v_exp_f32 v74, v74
    v_exp_f32 v75, v75
    v_exp_f32 v76, v76
    v_exp_f32 v77, v77
    v_exp_f32 v78, v78
    v_exp_f32 v79, v79
    v_cvt_pk_bf16_f32 v128, v64, v65
    v_cvt_pk_bf16_f32 v129, v66, v67
    v_cvt_pk_bf16_f32 v130, v68, v69
    v_cvt_pk_bf16_f32 v131, v70, v71
    v_cvt_pk_bf16_f32 v132, v72, v73
    v_cvt_pk_bf16_f32 v133, v74, v75
    v_cvt_pk_bf16_f32 v134, v76, v77
    v_cvt_pk_bf16_f32 v135, v78, v79
    v_mfma_f32_32x32x16_bf16 v[96:111], a[112:115], v[128:131], 0
    s_nop 0
    v_mfma_f32_32x32x16_bf16 v[96:111], a[116:119], v[132:135], v[96:111]
    v_mfma_f32_32x32x16_bf16 v[32:47], a[44:47], a[4:7], 0
    v_mfma_f32_32x32x16_bf16 v[48:63], a[40:43], a[4:7], 0
    s_nop 11
    s_branch Lfr_8_0
Lfb_8_1:
    s_waitcnt vmcnt(0)
    v_mfma_f32_32x32x16_bf16 v[32:47], a[44:47], a[4:7], 0
    v_mfma_f32_32x32x16_bf16 v[48:63], a[40:43], a[4:7], 0
    s_nop 10
    v_cndmask_b32 v64, v8, v32, s[70:71]
    v_cndmask_b32 v65, v8, v33, s[72:73]
    v_cndmask_b32 v66, v8, v34, s[74:75]
    v_cndmask_b32 v67, v8, v35, s[76:77]
    v_cndmask_b32 v68, v8, v36, s[78:79]
    v_cndmask_b32 v69, v8, v37, s[80:81]
    s_nop 4
    v_cndmask_b32 v70, v8, v38, s[82:83]
    v_cndmask_b32 v71, v8, v39, s[84:85]
    v_cndmask_b32 v72, v8, v40, s[86:87]
    v_cndmask_b32 v73, v8, v41, s[88:89]
    v_cndmask_b32 v74, v8, v42, s[90:91]
    v_cndmask_b32 v75, v8, v43, s[92:93]
    v_cndmask_b32 v76, v8, v44, s[94:95]
    v_cndmask_b32 v77, v8, v45, s[96:97]
    v_cndmask_b32 v78, v8, v46, s[98:99]
    v_cndmask_b32 v79, v8, v47, s[100:101]
    v_max_f32 v10, v64, v65
    v_max_f32 v13, v66, v67
    v_max3_f32 v10, v10, v68, v69
    v_max3_f32 v13, v13, v70, v71
    v_max3_f32 v10, v10, v72, v73
    v_max3_f32 v13, v13, v74, v75
    v_max3_f32 v10, v10, v76, v77
    v_max3_f32 v13, v13, v78, v79
    v_max3_f32 v10, v10, v48, v49
    v_max3_f32 v13, v13, v50, v51
    v_max3_f32 v10, v10, v52, v53
    v_max3_f32 v13, v13, v54, v55
    v_max3_f32 v10, v10, v56, v57
    v_max3_f32 v13, v13, v58, v59
    v_max3_f32 v10, v10, v60, v61
    v_max3_f32 v13, v13, v62, v63
    v_max_f32 v10, v10, v13
    v_mov_b32 v13, v10
    s_nop 1
    v_permlane32_swap_b32 v10, v13
    v_max_f32 v10, v10, v13
    v_sub_f32 v160, 0, v10
    v_sub_f32 v161, 0, v10
    v_sub_f32 v162, 0, v10
    v_sub_f32 v163, 0, v10
    v_sub_f32 v164, 0, v10
    v_sub_f32 v165, 0, v10
    v_sub_f32 v166, 0, v10
    v_sub_f32 v167, 0, v10
    v_sub_f32 v168, 0, v10
    v_sub_f32 v169, 0, v10
    v_sub_f32 v170, 0, v10
    v_sub_f32 v171, 0, v10
    v_sub_f32 v172, 0, v10
    v_sub_f32 v173, 0, v10
    v_sub_f32 v174, 0, v10
    v_sub_f32 v175, 0, v10
    s_nop 1
    v_mfma_f32_32x32x16_bf16 v[16:31], a[40:43], a[4:7], v[160:175]
    v_sub_f32 v64, v64, v10
    v_sub_f32 v65, v65, v10
    v_sub_f32 v66, v66, v10
    v_sub_f32 v67, v67, v10
    v_sub_f32 v68, v68, v10
    v_sub_f32 v69, v69, v10
    v_sub_f32 v70, v70, v10
    v_sub_f32 v71, v71, v10
    v_sub_f32 v72, v72, v10
    v_sub_f32 v73, v73, v10
    v_sub_f32 v74, v74, v10
    v_sub_f32 v75, v75, v10
    v_sub_f32 v76, v76, v10
    v_sub_f32 v77, v77, v10
    v_sub_f32 v78, v78, v10
    v_sub_f32 v79, v79, v10
    v_exp_f32 v64, v64
    v_exp_f32 v65, v65
    v_exp_f32 v66, v66
    v_exp_f32 v67, v67
    v_exp_f32 v68, v68
    v_exp_f32 v69, v69
    v_exp_f32 v70, v70
    v_exp_f32 v71, v71
    v_exp_f32 v72, v72
    v_exp_f32 v73, v73
    v_exp_f32 v74, v74
    v_exp_f32 v75, v75
    v_exp_f32 v76, v76
    v_exp_f32 v77, v77
    v_exp_f32 v78, v78
    v_exp_f32 v79, v79
    v_cvt_pk_bf16_f32 v128, v64, v65
    v_cvt_pk_bf16_f32 v129, v66, v67
    v_cvt_pk_bf16_f32 v130, v68, v69
    v_cvt_pk_bf16_f32 v131, v70, v71
    v_cvt_pk_bf16_f32 v132, v72, v73
    v_cvt_pk_bf16_f32 v133, v74, v75
    v_cvt_pk_bf16_f32 v134, v76, v77
    v_cvt_pk_bf16_f32 v135, v78, v79
    v_mfma_f32_32x32x16_bf16 v[112:127], a[120:123], v[128:131], 0
    v_exp_f32 v16, v16
    v_exp_f32 v17, v17
    v_exp_f32 v18, v18
    v_exp_f32 v19, v19
    v_mfma_f32_32x32x16_bf16 v[112:127], a[124:127], v[132:135], v[112:127]
    v_exp_f32 v20, v20
    v_exp_f32 v21, v21
    v_exp_f32 v22, v22
    v_exp_f32 v23, v23
    v_exp_f32 v24, v24
    v_exp_f32 v25, v25
    v_exp_f32 v26, v26
    v_exp_f32 v27, v27
    v_exp_f32 v28, v28
    v_exp_f32 v29, v29
    v_exp_f32 v30, v30
    v_exp_f32 v31, v31
    v_cvt_pk_bf16_f32 v128, v16, v17
    v_cvt_pk_bf16_f32 v129, v18, v19
    v_cvt_pk_bf16_f32 v130, v20, v21
    v_cvt_pk_bf16_f32 v131, v22, v23
    v_cvt_pk_bf16_f32 v132, v24, v25
    v_cvt_pk_bf16_f32 v133, v26, v27
    v_cvt_pk_bf16_f32 v134, v28, v29
    v_cvt_pk_bf16_f32 v135, v30, v31
    v_mfma_f32_32x32x16_bf16 v[112:127], a[112:115], v[128:131], v[112:127]
    s_nop 0
    v_mfma_f32_32x32x16_bf16 v[112:127], a[116:119], v[132:135], v[112:127]
    s_nop 11
    s_branch Lfr_8_1
.section .rodata,"a"
.p2align 6
.amdhsa_kernel parallel_sum__sliding_block__glu_gated_geglu__prompt_kernel
  .amdhsa_next_free_vgpr 512
  .amdhsa_next_free_sgpr 102
  .amdhsa_accum_offset 256
  .amdhsa_group_segment_fixed_size 0
  .amdhsa_kernarg_size 80
  .amdhsa_user_sgpr_count 2
  .amdhsa_user_sgpr_kernarg_segment_ptr 1
  .amdhsa_system_sgpr_workgroup_id_x 1
.end_amdhsa_kernel
.p2align 6
```
